```python
import torch

def _softmax(x, axis=-1):
    return torch.softmax(x, dim=axis)
def _gelu(x):
    return torch.nn.functional.gelu(x, approximate="tanh")
def _silu(x):
    return torch.nn.functional.silu(x)
def _sigmoid(x):
    return torch.sigmoid(x)
def _layernorm(x, axis=-1, eps=1e-5):
    m = x.mean(dim=axis, keepdim=True)
    v = x.var(dim=axis, keepdim=True, unbiased=False)
    return (x - m) / torch.sqrt(v + eps)
def _scatter_add(tgt, idx, src, axis=0):
    return tgt.clone().index_add_(axis, idx, src)
def _segment_sum(src, seg, n):
    out = torch.zeros((n,) + src.shape[1:], dtype=src.dtype)
    return out.index_add_(0, seg, src)
def _pad(x, pw):
    flat = tuple(v for pair in reversed(pw) for v in pair)
    return torch.nn.functional.pad(x, flat)

kernel_name = 'concat_heads__gqa_block_cached__gqa_block_cached__near_ridge'

def setup_inputs():

    _w = (lambda a: (lambda t: t.to(torch.bfloat16) if t.is_floating_point() else t)(torch.as_tensor(a)))
    def _A_setup():
        B, Sq, D = 8, 144, 640
        Hq, Hkv, Sk, Dh = 32, 32, 1024, 128
        assert Hq % Hkv == 0, (Hq, Hkv)
        return {
            "x": _w((lambda *s: torch.randn(*s, dtype=torch.bfloat16) * 0.8)(B, Sq, D)),
            "k_cache": _w((lambda *s: torch.randn(*s, dtype=torch.bfloat16) * 0.8)(B, Hkv, Sk, Dh)),
            "v_cache": _w((lambda *s: torch.randn(*s, dtype=torch.bfloat16) * 0.05)(B, Hkv, Sk, Dh)),
            "wq": _w((lambda *s: torch.randn(*s, dtype=torch.bfloat16) * 0.8)(D, Hq * Dh) * (D ** -0.5)),
            "wo": _w((lambda *s: torch.randn(*s, dtype=torch.bfloat16) * 0.05)(Hq * Dh, D) * ((Hq * Dh) ** -0.5)),
        }
    _A_in = _A_setup()

    def _B_setup():
        B, Sq, D = 8, 144, 640
        Hq, Hkv, Sk, Dh = 32, 32, 1024, 128
        assert Hq % Hkv == 0, (Hq, Hkv)
        return {
            "x": _w((lambda *s: torch.randn(*s, dtype=torch.bfloat16) * 0.8)(B, Sq, D)),
            "k_cache": _w((lambda *s: torch.randn(*s, dtype=torch.bfloat16) * 0.8)(B, Hkv, Sk, Dh)),
            "v_cache": _w((lambda *s: torch.randn(*s, dtype=torch.bfloat16) * 0.05)(B, Hkv, Sk, Dh)),
            "wq": _w((lambda *s: torch.randn(*s, dtype=torch.bfloat16) * 0.8)(D, Hq * Dh) * (D ** -0.5)),
            "wo": _w((lambda *s: torch.randn(*s, dtype=torch.bfloat16) * 0.05)(Hq * Dh, D) * ((Hq * Dh) ** -0.5)),
        }
    _B_in = _B_setup()

    return {
        "A_x": _A_in["x"],
        "A_k_cache": _A_in["k_cache"],
        "A_v_cache": _A_in["v_cache"],
        "A_wq": _A_in["wq"],
        "A_wo": _A_in["wo"],
        "B_x": _B_in["x"],
        "B_k_cache": _B_in["k_cache"],
        "B_v_cache": _B_in["v_cache"],
        "B_wq": _B_in["wq"],
        "B_wo": _B_in["wo"],
    }

def reference(A_x, A_k_cache, A_v_cache, A_wq, A_wo, B_x, B_k_cache, B_v_cache, B_wq, B_wo):
    def _A_ref(x, k_cache, v_cache, wq, wo):
        B, Sq, D = x.shape
        Hq, Dh = 32, 128
        Hkv = k_cache.shape[1]
        rep = Hq // Hkv
        q = (lambda x, *d: x.permute(*d))((x @ wq).reshape(B, Sq, Hq, Dh), 0, 2, 1, 3)
        k = (lambda x, n, axis: torch.repeat_interleave(x, n, dim=axis))(k_cache, rep, axis=1)
        v = (lambda x, n, axis: torch.repeat_interleave(x, n, dim=axis))(v_cache, rep, axis=1)
        scores = torch.einsum("bhqd,bhkd->bhqk", q, k) * (Dh ** -0.5)
        p = _softmax(scores, axis=-1)
        o = torch.einsum("bhqk,bhkd->bhqd", p, v)
        return (lambda x, *d: x.permute(*d))(o, 0, 2, 1, 3).reshape(B, Sq, Hq * Dh) @ wo

    def _B_ref(x, k_cache, v_cache, wq, wo):
        B, Sq, D = x.shape
        Hq, Dh = 32, 128
        Hkv = k_cache.shape[1]
        rep = Hq // Hkv
        q = (lambda x, *d: x.permute(*d))((x @ wq).reshape(B, Sq, Hq, Dh), 0, 2, 1, 3)
        k = (lambda x, n, axis: torch.repeat_interleave(x, n, dim=axis))(k_cache, rep, axis=1)
        v = (lambda x, n, axis: torch.repeat_interleave(x, n, dim=axis))(v_cache, rep, axis=1)
        scores = torch.einsum("bhqd,bhkd->bhqk", q, k) * (Dh ** -0.5)
        p = _softmax(scores, axis=-1)
        o = torch.einsum("bhqk,bhkd->bhqd", p, v)
        return (lambda x, *d: x.permute(*d))(o, 0, 2, 1, 3).reshape(B, Sq, Hq * Dh) @ wo

    a = _A_ref(A_x, A_k_cache, A_v_cache, A_wq, A_wo)
    b = _B_ref(B_x, B_k_cache, B_v_cache, B_wq, B_wo)
    return torch.concatenate([a, b], axis=-1)
```

```asm
; @launch grid=(256,1,1) block=(512,1,1) lds=163840
.amdgcn_target "amdgcn-amd-amdhsa--gfx950"
.text
.globl concat_heads__gqa_block_cached__gqa_block_cached__near_ridge_kernel
.p2align 8
.type concat_heads__gqa_block_cached__gqa_block_cached__near_ridge_kernel,@function
concat_heads__gqa_block_cached__gqa_block_cached__near_ridge_kernel:
    s_cmp_ge_u32 s2, 256
    s_cbranch_scc1 L_end
    s_load_dwordx16 s[48:63], s[0:1], 0
    s_load_dwordx8 s[64:71], s[0:1], 64
    s_load_dwordx2 s[72:73], s[0:1], 96
    v_lshrrev_b32 v1, 6, v0
    v_and_b32 v247, 63, v0
    v_readfirstlane_b32 s3, v1
    v_lshlrev_b32 v246, 4, v247
    s_and_b32 s4, s2, 7
    s_lshr_b32 s5, s2, 3
    s_lshr_b32 s36, s4, 2
    s_and_b32 s37, s5, 7
    s_lshr_b32 s6, s5, 3
    s_and_b32 s7, s4, 3
    s_lshl_b32 s7, s7, 3
    s_lshl_b32 s38, s6, 1
    s_add_u32 s38, s38, s7
    s_mul_i32 s6, s6, 5
    s_add_u32 s6, s6, 1
    s_lshr_b32 s6, s6, 1
    s_add_u32 s101, s6, s37
    s_cmp_ge_u32 s101, 9
    s_cselect_b32 s6, 9, 0
    s_sub_u32 s101, s101, s6
    s_lshl_b32 s6, s37, 5
    s_add_u32 s6, s6, s38
    s_lshl_b32 s39, s6, 18
    s_mul_i32 s6, s36, 72
    s_mul_i32 s7, s37, 9
    s_add_u32 s6, s6, s7
    s_lshl_b32 s6, s6, 5
    s_add_u32 s6, s6, s38
    s_lshl_b32 s47, s6, 12
    s_mov_b32 s40, 0x3e0293ee
    s_mov_b32 s18, 1474560
    s_mov_b32 s19, 0x20000
    s_mov_b32 s10, 67108864
    s_mov_b32 s11, 0x20000
    s_mov_b32 s14, 67108864
    s_mov_b32 s15, 0x20000
    s_mov_b32 s22, 5242880
    s_mov_b32 s23, 0x20000
    s_mov_b32 s30, 5242880
    s_mov_b32 s31, 0x20000
    s_mov_b32 s26, 292356096
    s_mov_b32 s27, 0x20000
    s_mov_b32 s34, 2949120
    s_mov_b32 s35, 0x20000
    s_and_b32 s76, s3, 1
    s_lshl_b32 s77, s76, 5
    s_lshl_b32 s76, s76, 2
    v_lshrrev_b32 v1, 4, v247
    v_and_b32 v2, 15, v247
    v_lshlrev_b32 v3, 2, v1
    v_xor_b32 v3, v3, v2
    v_lshlrev_b32 v3, 4, v3
    v_lshl_add_u32 v8, v1, 13, v3
    v_xor_b32 v8, s77, v8
    v_lshrrev_b32 v5, 3, v247
    v_mul_u32_u24 v5, 1280, v5
    v_and_b32 v6, 7, v247
    v_xor_b32 v4, s76, v1
    v_xor_b32 v4, v4, v6
    v_lshl_add_u32 v9, v4, 4, v5
    s_and_b32 s76, s3, 3
    s_lshl_b32 s76, s76, 16
    s_lshr_b32 s77, s3, 2
    s_add_u32 s77, s77, s38
    s_lshl_b32 s77, s77, 8
    s_add_u32 s76, s76, s77
    s_mul_i32 s77, s37, 184320
    s_mul_i32 s78, s3, 10240
    s_add_u32 s77, s77, s78
    s_lshl_b32 s78, s3, 11
    s_lshl_b32 s79, s3, 10
    s_waitcnt lgkmcnt(0)
    s_cmp_eq_u32 s36, 0
    s_cselect_b32 s16, s48, s58
    s_cselect_b32 s17, s49, s59
    s_cselect_b32 s20, s54, s64
    s_cselect_b32 s21, s55, s65
    s_cselect_b32 s8, s50, s60
    s_cselect_b32 s9, s51, s61
    s_cselect_b32 s12, s52, s62
    s_cselect_b32 s13, s53, s63
    s_cselect_b32 s28, s56, s66
    s_cselect_b32 s29, s57, s67
    s_add_u32 m0, s78, 49152
    s_nop 0
    buffer_load_dwordx4 v8, s[20:23], s76 offen lds
    s_add_u32 m0, s78, 50176
    s_add_u32 s76, s76, 32768
    buffer_load_dwordx4 v8, s[20:23], s76 offen lds
    s_add_u32 m0, s79, 98304
    s_nop 0
    buffer_load_dwordx4 v9, s[16:19], s77 offen lds
    s_add_u32 m0, s79, 106496
    s_add_u32 s76, s77, 81920
    buffer_load_dwordx4 v9, s[16:19], s76 offen lds
    s_and_b32 s78, s3, 1
    s_sub_u32 s79, s3, s78
    s_mul_i32 s79, s79, 10240
    s_sub_u32 s77, s77, s79
    s_lshl_b32 s78, s78, 10
    s_add_u32 m0, s78, 114688
    s_add_u32 s76, s77, 163840
    buffer_load_dwordx4 v9, s[16:19], s76 offen lds
    s_mov_b32 s24, s72
    s_mov_b32 s25, s73
    s_mov_b32 s32, s68
    s_mov_b32 s33, s69
    s_cmp_eq_u32 s3, 5
    s_cbranch_scc1 L_h0
    s_cmp_eq_u32 s3, 6
    s_cbranch_scc1 L_h1
    s_cmp_eq_u32 s3, 7
    s_cbranch_scc1 L_h2
    s_mov_b32 s75, 16384
    s_lshl_b32 s6, s3, 13
    s_add_u32 s74, s6, 98304
    s_lshl_b32 s6, s3, 18
    s_add_u32 s47, s47, s6
    s_cmp_eq_u32 s3, 4
    s_cbranch_scc1 L_a1
    s_getpc_b64 s[52:53]
L_pcbase:
    s_mov_b32 s54, L_end-L_pcbase
    s_mov_b32 s55, 0x20000
    s_lshl_b32 s6, s5, 2
    s_add_u32 s6, s6, s3
    s_lshl_b32 s6, s6, 10
    buffer_load_dwordx4 v[212:215], v246, s[52:55], s6 offen
    v_bfe_u32 v216, v247, 2, 2
    v_lshrrev_b32 v218, 4, v247
    v_lshl_add_u32 v219, v218, 3, v216
    v_lshlrev_b32 v219, 8, v219
    v_and_b32 v218, 1, v218
    v_lshlrev_b32 v218, 1, v218
    v_lshl_add_u32 v218, v216, 2, v218
    v_bfe_u32 v220, v247, 1, 1
    v_xor_b32 v218, v218, v220
    v_lshl_add_u32 v219, v218, 4, v219
    v_and_b32 v217, 1, v247
    v_lshl_add_u32 v219, v217, 3, v219
    s_and_b32 s4, s3, 1
    s_lshl_b32 s4, s4, 7
    s_lshr_b32 s5, s3, 1
    s_lshl_b32 s5, s5, 13
    s_add_u32 s5, s5, 32768
    v_xor_b32 v219, s4, v219
    v_add_u32 v219, s5, v219
    v_xor_b32 v224, 0, v219
    v_xor_b32 v225, 32, v219
    v_xor_b32 v226, 64, v219
    v_xor_b32 v227, 96, v219
    v_and_b32 v216, 15, v247
    v_lshrrev_b32 v218, 4, v247
    v_lshrrev_b32 v217, 1, v216
    v_xor_b32 v218, v218, v217
    v_lshlrev_b32 v219, 7, v216
    v_lshl_add_u32 v219, v218, 4, v219
    v_add_u32 v252, 98304, v219
    v_xor_b32 v253, 64, v252
    v_and_b32 v216, 15, v247
    v_lshrrev_b32 v217, 4, v247
    v_xor_b32 v217, v217, v216
    v_lshlrev_b32 v216, 8, v216
    v_lshl_add_u32 v216, v217, 4, v216
    v_xor_b32 v232, 0, v216
    v_xor_b32 v233, 64, v216
    v_xor_b32 v234, 128, v216
    v_xor_b32 v235, 192, v216
    v_bfe_u32 v216, v247, 2, 2
    v_lshrrev_b32 v218, 4, v247
    v_lshl_add_u32 v219, v218, 2, v216
    v_lshlrev_b32 v219, 8, v219
    v_and_b32 v218, 1, v218
    v_lshlrev_b32 v218, 1, v218
    v_lshl_add_u32 v218, v216, 2, v218
    v_bfe_u32 v220, v247, 1, 1
    v_xor_b32 v218, v218, v220
    v_lshl_add_u32 v219, v218, 4, v219
    v_and_b32 v217, 1, v247
    v_lshl_add_u32 v219, v217, 3, v219
    v_add_u32 v219, 49152, v219
    v_xor_b32 v236, 0, v219
    v_xor_b32 v237, 32, v219
    v_xor_b32 v238, 64, v219
    v_xor_b32 v239, 96, v219
    v_xor_b32 v240, 128, v219
    v_xor_b32 v241, 160, v219
    v_xor_b32 v242, 192, v219
    v_xor_b32 v243, 224, v219
    v_mov_b32 v244, 0
    v_mov_b32 v245, 0
    s_mov_b32 s41, 0x41000000
    s_mov_b32 s45, 1
    s_mov_b32 s46, 0
    s_lshl_b32 s6, s3, 13
    s_mov_b32 s7, 57344
    s_cmp_lt_u32 s3, 3
    s_cselect_b32 s7, 135168, s7
    s_add_u32 s6, s6, s7
    v_add_u32 v248, s6, v246
    v_pk_mov_b32 v[0:1], 0, 0
    v_pk_mov_b32 v[2:3], 0, 0
    v_pk_mov_b32 v[4:5], 0, 0
    v_pk_mov_b32 v[6:7], 0, 0
    v_pk_mov_b32 v[8:9], 0, 0
    v_pk_mov_b32 v[10:11], 0, 0
    v_pk_mov_b32 v[12:13], 0, 0
    v_pk_mov_b32 v[14:15], 0, 0
    v_pk_mov_b32 v[16:17], 0, 0
    v_pk_mov_b32 v[18:19], 0, 0
    v_pk_mov_b32 v[20:21], 0, 0
    v_pk_mov_b32 v[22:23], 0, 0
    v_pk_mov_b32 v[24:25], 0, 0
    v_pk_mov_b32 v[26:27], 0, 0
    v_pk_mov_b32 v[28:29], 0, 0
    v_pk_mov_b32 v[30:31], 0, 0
    v_pk_mov_b32 v[32:33], 0, 0
    v_pk_mov_b32 v[34:35], 0, 0
    v_pk_mov_b32 v[36:37], 0, 0
    v_pk_mov_b32 v[38:39], 0, 0
    v_pk_mov_b32 v[40:41], 0, 0
    v_pk_mov_b32 v[42:43], 0, 0
    v_pk_mov_b32 v[44:45], 0, 0
    v_pk_mov_b32 v[46:47], 0, 0
    v_pk_mov_b32 v[48:49], 0, 0
    v_pk_mov_b32 v[50:51], 0, 0
    v_pk_mov_b32 v[52:53], 0, 0
    v_pk_mov_b32 v[54:55], 0, 0
    v_pk_mov_b32 v[56:57], 0, 0
    v_pk_mov_b32 v[58:59], 0, 0
    v_pk_mov_b32 v[60:61], 0, 0
    v_pk_mov_b32 v[62:63], 0, 0
    v_pk_mov_b32 v[64:65], 0, 0
    v_pk_mov_b32 v[66:67], 0, 0
    v_pk_mov_b32 v[68:69], 0, 0
    v_pk_mov_b32 v[70:71], 0, 0
    v_pk_mov_b32 v[72:73], 0, 0
    v_pk_mov_b32 v[74:75], 0, 0
    v_pk_mov_b32 v[76:77], 0, 0
    v_pk_mov_b32 v[78:79], 0, 0
    v_pk_mov_b32 v[80:81], 0, 0
    v_pk_mov_b32 v[82:83], 0, 0
    v_pk_mov_b32 v[84:85], 0, 0
    v_pk_mov_b32 v[86:87], 0, 0
    v_pk_mov_b32 v[88:89], 0, 0
    v_pk_mov_b32 v[90:91], 0, 0
    v_pk_mov_b32 v[92:93], 0, 0
    v_pk_mov_b32 v[94:95], 0, 0
    v_pk_mov_b32 v[96:97], 0, 0
    v_pk_mov_b32 v[98:99], 0, 0
    v_pk_mov_b32 v[100:101], 0, 0
    v_pk_mov_b32 v[102:103], 0, 0
    v_pk_mov_b32 v[104:105], 0, 0
    v_pk_mov_b32 v[106:107], 0, 0
    v_pk_mov_b32 v[108:109], 0, 0
    v_pk_mov_b32 v[110:111], 0, 0
    v_pk_mov_b32 v[112:113], 0, 0
    v_pk_mov_b32 v[114:115], 0, 0
    v_pk_mov_b32 v[116:117], 0, 0
    v_pk_mov_b32 v[118:119], 0, 0
    v_pk_mov_b32 v[120:121], 0, 0
    v_pk_mov_b32 v[122:123], 0, 0
    v_pk_mov_b32 v[124:125], 0, 0
    v_pk_mov_b32 v[126:127], 0, 0
    v_pk_mov_b32 v[128:129], 0, 0
    v_pk_mov_b32 v[130:131], 0, 0
    v_pk_mov_b32 v[132:133], 0, 0
    v_pk_mov_b32 v[134:135], 0, 0
    v_pk_mov_b32 v[136:137], 0, 0
    v_pk_mov_b32 v[138:139], 0, 0
    v_pk_mov_b32 v[140:141], 0, 0
    v_pk_mov_b32 v[142:143], 0, 0
    s_mov_b32 s98, 0
    v_add_u32 v254, s98, v252
    v_add_u32 v255, s98, v253
    s_add_u32 s98, s98, 18432
    s_cmp_eq_u32 s98, 55296
    s_cselect_b32 s98, 0, s98
    s_waitcnt vmcnt(1)
    s_barrier
    ds_read_b64_tr_b16 v[180:181], v224 offset:16384
    ds_read_b64_tr_b16 v[182:183], v224 offset:17408
    ds_read_b64_tr_b16 v[184:185], v225 offset:16384
    ds_read_b64_tr_b16 v[186:187], v225 offset:17408
    ds_read_b64_tr_b16 v[188:189], v226 offset:16384
    ds_read_b64_tr_b16 v[190:191], v226 offset:17408
    ds_read_b64_tr_b16 v[192:193], v227 offset:16384
    ds_read_b64_tr_b16 v[194:195], v227 offset:17408
    ds_read_b128 v[144:147], v254
    ds_read_b128 v[148:151], v254 offset:2048
    ds_read_b128 v[152:155], v254 offset:4096
    ds_read_b128 v[156:159], v254 offset:6144
    ds_read_b128 v[160:163], v254 offset:8192
    ds_read_b128 v[164:167], v254 offset:10240
    ds_read_b128 v[168:171], v254 offset:12288
    ds_read_b128 v[172:175], v254 offset:14336
    ds_read_b128 v[176:179], v254 offset:16384
    s_mov_b32 s42, 0
    s_waitcnt lgkmcnt(0)
L_qp:
    s_barrier
    s_waitcnt lgkmcnt(12)
    v_mfma_f32_16x16x32_bf16 v[0:3], v[180:183], v[144:147], v[0:3]
    ds_read_b64_tr_b16 v[196:197], v224
    v_mfma_f32_16x16x32_bf16 v[4:7], v[184:187], v[144:147], v[4:7]
    ds_read_b64_tr_b16 v[198:199], v224 offset:1024
    s_waitcnt lgkmcnt(12)
    v_mfma_f32_16x16x32_bf16 v[8:11], v[188:191], v[144:147], v[8:11]
    ds_read_b64_tr_b16 v[200:201], v225
    s_waitcnt lgkmcnt(10)
    v_mfma_f32_16x16x32_bf16 v[12:15], v[192:195], v[144:147], v[12:15]
    ds_read_b64_tr_b16 v[202:203], v225 offset:1024
    v_mfma_f32_16x16x32_bf16 v[16:19], v[180:183], v[148:151], v[16:19]
    ds_read_b128 v[144:147], v255
    v_mfma_f32_16x16x32_bf16 v[20:23], v[184:187], v[148:151], v[20:23]
    ds_read_b64_tr_b16 v[204:205], v226
    v_mfma_f32_16x16x32_bf16 v[24:27], v[188:191], v[148:151], v[24:27]
    ds_read_b64_tr_b16 v[206:207], v226 offset:1024
    v_mfma_f32_16x16x32_bf16 v[28:31], v[192:195], v[148:151], v[28:31]
    ds_read_b64_tr_b16 v[208:209], v227
    s_waitcnt lgkmcnt(14)
    v_mfma_f32_16x16x32_bf16 v[32:35], v[180:183], v[152:155], v[32:35]
    ds_read_b128 v[148:151], v255 offset:2048
    v_mfma_f32_16x16x32_bf16 v[36:39], v[184:187], v[152:155], v[36:39]
    ds_read_b64_tr_b16 v[210:211], v227 offset:1024
    v_mfma_f32_16x16x32_bf16 v[40:43], v[188:191], v[152:155], v[40:43]
    v_mfma_f32_16x16x32_bf16 v[44:47], v[192:195], v[152:155], v[44:47]
    s_waitcnt lgkmcnt(15)
    v_mfma_f32_16x16x32_bf16 v[48:51], v[180:183], v[156:159], v[48:51]
    ds_read_b128 v[152:155], v255 offset:4096
    v_mfma_f32_16x16x32_bf16 v[52:55], v[184:187], v[156:159], v[52:55]
    v_mfma_f32_16x16x32_bf16 v[56:59], v[188:191], v[156:159], v[56:59]
    v_mfma_f32_16x16x32_bf16 v[60:63], v[192:195], v[156:159], v[60:63]
    s_waitcnt lgkmcnt(15)
    v_mfma_f32_16x16x32_bf16 v[64:67], v[180:183], v[160:163], v[64:67]
    ds_read_b128 v[156:159], v255 offset:6144
    v_mfma_f32_16x16x32_bf16 v[68:71], v[184:187], v[160:163], v[68:71]
    v_mfma_f32_16x16x32_bf16 v[72:75], v[188:191], v[160:163], v[72:75]
    v_mfma_f32_16x16x32_bf16 v[76:79], v[192:195], v[160:163], v[76:79]
    s_waitcnt lgkmcnt(15)
    v_mfma_f32_16x16x32_bf16 v[80:83], v[180:183], v[164:167], v[80:83]
    ds_read_b128 v[160:163], v255 offset:8192
    v_mfma_f32_16x16x32_bf16 v[84:87], v[184:187], v[164:167], v[84:87]
    v_mfma_f32_16x16x32_bf16 v[88:91], v[188:191], v[164:167], v[88:91]
    v_mfma_f32_16x16x32_bf16 v[92:95], v[192:195], v[164:167], v[92:95]
    s_waitcnt lgkmcnt(15)
    v_mfma_f32_16x16x32_bf16 v[96:99], v[180:183], v[168:171], v[96:99]
    ds_read_b128 v[164:167], v255 offset:10240
    v_mfma_f32_16x16x32_bf16 v[100:103], v[184:187], v[168:171], v[100:103]
    v_mfma_f32_16x16x32_bf16 v[104:107], v[188:191], v[168:171], v[104:107]
    v_mfma_f32_16x16x32_bf16 v[108:111], v[192:195], v[168:171], v[108:111]
    s_waitcnt lgkmcnt(15)
    v_mfma_f32_16x16x32_bf16 v[112:115], v[180:183], v[172:175], v[112:115]
    ds_read_b128 v[168:171], v255 offset:12288
    v_mfma_f32_16x16x32_bf16 v[116:119], v[184:187], v[172:175], v[116:119]
    v_mfma_f32_16x16x32_bf16 v[120:123], v[188:191], v[172:175], v[120:123]
    v_mfma_f32_16x16x32_bf16 v[124:127], v[192:195], v[172:175], v[124:127]
    s_waitcnt lgkmcnt(15)
    v_mfma_f32_16x16x32_bf16 v[128:131], v[180:183], v[176:179], v[128:131]
    ds_read_b128 v[172:175], v255 offset:14336
    v_mfma_f32_16x16x32_bf16 v[132:135], v[184:187], v[176:179], v[132:135]
    v_mfma_f32_16x16x32_bf16 v[136:139], v[188:191], v[176:179], v[136:139]
    v_mfma_f32_16x16x32_bf16 v[140:143], v[192:195], v[176:179], v[140:143]
    ds_read_b128 v[176:179], v255 offset:16384
    v_add_u32 v254, s98, v252
    v_add_u32 v255, s98, v253
    s_add_u32 s98, s98, 18432
    s_cmp_eq_u32 s98, 55296
    s_cselect_b32 s98, 0, s98
    s_barrier
    s_waitcnt lgkmcnt(12)
    v_mfma_f32_16x16x32_bf16 v[0:3], v[196:199], v[144:147], v[0:3]
    ds_read_b64_tr_b16 v[180:181], v224 offset:32768
    v_mfma_f32_16x16x32_bf16 v[4:7], v[200:203], v[144:147], v[4:7]
    ds_read_b64_tr_b16 v[182:183], v224 offset:33792
    s_waitcnt lgkmcnt(12)
    v_mfma_f32_16x16x32_bf16 v[8:11], v[204:207], v[144:147], v[8:11]
    ds_read_b64_tr_b16 v[184:185], v225 offset:32768
    s_waitcnt lgkmcnt(10)
    v_mfma_f32_16x16x32_bf16 v[12:15], v[208:211], v[144:147], v[12:15]
    ds_read_b64_tr_b16 v[186:187], v225 offset:33792
    v_mfma_f32_16x16x32_bf16 v[16:19], v[196:199], v[148:151], v[16:19]
    ds_read_b128 v[144:147], v254
    v_mfma_f32_16x16x32_bf16 v[20:23], v[200:203], v[148:151], v[20:23]
    ds_read_b64_tr_b16 v[188:189], v226 offset:32768
    v_mfma_f32_16x16x32_bf16 v[24:27], v[204:207], v[148:151], v[24:27]
    ds_read_b64_tr_b16 v[190:191], v226 offset:33792
    v_mfma_f32_16x16x32_bf16 v[28:31], v[208:211], v[148:151], v[28:31]
    ds_read_b64_tr_b16 v[192:193], v227 offset:32768
    s_waitcnt lgkmcnt(14)
    v_mfma_f32_16x16x32_bf16 v[32:35], v[196:199], v[152:155], v[32:35]
    ds_read_b128 v[148:151], v254 offset:2048
    v_mfma_f32_16x16x32_bf16 v[36:39], v[200:203], v[152:155], v[36:39]
    ds_read_b64_tr_b16 v[194:195], v227 offset:33792
    v_mfma_f32_16x16x32_bf16 v[40:43], v[204:207], v[152:155], v[40:43]
    v_mfma_f32_16x16x32_bf16 v[44:47], v[208:211], v[152:155], v[44:47]
    s_waitcnt lgkmcnt(15)
    v_mfma_f32_16x16x32_bf16 v[48:51], v[196:199], v[156:159], v[48:51]
    ds_read_b128 v[152:155], v254 offset:4096
    v_mfma_f32_16x16x32_bf16 v[52:55], v[200:203], v[156:159], v[52:55]
    v_mfma_f32_16x16x32_bf16 v[56:59], v[204:207], v[156:159], v[56:59]
    v_mfma_f32_16x16x32_bf16 v[60:63], v[208:211], v[156:159], v[60:63]
    s_waitcnt lgkmcnt(15)
    v_mfma_f32_16x16x32_bf16 v[64:67], v[196:199], v[160:163], v[64:67]
    ds_read_b128 v[156:159], v254 offset:6144
    v_mfma_f32_16x16x32_bf16 v[68:71], v[200:203], v[160:163], v[68:71]
    v_mfma_f32_16x16x32_bf16 v[72:75], v[204:207], v[160:163], v[72:75]
    v_mfma_f32_16x16x32_bf16 v[76:79], v[208:211], v[160:163], v[76:79]
    s_waitcnt lgkmcnt(15)
    v_mfma_f32_16x16x32_bf16 v[80:83], v[196:199], v[164:167], v[80:83]
    ds_read_b128 v[160:163], v254 offset:8192
    v_mfma_f32_16x16x32_bf16 v[84:87], v[200:203], v[164:167], v[84:87]
    v_mfma_f32_16x16x32_bf16 v[88:91], v[204:207], v[164:167], v[88:91]
    v_mfma_f32_16x16x32_bf16 v[92:95], v[208:211], v[164:167], v[92:95]
    s_waitcnt lgkmcnt(15)
    v_mfma_f32_16x16x32_bf16 v[96:99], v[196:199], v[168:171], v[96:99]
    ds_read_b128 v[164:167], v254 offset:10240
    v_mfma_f32_16x16x32_bf16 v[100:103], v[200:203], v[168:171], v[100:103]
    v_mfma_f32_16x16x32_bf16 v[104:107], v[204:207], v[168:171], v[104:107]
    v_mfma_f32_16x16x32_bf16 v[108:111], v[208:211], v[168:171], v[108:111]
    s_waitcnt lgkmcnt(15)
    v_mfma_f32_16x16x32_bf16 v[112:115], v[196:199], v[172:175], v[112:115]
    ds_read_b128 v[168:171], v254 offset:12288
    v_mfma_f32_16x16x32_bf16 v[116:119], v[200:203], v[172:175], v[116:119]
    v_mfma_f32_16x16x32_bf16 v[120:123], v[204:207], v[172:175], v[120:123]
    v_mfma_f32_16x16x32_bf16 v[124:127], v[208:211], v[172:175], v[124:127]
    s_waitcnt lgkmcnt(15)
    v_mfma_f32_16x16x32_bf16 v[128:131], v[196:199], v[176:179], v[128:131]
    ds_read_b128 v[172:175], v254 offset:14336
    v_mfma_f32_16x16x32_bf16 v[132:135], v[200:203], v[176:179], v[132:135]
    v_mfma_f32_16x16x32_bf16 v[136:139], v[204:207], v[176:179], v[136:139]
    v_mfma_f32_16x16x32_bf16 v[140:143], v[208:211], v[176:179], v[140:143]
    ds_read_b128 v[176:179], v254 offset:16384
    s_barrier
    s_waitcnt lgkmcnt(12)
    v_mfma_f32_16x16x32_bf16 v[0:3], v[180:183], v[144:147], v[0:3]
    ds_read_b64_tr_b16 v[196:197], v224 offset:49152
    v_mfma_f32_16x16x32_bf16 v[4:7], v[184:187], v[144:147], v[4:7]
    ds_read_b64_tr_b16 v[198:199], v224 offset:50176
    s_waitcnt lgkmcnt(12)
    v_mfma_f32_16x16x32_bf16 v[8:11], v[188:191], v[144:147], v[8:11]
    ds_read_b64_tr_b16 v[200:201], v225 offset:49152
    s_waitcnt lgkmcnt(10)
    v_mfma_f32_16x16x32_bf16 v[12:15], v[192:195], v[144:147], v[12:15]
    ds_read_b64_tr_b16 v[202:203], v225 offset:50176
    v_mfma_f32_16x16x32_bf16 v[16:19], v[180:183], v[148:151], v[16:19]
    ds_read_b128 v[144:147], v255
    v_mfma_f32_16x16x32_bf16 v[20:23], v[184:187], v[148:151], v[20:23]
    ds_read_b64_tr_b16 v[204:205], v226 offset:49152
    v_mfma_f32_16x16x32_bf16 v[24:27], v[188:191], v[148:151], v[24:27]
    ds_read_b64_tr_b16 v[206:207], v226 offset:50176
    v_mfma_f32_16x16x32_bf16 v[28:31], v[192:195], v[148:151], v[28:31]
    ds_read_b64_tr_b16 v[208:209], v227 offset:49152
    s_waitcnt lgkmcnt(14)
    v_mfma_f32_16x16x32_bf16 v[32:35], v[180:183], v[152:155], v[32:35]
    ds_read_b128 v[148:151], v255 offset:2048
    v_mfma_f32_16x16x32_bf16 v[36:39], v[184:187], v[152:155], v[36:39]
    ds_read_b64_tr_b16 v[210:211], v227 offset:50176
    v_mfma_f32_16x16x32_bf16 v[40:43], v[188:191], v[152:155], v[40:43]
    v_mfma_f32_16x16x32_bf16 v[44:47], v[192:195], v[152:155], v[44:47]
    s_waitcnt lgkmcnt(15)
    v_mfma_f32_16x16x32_bf16 v[48:51], v[180:183], v[156:159], v[48:51]
    ds_read_b128 v[152:155], v255 offset:4096
    v_mfma_f32_16x16x32_bf16 v[52:55], v[184:187], v[156:159], v[52:55]
    v_mfma_f32_16x16x32_bf16 v[56:59], v[188:191], v[156:159], v[56:59]
    v_mfma_f32_16x16x32_bf16 v[60:63], v[192:195], v[156:159], v[60:63]
    s_waitcnt lgkmcnt(15)
    v_mfma_f32_16x16x32_bf16 v[64:67], v[180:183], v[160:163], v[64:67]
    ds_read_b128 v[156:159], v255 offset:6144
    v_mfma_f32_16x16x32_bf16 v[68:71], v[184:187], v[160:163], v[68:71]
    v_mfma_f32_16x16x32_bf16 v[72:75], v[188:191], v[160:163], v[72:75]
    v_mfma_f32_16x16x32_bf16 v[76:79], v[192:195], v[160:163], v[76:79]
    s_waitcnt lgkmcnt(15)
    v_mfma_f32_16x16x32_bf16 v[80:83], v[180:183], v[164:167], v[80:83]
    ds_read_b128 v[160:163], v255 offset:8192
    v_mfma_f32_16x16x32_bf16 v[84:87], v[184:187], v[164:167], v[84:87]
    v_mfma_f32_16x16x32_bf16 v[88:91], v[188:191], v[164:167], v[88:91]
    v_mfma_f32_16x16x32_bf16 v[92:95], v[192:195], v[164:167], v[92:95]
    s_waitcnt lgkmcnt(15)
    v_mfma_f32_16x16x32_bf16 v[96:99], v[180:183], v[168:171], v[96:99]
    ds_read_b128 v[164:167], v255 offset:10240
    v_mfma_f32_16x16x32_bf16 v[100:103], v[184:187], v[168:171], v[100:103]
    v_mfma_f32_16x16x32_bf16 v[104:107], v[188:191], v[168:171], v[104:107]
    v_mfma_f32_16x16x32_bf16 v[108:111], v[192:195], v[168:171], v[108:111]
    s_waitcnt lgkmcnt(15)
    v_mfma_f32_16x16x32_bf16 v[112:115], v[180:183], v[172:175], v[112:115]
    ds_read_b128 v[168:171], v255 offset:12288
    v_mfma_f32_16x16x32_bf16 v[116:119], v[184:187], v[172:175], v[116:119]
    v_mfma_f32_16x16x32_bf16 v[120:123], v[188:191], v[172:175], v[120:123]
    v_mfma_f32_16x16x32_bf16 v[124:127], v[192:195], v[172:175], v[124:127]
    s_waitcnt lgkmcnt(15)
    v_mfma_f32_16x16x32_bf16 v[128:131], v[180:183], v[176:179], v[128:131]
    ds_read_b128 v[172:175], v255 offset:14336
    v_mfma_f32_16x16x32_bf16 v[132:135], v[184:187], v[176:179], v[132:135]
    v_mfma_f32_16x16x32_bf16 v[136:139], v[188:191], v[176:179], v[136:139]
    v_mfma_f32_16x16x32_bf16 v[140:143], v[192:195], v[176:179], v[140:143]
    ds_read_b128 v[176:179], v255 offset:16384
    v_add_u32 v254, s98, v252
    v_add_u32 v255, s98, v253
    s_add_u32 s98, s98, 18432
    s_cmp_eq_u32 s98, 55296
    s_cselect_b32 s98, 0, s98
    s_barrier
    s_waitcnt lgkmcnt(12)
    v_mfma_f32_16x16x32_bf16 v[0:3], v[196:199], v[144:147], v[0:3]
    ds_read_b64_tr_b16 v[180:181], v224 offset:16384
    v_mfma_f32_16x16x32_bf16 v[4:7], v[200:203], v[144:147], v[4:7]
    ds_read_b64_tr_b16 v[182:183], v224 offset:17408
    s_waitcnt lgkmcnt(12)
    v_mfma_f32_16x16x32_bf16 v[8:11], v[204:207], v[144:147], v[8:11]
    ds_read_b64_tr_b16 v[184:185], v225 offset:16384
    s_waitcnt lgkmcnt(10)
    v_mfma_f32_16x16x32_bf16 v[12:15], v[208:211], v[144:147], v[12:15]
    ds_read_b64_tr_b16 v[186:187], v225 offset:17408
    v_mfma_f32_16x16x32_bf16 v[16:19], v[196:199], v[148:151], v[16:19]
    ds_read_b128 v[144:147], v254
    v_mfma_f32_16x16x32_bf16 v[20:23], v[200:203], v[148:151], v[20:23]
    ds_read_b64_tr_b16 v[188:189], v226 offset:16384
    v_mfma_f32_16x16x32_bf16 v[24:27], v[204:207], v[148:151], v[24:27]
    ds_read_b64_tr_b16 v[190:191], v226 offset:17408
    v_mfma_f32_16x16x32_bf16 v[28:31], v[208:211], v[148:151], v[28:31]
    ds_read_b64_tr_b16 v[192:193], v227 offset:16384
    s_waitcnt lgkmcnt(14)
    v_mfma_f32_16x16x32_bf16 v[32:35], v[196:199], v[152:155], v[32:35]
    ds_read_b128 v[148:151], v254 offset:2048
    v_mfma_f32_16x16x32_bf16 v[36:39], v[200:203], v[152:155], v[36:39]
    ds_read_b64_tr_b16 v[194:195], v227 offset:17408
    v_mfma_f32_16x16x32_bf16 v[40:43], v[204:207], v[152:155], v[40:43]
    v_mfma_f32_16x16x32_bf16 v[44:47], v[208:211], v[152:155], v[44:47]
    s_waitcnt lgkmcnt(15)
    v_mfma_f32_16x16x32_bf16 v[48:51], v[196:199], v[156:159], v[48:51]
    ds_read_b128 v[152:155], v254 offset:4096
    v_mfma_f32_16x16x32_bf16 v[52:55], v[200:203], v[156:159], v[52:55]
    v_mfma_f32_16x16x32_bf16 v[56:59], v[204:207], v[156:159], v[56:59]
    v_mfma_f32_16x16x32_bf16 v[60:63], v[208:211], v[156:159], v[60:63]
    s_waitcnt lgkmcnt(15)
    v_mfma_f32_16x16x32_bf16 v[64:67], v[196:199], v[160:163], v[64:67]
    ds_read_b128 v[156:159], v254 offset:6144
    v_mfma_f32_16x16x32_bf16 v[68:71], v[200:203], v[160:163], v[68:71]
    v_mfma_f32_16x16x32_bf16 v[72:75], v[204:207], v[160:163], v[72:75]
    v_mfma_f32_16x16x32_bf16 v[76:79], v[208:211], v[160:163], v[76:79]
    s_waitcnt lgkmcnt(15)
    v_mfma_f32_16x16x32_bf16 v[80:83], v[196:199], v[164:167], v[80:83]
    ds_read_b128 v[160:163], v254 offset:8192
    v_mfma_f32_16x16x32_bf16 v[84:87], v[200:203], v[164:167], v[84:87]
    v_mfma_f32_16x16x32_bf16 v[88:91], v[204:207], v[164:167], v[88:91]
    v_mfma_f32_16x16x32_bf16 v[92:95], v[208:211], v[164:167], v[92:95]
    s_waitcnt lgkmcnt(15)
    v_mfma_f32_16x16x32_bf16 v[96:99], v[196:199], v[168:171], v[96:99]
    ds_read_b128 v[164:167], v254 offset:10240
    v_mfma_f32_16x16x32_bf16 v[100:103], v[200:203], v[168:171], v[100:103]
    v_mfma_f32_16x16x32_bf16 v[104:107], v[204:207], v[168:171], v[104:107]
    v_mfma_f32_16x16x32_bf16 v[108:111], v[208:211], v[168:171], v[108:111]
    s_waitcnt lgkmcnt(15)
    v_mfma_f32_16x16x32_bf16 v[112:115], v[196:199], v[172:175], v[112:115]
    ds_read_b128 v[168:171], v254 offset:12288
    v_mfma_f32_16x16x32_bf16 v[116:119], v[200:203], v[172:175], v[116:119]
    v_mfma_f32_16x16x32_bf16 v[120:123], v[204:207], v[172:175], v[120:123]
    v_mfma_f32_16x16x32_bf16 v[124:127], v[208:211], v[172:175], v[124:127]
    s_waitcnt lgkmcnt(15)
    v_mfma_f32_16x16x32_bf16 v[128:131], v[196:199], v[176:179], v[128:131]
    ds_read_b128 v[172:175], v254 offset:14336
    v_mfma_f32_16x16x32_bf16 v[132:135], v[200:203], v[176:179], v[132:135]
    v_mfma_f32_16x16x32_bf16 v[136:139], v[204:207], v[176:179], v[136:139]
    v_mfma_f32_16x16x32_bf16 v[140:143], v[208:211], v[176:179], v[140:143]
    ds_read_b128 v[176:179], v254 offset:16384
    s_add_u32 s42, s42, 2
    s_cmp_lt_u32 s42, 10
    s_cbranch_scc1 L_qp
    s_mov_b32 s7, 98304
    s_cmp_lt_u32 s3, 2
    s_cselect_b32 s4, 135168, s7
    s_cselect_b32 s5, 57344, s7
    s_and_b32 s6, s3, 1
    s_lshl_b32 s6, s6, 11
    s_add_u32 s4, s4, s6
    s_add_u32 s5, s5, s6
    v_add_u32 v224, s4, v246
    v_add_u32 v225, s5, v246
    s_waitcnt vmcnt(0) lgkmcnt(0)
    v_pk_mul_f32 v[0:1], v[0:1], s[40:41] op_sel_hi:[1,0]
    v_pk_mul_f32 v[2:3], v[2:3], s[40:41] op_sel_hi:[1,0]
    v_pk_mul_f32 v[4:5], v[4:5], s[40:41] op_sel_hi:[1,0]
    v_pk_mul_f32 v[6:7], v[6:7], s[40:41] op_sel_hi:[1,0]
    v_pk_mul_f32 v[8:9], v[8:9], s[40:41] op_sel_hi:[1,0]
    v_pk_mul_f32 v[10:11], v[10:11], s[40:41] op_sel_hi:[1,0]
    v_pk_mul_f32 v[12:13], v[12:13], s[40:41] op_sel_hi:[1,0]
    v_pk_mul_f32 v[14:15], v[14:15], s[40:41] op_sel_hi:[1,0]
    v_cvt_pk_bf16_f32 v144, v0, v1
    v_cvt_pk_bf16_f32 v145, v2, v3
    v_cvt_pk_bf16_f32 v146, v4, v5
    v_cvt_pk_bf16_f32 v147, v6, v7
    v_cvt_pk_bf16_f32 v148, v8, v9
    v_cvt_pk_bf16_f32 v149, v10, v11
    v_cvt_pk_bf16_f32 v150, v12, v13
    v_cvt_pk_bf16_f32 v151, v14, v15
    v_permlane32_swap_b32 v144, v146
    v_permlane32_swap_b32 v145, v147
    v_permlane32_swap_b32 v148, v150
    v_permlane32_swap_b32 v149, v151
    v_permlane16_swap_b32 v144, v146
    v_permlane16_swap_b32 v145, v147
    v_permlane16_swap_b32 v148, v150
    v_permlane16_swap_b32 v149, v151
    ds_write_b128 v224, v[144:147]
    ds_write_b128 v224, v[148:151] offset:1024
    v_pk_mul_f32 v[16:17], v[16:17], s[40:41] op_sel_hi:[1,0]
    v_pk_mul_f32 v[18:19], v[18:19], s[40:41] op_sel_hi:[1,0]
    v_pk_mul_f32 v[20:21], v[20:21], s[40:41] op_sel_hi:[1,0]
    v_pk_mul_f32 v[22:23], v[22:23], s[40:41] op_sel_hi:[1,0]
    v_pk_mul_f32 v[24:25], v[24:25], s[40:41] op_sel_hi:[1,0]
    v_pk_mul_f32 v[26:27], v[26:27], s[40:41] op_sel_hi:[1,0]
    v_pk_mul_f32 v[28:29], v[28:29], s[40:41] op_sel_hi:[1,0]
    v_pk_mul_f32 v[30:31], v[30:31], s[40:41] op_sel_hi:[1,0]
    v_cvt_pk_bf16_f32 v152, v16, v17
    v_cvt_pk_bf16_f32 v153, v18, v19
    v_cvt_pk_bf16_f32 v154, v20, v21
    v_cvt_pk_bf16_f32 v155, v22, v23
    v_cvt_pk_bf16_f32 v156, v24, v25
    v_cvt_pk_bf16_f32 v157, v26, v27
    v_cvt_pk_bf16_f32 v158, v28, v29
    v_cvt_pk_bf16_f32 v159, v30, v31
    v_permlane32_swap_b32 v152, v154
    v_permlane32_swap_b32 v153, v155
    v_permlane32_swap_b32 v156, v158
    v_permlane32_swap_b32 v157, v159
    v_permlane16_swap_b32 v152, v154
    v_permlane16_swap_b32 v153, v155
    v_permlane16_swap_b32 v156, v158
    v_permlane16_swap_b32 v157, v159
    ds_write_b128 v224, v[152:155] offset:4096
    ds_write_b128 v224, v[156:159] offset:5120
    v_pk_mul_f32 v[32:33], v[32:33], s[40:41] op_sel_hi:[1,0]
    v_pk_mul_f32 v[34:35], v[34:35], s[40:41] op_sel_hi:[1,0]
    v_pk_mul_f32 v[36:37], v[36:37], s[40:41] op_sel_hi:[1,0]
    v_pk_mul_f32 v[38:39], v[38:39], s[40:41] op_sel_hi:[1,0]
    v_pk_mul_f32 v[40:41], v[40:41], s[40:41] op_sel_hi:[1,0]
    v_pk_mul_f32 v[42:43], v[42:43], s[40:41] op_sel_hi:[1,0]
    v_pk_mul_f32 v[44:45], v[44:45], s[40:41] op_sel_hi:[1,0]
    v_pk_mul_f32 v[46:47], v[46:47], s[40:41] op_sel_hi:[1,0]
    v_cvt_pk_bf16_f32 v160, v32, v33
    v_cvt_pk_bf16_f32 v161, v34, v35
    v_cvt_pk_bf16_f32 v162, v36, v37
    v_cvt_pk_bf16_f32 v163, v38, v39
    v_cvt_pk_bf16_f32 v164, v40, v41
    v_cvt_pk_bf16_f32 v165, v42, v43
    v_cvt_pk_bf16_f32 v166, v44, v45
    v_cvt_pk_bf16_f32 v167, v46, v47
    v_permlane32_swap_b32 v160, v162
    v_permlane32_swap_b32 v161, v163
    v_permlane32_swap_b32 v164, v166
    v_permlane32_swap_b32 v165, v167
    v_permlane16_swap_b32 v160, v162
    v_permlane16_swap_b32 v161, v163
    v_permlane16_swap_b32 v164, v166
    v_permlane16_swap_b32 v165, v167
    ds_write_b128 v224, v[160:163] offset:8192
    ds_write_b128 v224, v[164:167] offset:9216
    v_pk_mul_f32 v[48:49], v[48:49], s[40:41] op_sel_hi:[1,0]
    v_pk_mul_f32 v[50:51], v[50:51], s[40:41] op_sel_hi:[1,0]
    v_pk_mul_f32 v[52:53], v[52:53], s[40:41] op_sel_hi:[1,0]
    v_pk_mul_f32 v[54:55], v[54:55], s[40:41] op_sel_hi:[1,0]
    v_pk_mul_f32 v[56:57], v[56:57], s[40:41] op_sel_hi:[1,0]
    v_pk_mul_f32 v[58:59], v[58:59], s[40:41] op_sel_hi:[1,0]
    v_pk_mul_f32 v[60:61], v[60:61], s[40:41] op_sel_hi:[1,0]
    v_pk_mul_f32 v[62:63], v[62:63], s[40:41] op_sel_hi:[1,0]
    v_cvt_pk_bf16_f32 v168, v48, v49
    v_cvt_pk_bf16_f32 v169, v50, v51
    v_cvt_pk_bf16_f32 v170, v52, v53
    v_cvt_pk_bf16_f32 v171, v54, v55
    v_cvt_pk_bf16_f32 v172, v56, v57
    v_cvt_pk_bf16_f32 v173, v58, v59
    v_cvt_pk_bf16_f32 v174, v60, v61
    v_cvt_pk_bf16_f32 v175, v62, v63
    v_permlane32_swap_b32 v168, v170
    v_permlane32_swap_b32 v169, v171
    v_permlane32_swap_b32 v172, v174
    v_permlane32_swap_b32 v173, v175
    v_permlane16_swap_b32 v168, v170
    v_permlane16_swap_b32 v169, v171
    v_permlane16_swap_b32 v172, v174
    v_permlane16_swap_b32 v173, v175
    ds_write_b128 v224, v[168:171] offset:12288
    ds_write_b128 v224, v[172:175] offset:13312
    v_pk_mul_f32 v[64:65], v[64:65], s[40:41] op_sel_hi:[1,0]
    v_pk_mul_f32 v[66:67], v[66:67], s[40:41] op_sel_hi:[1,0]
    v_pk_mul_f32 v[68:69], v[68:69], s[40:41] op_sel_hi:[1,0]
    v_pk_mul_f32 v[70:71], v[70:71], s[40:41] op_sel_hi:[1,0]
    v_pk_mul_f32 v[72:73], v[72:73], s[40:41] op_sel_hi:[1,0]
    v_pk_mul_f32 v[74:75], v[74:75], s[40:41] op_sel_hi:[1,0]
    v_pk_mul_f32 v[76:77], v[76:77], s[40:41] op_sel_hi:[1,0]
    v_pk_mul_f32 v[78:79], v[78:79], s[40:41] op_sel_hi:[1,0]
    v_cvt_pk_bf16_f32 v176, v64, v65
    v_cvt_pk_bf16_f32 v177, v66, v67
    v_cvt_pk_bf16_f32 v178, v68, v69
    v_cvt_pk_bf16_f32 v179, v70, v71
    v_cvt_pk_bf16_f32 v180, v72, v73
    v_cvt_pk_bf16_f32 v181, v74, v75
    v_cvt_pk_bf16_f32 v182, v76, v77
    v_cvt_pk_bf16_f32 v183, v78, v79
    v_permlane32_swap_b32 v176, v178
    v_permlane32_swap_b32 v177, v179
    v_permlane32_swap_b32 v180, v182
    v_permlane32_swap_b32 v181, v183
    v_permlane16_swap_b32 v176, v178
    v_permlane16_swap_b32 v177, v179
    v_permlane16_swap_b32 v180, v182
    v_permlane16_swap_b32 v181, v183
    ds_write_b128 v224, v[176:179] offset:16384
    ds_write_b128 v224, v[180:183] offset:17408
    v_pk_mul_f32 v[80:81], v[80:81], s[40:41] op_sel_hi:[1,0]
    v_pk_mul_f32 v[82:83], v[82:83], s[40:41] op_sel_hi:[1,0]
    v_pk_mul_f32 v[84:85], v[84:85], s[40:41] op_sel_hi:[1,0]
    v_pk_mul_f32 v[86:87], v[86:87], s[40:41] op_sel_hi:[1,0]
    v_pk_mul_f32 v[88:89], v[88:89], s[40:41] op_sel_hi:[1,0]
    v_pk_mul_f32 v[90:91], v[90:91], s[40:41] op_sel_hi:[1,0]
    v_pk_mul_f32 v[92:93], v[92:93], s[40:41] op_sel_hi:[1,0]
    v_pk_mul_f32 v[94:95], v[94:95], s[40:41] op_sel_hi:[1,0]
    v_cvt_pk_bf16_f32 v184, v80, v81
    v_cvt_pk_bf16_f32 v185, v82, v83
    v_cvt_pk_bf16_f32 v186, v84, v85
    v_cvt_pk_bf16_f32 v187, v86, v87
    v_cvt_pk_bf16_f32 v188, v88, v89
    v_cvt_pk_bf16_f32 v189, v90, v91
    v_cvt_pk_bf16_f32 v190, v92, v93
    v_cvt_pk_bf16_f32 v191, v94, v95
    v_permlane32_swap_b32 v184, v186
    v_permlane32_swap_b32 v185, v187
    v_permlane32_swap_b32 v188, v190
    v_permlane32_swap_b32 v189, v191
    v_permlane16_swap_b32 v184, v186
    v_permlane16_swap_b32 v185, v187
    v_permlane16_swap_b32 v188, v190
    v_permlane16_swap_b32 v189, v191
    ds_write_b128 v224, v[184:187] offset:20480
    ds_write_b128 v224, v[188:191] offset:21504
    v_pk_mul_f32 v[96:97], v[96:97], s[40:41] op_sel_hi:[1,0]
    v_pk_mul_f32 v[98:99], v[98:99], s[40:41] op_sel_hi:[1,0]
    v_pk_mul_f32 v[100:101], v[100:101], s[40:41] op_sel_hi:[1,0]
    v_pk_mul_f32 v[102:103], v[102:103], s[40:41] op_sel_hi:[1,0]
    v_pk_mul_f32 v[104:105], v[104:105], s[40:41] op_sel_hi:[1,0]
    v_pk_mul_f32 v[106:107], v[106:107], s[40:41] op_sel_hi:[1,0]
    v_pk_mul_f32 v[108:109], v[108:109], s[40:41] op_sel_hi:[1,0]
    v_pk_mul_f32 v[110:111], v[110:111], s[40:41] op_sel_hi:[1,0]
    v_cvt_pk_bf16_f32 v192, v96, v97
    v_cvt_pk_bf16_f32 v193, v98, v99
    v_cvt_pk_bf16_f32 v194, v100, v101
    v_cvt_pk_bf16_f32 v195, v102, v103
    v_cvt_pk_bf16_f32 v196, v104, v105
    v_cvt_pk_bf16_f32 v197, v106, v107
    v_cvt_pk_bf16_f32 v198, v108, v109
    v_cvt_pk_bf16_f32 v199, v110, v111
    v_permlane32_swap_b32 v192, v194
    v_permlane32_swap_b32 v193, v195
    v_permlane32_swap_b32 v196, v198
    v_permlane32_swap_b32 v197, v199
    v_permlane16_swap_b32 v192, v194
    v_permlane16_swap_b32 v193, v195
    v_permlane16_swap_b32 v196, v198
    v_permlane16_swap_b32 v197, v199
    ds_write_b128 v225, v[192:195] offset:24576
    ds_write_b128 v225, v[196:199] offset:25600
    v_pk_mul_f32 v[112:113], v[112:113], s[40:41] op_sel_hi:[1,0]
    v_pk_mul_f32 v[114:115], v[114:115], s[40:41] op_sel_hi:[1,0]
    v_pk_mul_f32 v[116:117], v[116:117], s[40:41] op_sel_hi:[1,0]
    v_pk_mul_f32 v[118:119], v[118:119], s[40:41] op_sel_hi:[1,0]
    v_pk_mul_f32 v[120:121], v[120:121], s[40:41] op_sel_hi:[1,0]
    v_pk_mul_f32 v[122:123], v[122:123], s[40:41] op_sel_hi:[1,0]
    v_pk_mul_f32 v[124:125], v[124:125], s[40:41] op_sel_hi:[1,0]
    v_pk_mul_f32 v[126:127], v[126:127], s[40:41] op_sel_hi:[1,0]
    v_cvt_pk_bf16_f32 v200, v112, v113
    v_cvt_pk_bf16_f32 v201, v114, v115
    v_cvt_pk_bf16_f32 v202, v116, v117
    v_cvt_pk_bf16_f32 v203, v118, v119
    v_cvt_pk_bf16_f32 v204, v120, v121
    v_cvt_pk_bf16_f32 v205, v122, v123
    v_cvt_pk_bf16_f32 v206, v124, v125
    v_cvt_pk_bf16_f32 v207, v126, v127
    v_permlane32_swap_b32 v200, v202
    v_permlane32_swap_b32 v201, v203
    v_permlane32_swap_b32 v204, v206
    v_permlane32_swap_b32 v205, v207
    v_permlane16_swap_b32 v200, v202
    v_permlane16_swap_b32 v201, v203
    v_permlane16_swap_b32 v204, v206
    v_permlane16_swap_b32 v205, v207
    ds_write_b128 v225, v[200:203] offset:28672
    ds_write_b128 v225, v[204:207] offset:29696
    v_pk_mul_f32 v[128:129], v[128:129], s[40:41] op_sel_hi:[1,0]
    v_pk_mul_f32 v[130:131], v[130:131], s[40:41] op_sel_hi:[1,0]
    v_pk_mul_f32 v[132:133], v[132:133], s[40:41] op_sel_hi:[1,0]
    v_pk_mul_f32 v[134:135], v[134:135], s[40:41] op_sel_hi:[1,0]
    v_pk_mul_f32 v[136:137], v[136:137], s[40:41] op_sel_hi:[1,0]
    v_pk_mul_f32 v[138:139], v[138:139], s[40:41] op_sel_hi:[1,0]
    v_pk_mul_f32 v[140:141], v[140:141], s[40:41] op_sel_hi:[1,0]
    v_pk_mul_f32 v[142:143], v[142:143], s[40:41] op_sel_hi:[1,0]
    v_cvt_pk_bf16_f32 v144, v128, v129
    v_cvt_pk_bf16_f32 v145, v130, v131
    v_cvt_pk_bf16_f32 v146, v132, v133
    v_cvt_pk_bf16_f32 v147, v134, v135
    v_cvt_pk_bf16_f32 v148, v136, v137
    v_cvt_pk_bf16_f32 v149, v138, v139
    v_cvt_pk_bf16_f32 v150, v140, v141
    v_cvt_pk_bf16_f32 v151, v142, v143
    v_permlane32_swap_b32 v144, v146
    v_permlane32_swap_b32 v145, v147
    v_permlane32_swap_b32 v148, v150
    v_permlane32_swap_b32 v149, v151
    v_permlane16_swap_b32 v144, v146
    v_permlane16_swap_b32 v145, v147
    v_permlane16_swap_b32 v148, v150
    v_permlane16_swap_b32 v149, v151
    ds_write_b128 v225, v[144:147] offset:32768
    ds_write_b128 v225, v[148:151] offset:33792
    v_mov_b32 v224, 0
    v_mov_b32 v225, 0
    v_mov_b32 v226, 0
    v_mov_b32 v227, 0
    v_mov_b32 v228, 0
    v_mov_b32 v229, 0
    v_mov_b32 v230, 0
    v_mov_b32 v231, 0
    s_waitcnt lgkmcnt(0)
    s_barrier
    ds_read_b128 v[128:131], v248
    ds_read_b128 v[132:135], v248 offset:1024
    ds_read_b128 v[136:139], v248 offset:2048
    ds_read_b128 v[140:143], v248 offset:3072
    ds_read_b128 v[144:147], v248 offset:4096
    ds_read_b128 v[148:151], v248 offset:5120
    ds_read_b128 v[152:155], v248 offset:6144
    ds_read_b128 v[156:159], v248 offset:7168
    ds_read_b128 v[160:163], v232
    ds_read_b128 v[164:167], v233
    ds_read_b128 v[168:171], v234
    ds_read_b128 v[172:175], v235
    ds_read_b128 v[176:179], v232 offset:4096
    ds_read_b128 v[180:183], v233 offset:4096
    ds_read_b128 v[184:187], v234 offset:4096
    ds_read_b128 v[188:191], v235 offset:4096
    ds_read_b128 v[192:195], v232 offset:8192
    ds_read_b128 v[196:199], v233 offset:8192
    ds_read_b128 v[200:203], v234 offset:8192
    ds_read_b128 v[204:207], v235 offset:8192
    ds_read_b128 v[208:211], v232 offset:12288
    ds_read_b128 v[212:215], v233 offset:12288
    ds_read_b128 v[216:219], v234 offset:12288
    ds_read_b128 v[220:223], v235 offset:12288
    v_add_u32 v232, 16384, v232
    v_add_u32 v233, 16384, v233
    v_add_u32 v234, 16384, v234
    v_add_u32 v235, 16384, v235
    s_waitcnt lgkmcnt(15)
    v_mfma_f32_16x16x32_bf16 v[64:67], v[160:163], v[128:131], v[224:227]
    v_mfma_f32_16x16x32_bf16 v[80:83], v[160:163], v[144:147], v[228:231]
    v_pk_mov_b32 v[0:1], 0, 0
    v_pk_mov_b32 v[2:3], 0, 0
    s_waitcnt lgkmcnt(14)
    v_mfma_f32_16x16x32_bf16 v[64:67], v[164:167], v[132:135], v[64:67]
    v_mfma_f32_16x16x32_bf16 v[80:83], v[164:167], v[148:151], v[80:83]
    v_pk_mov_b32 v[4:5], 0, 0
    v_pk_mov_b32 v[6:7], 0, 0
    s_waitcnt lgkmcnt(13)
    v_mfma_f32_16x16x32_bf16 v[64:67], v[168:171], v[136:139], v[64:67]
    v_mfma_f32_16x16x32_bf16 v[80:83], v[168:171], v[152:155], v[80:83]
    v_pk_mov_b32 v[8:9], 0, 0
    v_pk_mov_b32 v[10:11], 0, 0
    s_waitcnt lgkmcnt(12)
    v_mfma_f32_16x16x32_bf16 v[64:67], v[172:175], v[140:143], v[64:67]
    v_mfma_f32_16x16x32_bf16 v[80:83], v[172:175], v[156:159], v[80:83]
    v_pk_mov_b32 v[12:13], 0, 0
    v_pk_mov_b32 v[14:15], 0, 0
    s_waitcnt lgkmcnt(11)
    v_mfma_f32_16x16x32_bf16 v[68:71], v[176:179], v[128:131], v[224:227]
    v_mfma_f32_16x16x32_bf16 v[84:87], v[176:179], v[144:147], v[228:231]
    v_pk_mov_b32 v[16:17], 0, 0
    v_pk_mov_b32 v[18:19], 0, 0
    s_waitcnt lgkmcnt(10)
    v_mfma_f32_16x16x32_bf16 v[68:71], v[180:183], v[132:135], v[68:71]
    v_mfma_f32_16x16x32_bf16 v[84:87], v[180:183], v[148:151], v[84:87]
    v_pk_mov_b32 v[20:21], 0, 0
    v_pk_mov_b32 v[22:23], 0, 0
    s_waitcnt lgkmcnt(9)
    v_mfma_f32_16x16x32_bf16 v[68:71], v[184:187], v[136:139], v[68:71]
    v_mfma_f32_16x16x32_bf16 v[84:87], v[184:187], v[152:155], v[84:87]
    v_pk_mov_b32 v[24:25], 0, 0
    v_pk_mov_b32 v[26:27], 0, 0
    s_waitcnt lgkmcnt(8)
    v_mfma_f32_16x16x32_bf16 v[68:71], v[188:191], v[140:143], v[68:71]
    v_mfma_f32_16x16x32_bf16 v[84:87], v[188:191], v[156:159], v[84:87]
    v_pk_mov_b32 v[28:29], 0, 0
    v_pk_mov_b32 v[30:31], 0, 0
    s_waitcnt lgkmcnt(7)
    v_mfma_f32_16x16x32_bf16 v[72:75], v[192:195], v[128:131], v[224:227]
    v_mfma_f32_16x16x32_bf16 v[88:91], v[192:195], v[144:147], v[228:231]
    v_pk_mov_b32 v[32:33], 0, 0
    v_pk_mov_b32 v[34:35], 0, 0
    s_waitcnt lgkmcnt(6)
    v_mfma_f32_16x16x32_bf16 v[72:75], v[196:199], v[132:135], v[72:75]
    v_mfma_f32_16x16x32_bf16 v[88:91], v[196:199], v[148:151], v[88:91]
    v_pk_mov_b32 v[36:37], 0, 0
    v_pk_mov_b32 v[38:39], 0, 0
    s_waitcnt lgkmcnt(5)
    v_mfma_f32_16x16x32_bf16 v[72:75], v[200:203], v[136:139], v[72:75]
    v_mfma_f32_16x16x32_bf16 v[88:91], v[200:203], v[152:155], v[88:91]
    v_pk_mov_b32 v[40:41], 0, 0
    v_pk_mov_b32 v[42:43], 0, 0
    s_waitcnt lgkmcnt(4)
    v_mfma_f32_16x16x32_bf16 v[72:75], v[204:207], v[140:143], v[72:75]
    v_mfma_f32_16x16x32_bf16 v[88:91], v[204:207], v[156:159], v[88:91]
    v_pk_mov_b32 v[44:45], 0, 0
    v_pk_mov_b32 v[46:47], 0, 0
    s_waitcnt lgkmcnt(3)
    v_mfma_f32_16x16x32_bf16 v[76:79], v[208:211], v[128:131], v[224:227]
    v_mfma_f32_16x16x32_bf16 v[92:95], v[208:211], v[144:147], v[228:231]
    v_pk_mov_b32 v[48:49], 0, 0
    v_pk_mov_b32 v[50:51], 0, 0
    s_waitcnt lgkmcnt(2)
    v_mfma_f32_16x16x32_bf16 v[76:79], v[212:215], v[132:135], v[76:79]
    v_mfma_f32_16x16x32_bf16 v[92:95], v[212:215], v[148:151], v[92:95]
    v_pk_mov_b32 v[52:53], 0, 0
    v_pk_mov_b32 v[54:55], 0, 0
    s_waitcnt lgkmcnt(1)
    v_mfma_f32_16x16x32_bf16 v[76:79], v[216:219], v[136:139], v[76:79]
    v_mfma_f32_16x16x32_bf16 v[92:95], v[216:219], v[152:155], v[92:95]
    v_pk_mov_b32 v[56:57], 0, 0
    v_pk_mov_b32 v[58:59], 0, 0
    s_waitcnt lgkmcnt(0)
    v_mfma_f32_16x16x32_bf16 v[76:79], v[220:223], v[140:143], v[76:79]
    v_mfma_f32_16x16x32_bf16 v[92:95], v[220:223], v[156:159], v[92:95]
    v_pk_mov_b32 v[60:61], 0, 0
    v_pk_mov_b32 v[62:63], 0, 0
    s_mov_b32 s42, 0
    s_waitcnt lgkmcnt(0)
    s_barrier
    v_mov_b32 v252, 163824
    ds_read_b32 v253, v252
    s_and_b32 s4, s2, 7
    s_lshl_b32 s67, s4, 13
    s_add_u32 s67, s67, 58720256
    s_waitcnt lgkmcnt(0)
    v_readfirstlane_b32 s62, v253
    ds_read_b128 v[160:163], v232
    ds_read_b128 v[164:167], v233
    ds_read_b128 v[168:171], v234
    ds_read_b128 v[172:175], v235
    ds_read_b128 v[176:179], v232 offset:4096
    ds_read_b128 v[180:183], v233 offset:4096
    ds_read_b128 v[184:187], v234 offset:4096
    ds_read_b128 v[188:191], v235 offset:4096
    ds_read_b128 v[192:195], v232 offset:8192
    ds_read_b128 v[196:199], v233 offset:8192
    ds_read_b128 v[200:203], v234 offset:8192
    ds_read_b128 v[204:207], v235 offset:8192
    ds_read_b128 v[208:211], v232 offset:12288
    ds_read_b128 v[212:215], v233 offset:12288
    ds_read_b128 v[216:219], v234 offset:12288
    ds_read_b128 v[220:223], v235 offset:12288
    v_max3_f32 v248, v64, v65, v66
    v_max3_f32 v248, v248, v67, v68
    v_max3_f32 v248, v248, v69, v70
    v_max3_f32 v248, v248, v71, v72
    v_max3_f32 v250, v80, v81, v82
    v_max3_f32 v250, v250, v83, v84
    v_max3_f32 v250, v250, v85, v86
    v_max3_f32 v250, v250, v87, v88
    v_max3_f32 v248, v248, v73, v74
    v_max3_f32 v248, v248, v75, v76
    v_max3_f32 v248, v248, v77, v78
    v_max_f32 v248, v248, v79
    v_max3_f32 v250, v250, v89, v90
    v_max3_f32 v250, v250, v91, v92
    v_max3_f32 v250, v250, v93, v94
    v_max_f32 v250, v250, v95
    v_max_f32 v249, v248, v250
    v_mov_b32 v249, v248
    s_nop 1
    v_permlane16_swap_b32 v248, v249
    v_max_f32 v248, v248, v249
    v_mov_b32 v249, v248
    s_nop 1
    v_permlane32_swap_b32 v248, v249
    v_max_f32 v248, v248, v249
    v_sub_f32 v64, v64, v248
    v_sub_f32 v65, v65, v248
    v_sub_f32 v66, v66, v248
    v_sub_f32 v67, v67, v248
    v_sub_f32 v68, v68, v248
    v_sub_f32 v69, v69, v248
    v_sub_f32 v70, v70, v248
    v_sub_f32 v71, v71, v248
    v_sub_f32 v72, v72, v248
    v_sub_f32 v73, v73, v248
    v_sub_f32 v74, v74, v248
    v_sub_f32 v75, v75, v248
    v_sub_f32 v76, v76, v248
    v_sub_f32 v77, v77, v248
    v_sub_f32 v78, v78, v248
    v_sub_f32 v79, v79, v248
    v_sub_f32 v224, v224, v248
    v_sub_f32 v225, v225, v248
    v_sub_f32 v226, v226, v248
    v_sub_f32 v227, v227, v248
    v_mov_b32 v251, v250
    s_nop 1
    v_permlane16_swap_b32 v250, v251
    v_max_f32 v250, v250, v251
    v_mov_b32 v251, v250
    s_nop 1
    v_permlane32_swap_b32 v250, v251
    v_max_f32 v250, v250, v251
    v_sub_f32 v80, v80, v250
    v_sub_f32 v81, v81, v250
    v_sub_f32 v82, v82, v250
    v_sub_f32 v83, v83, v250
    v_sub_f32 v84, v84, v250
    v_sub_f32 v85, v85, v250
    v_sub_f32 v86, v86, v250
    v_sub_f32 v87, v87, v250
    v_sub_f32 v88, v88, v250
    v_sub_f32 v89, v89, v250
    v_sub_f32 v90, v90, v250
    v_sub_f32 v91, v91, v250
    v_sub_f32 v92, v92, v250
    v_sub_f32 v93, v93, v250
    v_sub_f32 v94, v94, v250
    v_sub_f32 v95, v95, v250
    v_sub_f32 v228, v228, v250
    v_sub_f32 v229, v229, v250
    v_sub_f32 v230, v230, v250
    v_sub_f32 v231, v231, v250
    s_nop 1
.p2align 3
L_loop_a2:
    s_add_u32 s45, s45, 1
    s_cmp_eq_u32 s45, 3
    s_cselect_b32 s43, -32768, s75
    s_cselect_b32 s45, 0, s45
    s_add_u32 s46, s46, 1
    s_cmp_eq_u32 s46, 3
    s_cselect_b32 s44, -32768, s75
    s_cselect_b32 s46, 0, s46
    s_waitcnt lgkmcnt(15)
    v_mfma_f32_16x16x32_bf16 v[96:99], v[160:163], v[128:131], v[224:227]
    v_exp_f32 v64, v64
    v_exp_f32 v65, v65
    v_mfma_f32_16x16x32_bf16 v[112:115], v[160:163], v[144:147], v[228:231]
    ds_read_b64_tr_b16 v[160:161], v236
    ds_read_b64_tr_b16 v[162:163], v236 offset:4096
    v_add_f32 v244, v244, v64
    s_waitcnt lgkmcnt(15)
    v_mfma_f32_16x16x32_bf16 v[96:99], v[164:167], v[132:135], v[96:99]
    v_exp_f32 v66, v66
    v_add_f32 v244, v244, v65
    v_mfma_f32_16x16x32_bf16 v[112:115], v[164:167], v[148:151], v[112:115]
    ds_read_b64_tr_b16 v[164:165], v237
    ds_read_b64_tr_b16 v[166:167], v237 offset:4096
    v_exp_f32 v67, v67
    v_mfma_f32_16x16x32_bf16 v[96:99], v[168:171], v[136:139], v[96:99]
    v_cvt_pk_bf16_f32 v64, v64, v65
    v_add_f32 v244, v244, v66
    v_mfma_f32_16x16x32_bf16 v[112:115], v[168:171], v[152:155], v[112:115]
    ds_read_b64_tr_b16 v[168:169], v238
    ds_read_b64_tr_b16 v[170:171], v238 offset:4096
    v_exp_f32 v68, v68
    s_waitcnt lgkmcnt(15)
    v_mfma_f32_16x16x32_bf16 v[96:99], v[172:175], v[140:143], v[96:99]
    v_add_f32 v244, v244, v67
    v_exp_f32 v69, v69
    v_mfma_f32_16x16x32_bf16 v[112:115], v[172:175], v[156:159], v[112:115]
    ds_read_b64_tr_b16 v[172:173], v239
    ds_read_b64_tr_b16 v[174:175], v239 offset:4096
    v_mfma_f32_16x16x32_bf16 v[100:103], v[176:179], v[128:131], v[224:227]
    v_cvt_pk_bf16_f32 v65, v66, v67
    v_add_f32 v244, v244, v68
    v_exp_f32 v70, v70
    v_mfma_f32_16x16x32_bf16 v[116:119], v[176:179], v[144:147], v[228:231]
    ds_read_b64_tr_b16 v[176:177], v240
    ds_read_b64_tr_b16 v[178:179], v240 offset:4096
    v_mfma_f32_16x16x32_bf16 v[100:103], v[180:183], v[132:135], v[100:103]
    v_add_f32 v244, v244, v69
    v_exp_f32 v71, v71
    v_mfma_f32_16x16x32_bf16 v[116:119], v[180:183], v[148:151], v[116:119]
    ds_read_b64_tr_b16 v[180:181], v241
    ds_read_b64_tr_b16 v[182:183], v241 offset:4096
    v_cvt_pk_bf16_f32 v66, v68, v69
    v_mfma_f32_16x16x32_bf16 v[100:103], v[184:187], v[136:139], v[100:103]
    v_add_f32 v244, v244, v70
    v_add_f32 v244, v244, v71
    v_cvt_pk_bf16_f32 v67, v70, v71
    v_mfma_f32_16x16x32_bf16 v[116:119], v[184:187], v[152:155], v[116:119]
    ds_read_b64_tr_b16 v[184:185], v242
    ds_read_b64_tr_b16 v[186:187], v242 offset:4096
    v_exp_f32 v80, v80
    s_waitcnt lgkmcnt(15)
    v_mfma_f32_16x16x32_bf16 v[100:103], v[188:191], v[140:143], v[100:103]
    v_exp_f32 v81, v81
    v_mfma_f32_16x16x32_bf16 v[116:119], v[188:191], v[156:159], v[116:119]
    ds_read_b64_tr_b16 v[188:189], v243
    ds_read_b64_tr_b16 v[190:191], v243 offset:4096
    v_add_f32 v245, v245, v80
    v_exp_f32 v82, v82
    v_mfma_f32_16x16x32_bf16 v[104:107], v[192:195], v[128:131], v[224:227]
    v_add_f32 v245, v245, v81
    v_exp_f32 v83, v83
    v_mfma_f32_16x16x32_bf16 v[120:123], v[192:195], v[144:147], v[228:231]
    ds_read_b64_tr_b16 v[192:193], v236 offset:8192
    ds_read_b64_tr_b16 v[194:195], v236 offset:12288
    v_mfma_f32_16x16x32_bf16 v[104:107], v[196:199], v[132:135], v[104:107]
    v_cvt_pk_bf16_f32 v80, v80, v81
    v_add_f32 v245, v245, v82
    v_exp_f32 v84, v84
    v_mfma_f32_16x16x32_bf16 v[120:123], v[196:199], v[148:151], v[120:123]
    ds_read_b64_tr_b16 v[196:197], v237 offset:8192
    ds_read_b64_tr_b16 v[198:199], v237 offset:12288
    v_mfma_f32_16x16x32_bf16 v[104:107], v[200:203], v[136:139], v[104:107]
    v_add_f32 v245, v245, v83
    v_exp_f32 v85, v85
    v_mfma_f32_16x16x32_bf16 v[120:123], v[200:203], v[152:155], v[120:123]
    ds_read_b64_tr_b16 v[200:201], v238 offset:8192
    ds_read_b64_tr_b16 v[202:203], v238 offset:12288
    v_cvt_pk_bf16_f32 v81, v82, v83
    v_mfma_f32_16x16x32_bf16 v[104:107], v[204:207], v[140:143], v[104:107]
    v_add_f32 v245, v245, v84
    v_exp_f32 v86, v86
    v_mfma_f32_16x16x32_bf16 v[120:123], v[204:207], v[156:159], v[120:123]
    ds_read_b64_tr_b16 v[204:205], v239 offset:8192
    ds_read_b64_tr_b16 v[206:207], v239 offset:12288
    v_add_f32 v245, v245, v85
    v_mfma_f32_16x16x32_bf16 v[108:111], v[208:211], v[128:131], v[224:227]
    v_exp_f32 v87, v87
    v_cvt_pk_bf16_f32 v82, v84, v85
    v_mfma_f32_16x16x32_bf16 v[124:127], v[208:211], v[144:147], v[228:231]
    ds_read_b64_tr_b16 v[208:209], v240 offset:8192
    ds_read_b64_tr_b16 v[210:211], v240 offset:12288
    v_add_f32 v245, v245, v86
    v_mfma_f32_16x16x32_bf16 v[108:111], v[212:215], v[132:135], v[108:111]
    v_add_f32 v245, v245, v87
    v_cvt_pk_bf16_f32 v83, v86, v87
    v_add_u32 v232, s43, v232
    v_mfma_f32_16x16x32_bf16 v[124:127], v[212:215], v[148:151], v[124:127]
    ds_read_b64_tr_b16 v[212:213], v241 offset:8192
    ds_read_b64_tr_b16 v[214:215], v241 offset:12288
    v_add_u32 v233, s43, v233
    v_mfma_f32_16x16x32_bf16 v[108:111], v[216:219], v[136:139], v[108:111]
    v_add_u32 v234, s43, v234
    v_add_u32 v235, s43, v235
    v_exp_f32 v72, v72
    v_mfma_f32_16x16x32_bf16 v[124:127], v[216:219], v[152:155], v[124:127]
    ds_read_b64_tr_b16 v[216:217], v242 offset:8192
    ds_read_b64_tr_b16 v[218:219], v242 offset:12288
    s_waitcnt lgkmcnt(15)
    v_mfma_f32_16x16x32_bf16 v[108:111], v[220:223], v[140:143], v[108:111]
    v_exp_f32 v73, v73
    v_add_f32 v244, v244, v72
    v_mfma_f32_16x16x32_bf16 v[124:127], v[220:223], v[156:159], v[124:127]
    ds_read_b64_tr_b16 v[220:221], v243 offset:8192
    ds_read_b64_tr_b16 v[222:223], v243 offset:12288
    v_exp_f32 v74, v74
    s_cmp_eq_u32 s42, 7
    s_cbranch_scc1 L_q2_a2
L_q2b_a2:
    v_mfma_f32_16x16x32_bf16 v[0:3], v[160:163], v[64:67], v[0:3]
    v_add_f32 v244, v244, v73
    v_exp_f32 v75, v75
    v_mfma_f32_16x16x32_bf16 v[32:35], v[160:163], v[80:83], v[32:35]
    v_cvt_pk_bf16_f32 v72, v72, v73
    v_add_f32 v244, v244, v74
    v_exp_f32 v76, v76
    v_mfma_f32_16x16x32_bf16 v[4:7], v[164:167], v[64:67], v[4:7]
    v_add_f32 v244, v244, v75
    v_exp_f32 v77, v77
    v_mfma_f32_16x16x32_bf16 v[36:39], v[164:167], v[80:83], v[36:39]
    v_cvt_pk_bf16_f32 v73, v74, v75
    v_add_f32 v244, v244, v76
    v_mfma_f32_16x16x32_bf16 v[8:11], v[168:171], v[64:67], v[8:11]
    v_exp_f32 v78, v78
    v_add_f32 v244, v244, v77
    v_mfma_f32_16x16x32_bf16 v[40:43], v[168:171], v[80:83], v[40:43]
    v_exp_f32 v79, v79
    v_cvt_pk_bf16_f32 v74, v76, v77
    v_mfma_f32_16x16x32_bf16 v[12:15], v[172:175], v[64:67], v[12:15]
    v_add_f32 v244, v244, v78
    v_add_f32 v244, v244, v79
    v_cvt_pk_bf16_f32 v75, v78, v79
    v_mfma_f32_16x16x32_bf16 v[44:47], v[172:175], v[80:83], v[44:47]
    v_exp_f32 v88, v88
    v_exp_f32 v89, v89
    v_mfma_f32_16x16x32_bf16 v[16:19], v[176:179], v[64:67], v[16:19]
    s_waitcnt lgkmcnt(0)
    s_barrier
    ds_read_b128 v[160:163], v232
    v_mfma_f32_16x16x32_bf16 v[48:51], v[176:179], v[80:83], v[48:51]
    ds_read_b128 v[164:167], v233
    ds_read_b128 v[168:171], v234
    ds_read_b128 v[172:175], v235
    v_mfma_f32_16x16x32_bf16 v[20:23], v[180:183], v[64:67], v[20:23]
    ds_read_b128 v[176:179], v232 offset:4096
    v_add_f32 v245, v245, v88
    v_exp_f32 v90, v90
    v_mfma_f32_16x16x32_bf16 v[52:55], v[180:183], v[80:83], v[52:55]
    ds_read_b128 v[180:183], v233 offset:4096
    v_add_f32 v245, v245, v89
    v_mfma_f32_16x16x32_bf16 v[24:27], v[184:187], v[64:67], v[24:27]
    v_exp_f32 v91, v91
    v_cvt_pk_bf16_f32 v88, v88, v89
    v_mfma_f32_16x16x32_bf16 v[56:59], v[184:187], v[80:83], v[56:59]
    v_add_f32 v245, v245, v90
    v_exp_f32 v92, v92
    v_mfma_f32_16x16x32_bf16 v[28:31], v[188:191], v[64:67], v[28:31]
    v_add_f32 v245, v245, v91
    v_exp_f32 v93, v93
    v_cvt_pk_bf16_f32 v89, v90, v91
    v_mfma_f32_16x16x32_bf16 v[60:63], v[188:191], v[80:83], v[60:63]
    v_add_f32 v245, v245, v92
    v_exp_f32 v94, v94
    v_add_f32 v245, v245, v93
    v_exp_f32 v95, v95
    v_cvt_pk_bf16_f32 v90, v92, v93
    v_add_f32 v245, v245, v94
    v_add_f32 v245, v245, v95
    v_cvt_pk_bf16_f32 v91, v94, v95
    v_mfma_f32_16x16x32_bf16 v[0:3], v[192:195], v[72:75], v[0:3]
    ds_read_b128 v[184:187], v234 offset:4096
    v_mfma_f32_16x16x32_bf16 v[32:35], v[192:195], v[88:91], v[32:35]
    v_mfma_f32_16x16x32_bf16 v[4:7], v[196:199], v[72:75], v[4:7]
    ds_read_b128 v[188:191], v235 offset:4096
    v_mfma_f32_16x16x32_bf16 v[36:39], v[196:199], v[88:91], v[36:39]
    ds_read_b128 v[192:195], v232 offset:8192
    ds_read_b128 v[196:199], v233 offset:8192
    v_max3_f32 v248, v96, v97, v98
    v_mfma_f32_16x16x32_bf16 v[8:11], v[200:203], v[72:75], v[8:11]
    v_max3_f32 v248, v248, v99, v100
    v_max3_f32 v248, v248, v101, v102
    v_max3_f32 v248, v248, v103, v104
    v_mfma_f32_16x16x32_bf16 v[40:43], v[200:203], v[88:91], v[40:43]
    ds_read_b128 v[200:203], v234 offset:8192
    v_max3_f32 v250, v112, v113, v114
    v_max3_f32 v250, v250, v115, v116
    v_mfma_f32_16x16x32_bf16 v[12:15], v[204:207], v[72:75], v[12:15]
    v_max3_f32 v250, v250, v117, v118
    v_max3_f32 v250, v250, v119, v120
    v_max3_f32 v248, v248, v105, v106
    v_mfma_f32_16x16x32_bf16 v[44:47], v[204:207], v[88:91], v[44:47]
    ds_read_b128 v[204:207], v235 offset:8192
    v_max3_f32 v248, v248, v107, v108
    v_max3_f32 v248, v248, v109, v110
    v_mfma_f32_16x16x32_bf16 v[16:19], v[208:211], v[72:75], v[16:19]
    v_max_f32 v248, v248, v111
    v_max3_f32 v250, v250, v121, v122
    v_max3_f32 v250, v250, v123, v124
    v_mfma_f32_16x16x32_bf16 v[48:51], v[208:211], v[88:91], v[48:51]
    ds_read_b128 v[208:211], v232 offset:12288
    v_max3_f32 v250, v250, v125, v126
    v_max_f32 v250, v250, v127
    v_mfma_f32_16x16x32_bf16 v[20:23], v[212:215], v[72:75], v[20:23]
    v_max_f32 v249, v248, v250
    v_add_u32 v236, s44, v236
    v_add_u32 v237, s44, v237
    v_mfma_f32_16x16x32_bf16 v[52:55], v[212:215], v[88:91], v[52:55]
    ds_read_b128 v[212:215], v233 offset:12288
    v_add_u32 v238, s44, v238
    v_add_u32 v239, s44, v239
    v_mfma_f32_16x16x32_bf16 v[24:27], v[216:219], v[72:75], v[24:27]
    v_add_u32 v240, s44, v240
    v_add_u32 v241, s44, v241
    v_add_u32 v242, s44, v242
    v_mfma_f32_16x16x32_bf16 v[56:59], v[216:219], v[88:91], v[56:59]
    ds_read_b128 v[216:219], v234 offset:12288
    v_add_u32 v243, s44, v243
    v_mfma_f32_16x16x32_bf16 v[28:31], v[220:223], v[72:75], v[28:31]
    v_mfma_f32_16x16x32_bf16 v[60:63], v[220:223], v[88:91], v[60:63]
    ds_read_b128 v[220:223], v235 offset:12288
L_ja_a2:
    v_cmp_lt_f32 vcc, s41, v249
    s_nop 0
    s_cbranch_vccnz L_rare_a2a
L_back_a2a:
    s_add_u32 s45, s45, 1
    s_cmp_eq_u32 s45, 3
    s_cselect_b32 s43, -32768, s75
    s_cselect_b32 s45, 0, s45
    s_add_u32 s46, s46, 1
    s_cmp_eq_u32 s46, 3
    s_cselect_b32 s44, -32768, s75
    s_cselect_b32 s46, 0, s46
    s_waitcnt lgkmcnt(15)
    v_mfma_f32_16x16x32_bf16 v[64:67], v[160:163], v[128:131], v[224:227]
    v_exp_f32 v96, v96
    v_exp_f32 v97, v97
    v_mfma_f32_16x16x32_bf16 v[80:83], v[160:163], v[144:147], v[228:231]
    ds_read_b64_tr_b16 v[160:161], v236
    ds_read_b64_tr_b16 v[162:163], v236 offset:4096
    v_add_f32 v244, v244, v96
    s_waitcnt lgkmcnt(15)
    v_mfma_f32_16x16x32_bf16 v[64:67], v[164:167], v[132:135], v[64:67]
    v_exp_f32 v98, v98
    v_add_f32 v244, v244, v97
    v_mfma_f32_16x16x32_bf16 v[80:83], v[164:167], v[148:151], v[80:83]
    ds_read_b64_tr_b16 v[164:165], v237
    ds_read_b64_tr_b16 v[166:167], v237 offset:4096
    v_exp_f32 v99, v99
    v_mfma_f32_16x16x32_bf16 v[64:67], v[168:171], v[136:139], v[64:67]
    v_cvt_pk_bf16_f32 v96, v96, v97
    v_add_f32 v244, v244, v98
    v_mfma_f32_16x16x32_bf16 v[80:83], v[168:171], v[152:155], v[80:83]
    ds_read_b64_tr_b16 v[168:169], v238
    ds_read_b64_tr_b16 v[170:171], v238 offset:4096
    v_exp_f32 v100, v100
    s_waitcnt lgkmcnt(15)
    v_mfma_f32_16x16x32_bf16 v[64:67], v[172:175], v[140:143], v[64:67]
    v_add_f32 v244, v244, v99
    v_exp_f32 v101, v101
    v_mfma_f32_16x16x32_bf16 v[80:83], v[172:175], v[156:159], v[80:83]
    ds_read_b64_tr_b16 v[172:173], v239
    ds_read_b64_tr_b16 v[174:175], v239 offset:4096
    v_mfma_f32_16x16x32_bf16 v[68:71], v[176:179], v[128:131], v[224:227]
    v_cvt_pk_bf16_f32 v97, v98, v99
    v_add_f32 v244, v244, v100
    v_exp_f32 v102, v102
    v_mfma_f32_16x16x32_bf16 v[84:87], v[176:179], v[144:147], v[228:231]
    ds_read_b64_tr_b16 v[176:177], v240
    ds_read_b64_tr_b16 v[178:179], v240 offset:4096
    v_mfma_f32_16x16x32_bf16 v[68:71], v[180:183], v[132:135], v[68:71]
    v_add_f32 v244, v244, v101
    v_exp_f32 v103, v103
    v_mfma_f32_16x16x32_bf16 v[84:87], v[180:183], v[148:151], v[84:87]
    ds_read_b64_tr_b16 v[180:181], v241
    ds_read_b64_tr_b16 v[182:183], v241 offset:4096
    v_cvt_pk_bf16_f32 v98, v100, v101
    v_mfma_f32_16x16x32_bf16 v[68:71], v[184:187], v[136:139], v[68:71]
    v_add_f32 v244, v244, v102
    v_add_f32 v244, v244, v103
    v_cvt_pk_bf16_f32 v99, v102, v103
    v_mfma_f32_16x16x32_bf16 v[84:87], v[184:187], v[152:155], v[84:87]
    ds_read_b64_tr_b16 v[184:185], v242
    ds_read_b64_tr_b16 v[186:187], v242 offset:4096
    v_exp_f32 v112, v112
    s_waitcnt lgkmcnt(15)
    v_mfma_f32_16x16x32_bf16 v[68:71], v[188:191], v[140:143], v[68:71]
    v_exp_f32 v113, v113
    v_mfma_f32_16x16x32_bf16 v[84:87], v[188:191], v[156:159], v[84:87]
    ds_read_b64_tr_b16 v[188:189], v243
    ds_read_b64_tr_b16 v[190:191], v243 offset:4096
    v_add_f32 v245, v245, v112
    v_exp_f32 v114, v114
    v_mfma_f32_16x16x32_bf16 v[72:75], v[192:195], v[128:131], v[224:227]
    v_add_f32 v245, v245, v113
    v_exp_f32 v115, v115
    v_mfma_f32_16x16x32_bf16 v[88:91], v[192:195], v[144:147], v[228:231]
    ds_read_b64_tr_b16 v[192:193], v236 offset:8192
    ds_read_b64_tr_b16 v[194:195], v236 offset:12288
    v_mfma_f32_16x16x32_bf16 v[72:75], v[196:199], v[132:135], v[72:75]
    v_cvt_pk_bf16_f32 v112, v112, v113
    v_add_f32 v245, v245, v114
    v_exp_f32 v116, v116
    v_mfma_f32_16x16x32_bf16 v[88:91], v[196:199], v[148:151], v[88:91]
    ds_read_b64_tr_b16 v[196:197], v237 offset:8192
    ds_read_b64_tr_b16 v[198:199], v237 offset:12288
    v_mfma_f32_16x16x32_bf16 v[72:75], v[200:203], v[136:139], v[72:75]
    v_add_f32 v245, v245, v115
    v_exp_f32 v117, v117
    v_mfma_f32_16x16x32_bf16 v[88:91], v[200:203], v[152:155], v[88:91]
    ds_read_b64_tr_b16 v[200:201], v238 offset:8192
    ds_read_b64_tr_b16 v[202:203], v238 offset:12288
    v_cvt_pk_bf16_f32 v113, v114, v115
    v_mfma_f32_16x16x32_bf16 v[72:75], v[204:207], v[140:143], v[72:75]
    v_add_f32 v245, v245, v116
    v_exp_f32 v118, v118
    v_mfma_f32_16x16x32_bf16 v[88:91], v[204:207], v[156:159], v[88:91]
    ds_read_b64_tr_b16 v[204:205], v239 offset:8192
    ds_read_b64_tr_b16 v[206:207], v239 offset:12288
    v_add_f32 v245, v245, v117
    v_mfma_f32_16x16x32_bf16 v[76:79], v[208:211], v[128:131], v[224:227]
    v_exp_f32 v119, v119
    v_cvt_pk_bf16_f32 v114, v116, v117
    v_mfma_f32_16x16x32_bf16 v[92:95], v[208:211], v[144:147], v[228:231]
    ds_read_b64_tr_b16 v[208:209], v240 offset:8192
    ds_read_b64_tr_b16 v[210:211], v240 offset:12288
    v_add_f32 v245, v245, v118
    v_mfma_f32_16x16x32_bf16 v[76:79], v[212:215], v[132:135], v[76:79]
    v_add_f32 v245, v245, v119
    v_cvt_pk_bf16_f32 v115, v118, v119
    v_add_u32 v232, s43, v232
    v_mfma_f32_16x16x32_bf16 v[92:95], v[212:215], v[148:151], v[92:95]
    ds_read_b64_tr_b16 v[212:213], v241 offset:8192
    ds_read_b64_tr_b16 v[214:215], v241 offset:12288
    v_add_u32 v233, s43, v233
    v_mfma_f32_16x16x32_bf16 v[76:79], v[216:219], v[136:139], v[76:79]
    v_add_u32 v234, s43, v234
    v_add_u32 v235, s43, v235
    v_exp_f32 v104, v104
    v_mfma_f32_16x16x32_bf16 v[92:95], v[216:219], v[152:155], v[92:95]
    ds_read_b64_tr_b16 v[216:217], v242 offset:8192
    ds_read_b64_tr_b16 v[218:219], v242 offset:12288
    s_waitcnt lgkmcnt(15)
    v_mfma_f32_16x16x32_bf16 v[76:79], v[220:223], v[140:143], v[76:79]
    v_exp_f32 v105, v105
    v_add_f32 v244, v244, v104
    v_mfma_f32_16x16x32_bf16 v[92:95], v[220:223], v[156:159], v[92:95]
    ds_read_b64_tr_b16 v[220:221], v243 offset:8192
    ds_read_b64_tr_b16 v[222:223], v243 offset:12288
    v_exp_f32 v106, v106
    v_mfma_f32_16x16x32_bf16 v[0:3], v[160:163], v[96:99], v[0:3]
    v_add_f32 v244, v244, v105
    v_exp_f32 v107, v107
    v_mfma_f32_16x16x32_bf16 v[32:35], v[160:163], v[112:115], v[32:35]
    v_cvt_pk_bf16_f32 v104, v104, v105
    v_add_f32 v244, v244, v106
    v_exp_f32 v108, v108
    v_mfma_f32_16x16x32_bf16 v[4:7], v[164:167], v[96:99], v[4:7]
    v_add_f32 v244, v244, v107
    v_exp_f32 v109, v109
    v_mfma_f32_16x16x32_bf16 v[36:39], v[164:167], v[112:115], v[36:39]
    v_cvt_pk_bf16_f32 v105, v106, v107
    v_add_f32 v244, v244, v108
    v_mfma_f32_16x16x32_bf16 v[8:11], v[168:171], v[96:99], v[8:11]
    v_exp_f32 v110, v110
    v_add_f32 v244, v244, v109
    v_mfma_f32_16x16x32_bf16 v[40:43], v[168:171], v[112:115], v[40:43]
    v_exp_f32 v111, v111
    v_cvt_pk_bf16_f32 v106, v108, v109
    v_mfma_f32_16x16x32_bf16 v[12:15], v[172:175], v[96:99], v[12:15]
    v_add_f32 v244, v244, v110
    v_add_f32 v244, v244, v111
    v_cvt_pk_bf16_f32 v107, v110, v111
    v_mfma_f32_16x16x32_bf16 v[44:47], v[172:175], v[112:115], v[44:47]
    v_exp_f32 v120, v120
    v_exp_f32 v121, v121
    v_mfma_f32_16x16x32_bf16 v[16:19], v[176:179], v[96:99], v[16:19]
    s_waitcnt vmcnt(0) lgkmcnt(0)
    s_barrier
    ds_read_b128 v[160:163], v232
    v_mfma_f32_16x16x32_bf16 v[48:51], v[176:179], v[112:115], v[48:51]
    ds_read_b128 v[164:167], v233
    ds_read_b128 v[168:171], v234
    ds_read_b128 v[172:175], v235
    v_mfma_f32_16x16x32_bf16 v[20:23], v[180:183], v[96:99], v[20:23]
    ds_read_b128 v[176:179], v232 offset:4096
    v_add_f32 v245, v245, v120
    v_exp_f32 v122, v122
    v_mfma_f32_16x16x32_bf16 v[52:55], v[180:183], v[112:115], v[52:55]
    ds_read_b128 v[180:183], v233 offset:4096
    v_add_f32 v245, v245, v121
    v_mfma_f32_16x16x32_bf16 v[24:27], v[184:187], v[96:99], v[24:27]
    v_exp_f32 v123, v123
    v_cvt_pk_bf16_f32 v120, v120, v121
    v_mfma_f32_16x16x32_bf16 v[56:59], v[184:187], v[112:115], v[56:59]
    v_add_f32 v245, v245, v122
    v_exp_f32 v124, v124
    v_mfma_f32_16x16x32_bf16 v[28:31], v[188:191], v[96:99], v[28:31]
    v_add_f32 v245, v245, v123
    v_exp_f32 v125, v125
    v_cvt_pk_bf16_f32 v121, v122, v123
    v_mfma_f32_16x16x32_bf16 v[60:63], v[188:191], v[112:115], v[60:63]
    v_add_f32 v245, v245, v124
    v_exp_f32 v126, v126
    v_add_f32 v245, v245, v125
    v_exp_f32 v127, v127
    v_cvt_pk_bf16_f32 v122, v124, v125
    v_add_f32 v245, v245, v126
    v_add_f32 v245, v245, v127
    v_cvt_pk_bf16_f32 v123, v126, v127
    v_mfma_f32_16x16x32_bf16 v[0:3], v[192:195], v[104:107], v[0:3]
    ds_read_b128 v[184:187], v234 offset:4096
    v_mfma_f32_16x16x32_bf16 v[32:35], v[192:195], v[120:123], v[32:35]
    v_mfma_f32_16x16x32_bf16 v[4:7], v[196:199], v[104:107], v[4:7]
    ds_read_b128 v[188:191], v235 offset:4096
    v_mfma_f32_16x16x32_bf16 v[36:39], v[196:199], v[120:123], v[36:39]
    ds_read_b128 v[192:195], v232 offset:8192
    ds_read_b128 v[196:199], v233 offset:8192
    v_max3_f32 v248, v64, v65, v66
    v_mfma_f32_16x16x32_bf16 v[8:11], v[200:203], v[104:107], v[8:11]
    v_max3_f32 v248, v248, v67, v68
    v_max3_f32 v248, v248, v69, v70
    v_max3_f32 v248, v248, v71, v72
    v_mfma_f32_16x16x32_bf16 v[40:43], v[200:203], v[120:123], v[40:43]
    ds_read_b128 v[200:203], v234 offset:8192
    v_max3_f32 v250, v80, v81, v82
    v_max3_f32 v250, v250, v83, v84
    v_mfma_f32_16x16x32_bf16 v[12:15], v[204:207], v[104:107], v[12:15]
    v_max3_f32 v250, v250, v85, v86
    v_max3_f32 v250, v250, v87, v88
    v_max3_f32 v248, v248, v73, v74
    v_mfma_f32_16x16x32_bf16 v[44:47], v[204:207], v[120:123], v[44:47]
    ds_read_b128 v[204:207], v235 offset:8192
    v_max3_f32 v248, v248, v75, v76
    v_max3_f32 v248, v248, v77, v78
    v_mfma_f32_16x16x32_bf16 v[16:19], v[208:211], v[104:107], v[16:19]
    v_max_f32 v248, v248, v79
    v_max3_f32 v250, v250, v89, v90
    v_max3_f32 v250, v250, v91, v92
    v_mfma_f32_16x16x32_bf16 v[48:51], v[208:211], v[120:123], v[48:51]
    ds_read_b128 v[208:211], v232 offset:12288
    v_max3_f32 v250, v250, v93, v94
    v_max_f32 v250, v250, v95
    v_mfma_f32_16x16x32_bf16 v[20:23], v[212:215], v[104:107], v[20:23]
    v_max_f32 v249, v248, v250
    v_add_u32 v236, s44, v236
    v_add_u32 v237, s44, v237
    v_mfma_f32_16x16x32_bf16 v[52:55], v[212:215], v[120:123], v[52:55]
    ds_read_b128 v[212:215], v233 offset:12288
    v_add_u32 v238, s44, v238
    v_add_u32 v239, s44, v239
    v_mfma_f32_16x16x32_bf16 v[24:27], v[216:219], v[104:107], v[24:27]
    v_add_u32 v240, s44, v240
    v_add_u32 v241, s44, v241
    v_add_u32 v242, s44, v242
    v_mfma_f32_16x16x32_bf16 v[56:59], v[216:219], v[120:123], v[56:59]
    ds_read_b128 v[216:219], v234 offset:12288
    v_add_u32 v243, s44, v243
    v_mfma_f32_16x16x32_bf16 v[28:31], v[220:223], v[104:107], v[28:31]
    v_mfma_f32_16x16x32_bf16 v[60:63], v[220:223], v[120:123], v[60:63]
    ds_read_b128 v[220:223], v235 offset:12288
    s_add_u32 s42, s42, 1
    s_and_b32 s4, s42, 7
    s_cmp_eq_u32 s4, 0
    s_cbranch_scc1 L_sw_a2
    v_cmp_lt_f32 vcc, s41, v249
    s_nop 0
    s_cbranch_vccnz L_rare_a2b
L_back_a2b:
    s_branch L_loop_a2
L_sw_a2:
    s_cmp_eq_u32 s42, 16
    s_cbranch_scc1 L_fin_a2
    v_mov_b32 v249, v248
    s_nop 1
    v_permlane16_swap_b32 v248, v249
    v_max_f32 v248, v248, v249
    v_mov_b32 v249, v248
    s_nop 1
    v_permlane32_swap_b32 v248, v249
    v_max_f32 v248, v248, v249
    v_sub_f32 v64, v64, v248
    v_sub_f32 v65, v65, v248
    v_sub_f32 v66, v66, v248
    v_sub_f32 v67, v67, v248
    v_sub_f32 v68, v68, v248
    v_sub_f32 v69, v69, v248
    v_sub_f32 v70, v70, v248
    v_sub_f32 v71, v71, v248
    v_sub_f32 v72, v72, v248
    v_sub_f32 v73, v73, v248
    v_sub_f32 v74, v74, v248
    v_sub_f32 v75, v75, v248
    v_sub_f32 v76, v76, v248
    v_sub_f32 v77, v77, v248
    v_sub_f32 v78, v78, v248
    v_sub_f32 v79, v79, v248
    v_sub_f32 v224, v224, v248
    v_sub_f32 v225, v225, v248
    v_sub_f32 v226, v226, v248
    v_sub_f32 v227, v227, v248
    v_mov_b32 v251, v250
    s_nop 1
    v_permlane16_swap_b32 v250, v251
    v_max_f32 v250, v250, v251
    v_mov_b32 v251, v250
    s_nop 1
    v_permlane32_swap_b32 v250, v251
    v_max_f32 v250, v250, v251
    v_sub_f32 v80, v80, v250
    v_sub_f32 v81, v81, v250
    v_sub_f32 v82, v82, v250
    v_sub_f32 v83, v83, v250
    v_sub_f32 v84, v84, v250
    v_sub_f32 v85, v85, v250
    v_sub_f32 v86, v86, v250
    v_sub_f32 v87, v87, v250
    v_sub_f32 v88, v88, v250
    v_sub_f32 v89, v89, v250
    v_sub_f32 v90, v90, v250
    v_sub_f32 v91, v91, v250
    v_sub_f32 v92, v92, v250
    v_sub_f32 v93, v93, v250
    v_sub_f32 v94, v94, v250
    v_sub_f32 v95, v95, v250
    v_sub_f32 v228, v228, v250
    v_sub_f32 v229, v229, v250
    v_sub_f32 v230, v230, v250
    v_sub_f32 v231, v231, v250
    v_mov_b32 v249, v244
    s_nop 1
    v_permlane16_swap_b32 v244, v249
    v_add_f32 v244, v244, v249
    v_mov_b32 v249, v244
    s_nop 1
    v_permlane32_swap_b32 v244, v249
    v_add_f32 v244, v244, v249
    v_rcp_f32 v248, v244
    v_mov_b32 v244, 0
    v_mov_b32 v251, v245
    s_nop 1
    v_permlane16_swap_b32 v245, v251
    v_add_f32 v245, v245, v251
    v_mov_b32 v251, v245
    s_nop 1
    v_permlane32_swap_b32 v245, v251
    v_add_f32 v245, v245, v251
    v_rcp_f32 v250, v245
    v_mov_b32 v245, 0
    s_add_u32 s45, s45, 1
    s_cmp_eq_u32 s45, 3
    s_cselect_b32 s43, -32768, s75
    s_cselect_b32 s45, 0, s45
    s_add_u32 s46, s46, 1
    s_cmp_eq_u32 s46, 3
    s_cselect_b32 s44, -32768, s75
    s_cselect_b32 s46, 0, s46
    s_waitcnt lgkmcnt(15)
    v_mfma_f32_16x16x32_bf16 v[96:99], v[160:163], v[128:131], v[224:227]
    v_exp_f32 v64, v64
    v_exp_f32 v65, v65
    v_add_f32 v244, v244, v64
    v_mfma_f32_16x16x32_bf16 v[112:115], v[160:163], v[144:147], v[228:231]
    ds_read_b64_tr_b16 v[160:161], v236
    ds_read_b64_tr_b16 v[162:163], v236 offset:4096
    v_exp_f32 v66, v66
    v_add_f32 v244, v244, v65
    s_waitcnt lgkmcnt(15)
    v_mfma_f32_16x16x32_bf16 v[96:99], v[164:167], v[132:135], v[96:99]
    v_exp_f32 v67, v67
    v_cvt_pk_bf16_f32 v64, v64, v65
    v_add_f32 v244, v244, v66
    v_exp_f32 v68, v68
    v_mfma_f32_16x16x32_bf16 v[112:115], v[164:167], v[148:151], v[112:115]
    ds_read_b64_tr_b16 v[164:165], v237
    ds_read_b64_tr_b16 v[166:167], v237 offset:4096
    v_add_f32 v244, v244, v67
    v_exp_f32 v69, v69
    v_mfma_f32_16x16x32_bf16 v[96:99], v[168:171], v[136:139], v[96:99]
    v_cvt_pk_bf16_f32 v65, v66, v67
    v_add_f32 v244, v244, v68
    v_exp_f32 v70, v70
    v_mfma_f32_16x16x32_bf16 v[112:115], v[168:171], v[152:155], v[112:115]
    ds_read_b64_tr_b16 v[168:169], v238
    ds_read_b64_tr_b16 v[170:171], v238 offset:4096
    v_add_f32 v244, v244, v69
    v_exp_f32 v71, v71
    s_waitcnt lgkmcnt(15)
    v_mfma_f32_16x16x32_bf16 v[96:99], v[172:175], v[140:143], v[96:99]
    v_cvt_pk_bf16_f32 v66, v68, v69
    v_add_f32 v244, v244, v70
    v_add_f32 v244, v244, v71
    v_cvt_pk_bf16_f32 v67, v70, v71
    v_mfma_f32_16x16x32_bf16 v[112:115], v[172:175], v[156:159], v[112:115]
    ds_read_b64_tr_b16 v[172:173], v239
    ds_read_b64_tr_b16 v[174:175], v239 offset:4096
    v_pk_mul_f32 v[0:1], v[0:1], v[248:249] op_sel_hi:[1,0]
    v_pk_mul_f32 v[2:3], v[2:3], v[248:249] op_sel_hi:[1,0]
    v_pk_mul_f32 v[4:5], v[4:5], v[248:249] op_sel_hi:[1,0]
    v_mfma_f32_16x16x32_bf16 v[100:103], v[176:179], v[128:131], v[224:227]
    v_pk_mul_f32 v[6:7], v[6:7], v[248:249] op_sel_hi:[1,0]
    v_cvt_pk_bf16_f32 v0, v0, v1
    v_cvt_pk_bf16_f32 v1, v2, v3
    v_cvt_pk_bf16_f32 v2, v4, v5
    v_cvt_pk_bf16_f32 v3, v6, v7
    v_mfma_f32_16x16x32_bf16 v[116:119], v[176:179], v[144:147], v[228:231]
    ds_read_b64_tr_b16 v[176:177], v240
    ds_read_b64_tr_b16 v[178:179], v240 offset:4096
    buffer_store_dwordx4 v[0:3], v246, s[24:27], s47 offen sc0 sc1
    v_pk_mul_f32 v[8:9], v[8:9], v[248:249] op_sel_hi:[1,0]
    v_pk_mul_f32 v[10:11], v[10:11], v[248:249] op_sel_hi:[1,0]
    v_mfma_f32_16x16x32_bf16 v[100:103], v[180:183], v[132:135], v[100:103]
    v_pk_mul_f32 v[12:13], v[12:13], v[248:249] op_sel_hi:[1,0]
    v_pk_mul_f32 v[14:15], v[14:15], v[248:249] op_sel_hi:[1,0]
    v_cvt_pk_bf16_f32 v8, v8, v9
    v_cvt_pk_bf16_f32 v9, v10, v11
    v_cvt_pk_bf16_f32 v10, v12, v13
    v_mfma_f32_16x16x32_bf16 v[116:119], v[180:183], v[148:151], v[116:119]
    ds_read_b64_tr_b16 v[180:181], v241
    ds_read_b64_tr_b16 v[182:183], v241 offset:4096
    v_cvt_pk_bf16_f32 v11, v14, v15
    buffer_store_dwordx4 v[8:11], v246, s[24:27], s47 offen offset:1024 sc0 sc1
    v_pk_mul_f32 v[16:17], v[16:17], v[248:249] op_sel_hi:[1,0]
    v_mfma_f32_16x16x32_bf16 v[100:103], v[184:187], v[136:139], v[100:103]
    v_pk_mul_f32 v[18:19], v[18:19], v[248:249] op_sel_hi:[1,0]
    v_pk_mul_f32 v[20:21], v[20:21], v[248:249] op_sel_hi:[1,0]
    v_pk_mul_f32 v[22:23], v[22:23], v[248:249] op_sel_hi:[1,0]
    v_cvt_pk_bf16_f32 v16, v16, v17
    v_cvt_pk_bf16_f32 v17, v18, v19
    v_mfma_f32_16x16x32_bf16 v[116:119], v[184:187], v[152:155], v[116:119]
    ds_read_b64_tr_b16 v[184:185], v242
    ds_read_b64_tr_b16 v[186:187], v242 offset:4096
    v_cvt_pk_bf16_f32 v18, v20, v21
    v_cvt_pk_bf16_f32 v19, v22, v23
    s_waitcnt lgkmcnt(15)
    v_mfma_f32_16x16x32_bf16 v[100:103], v[188:191], v[140:143], v[100:103]
    buffer_store_dwordx4 v[16:19], v246, s[24:27], s47 offen offset:2048 sc0 sc1
    v_pk_mul_f32 v[24:25], v[24:25], v[248:249] op_sel_hi:[1,0]
    v_pk_mul_f32 v[26:27], v[26:27], v[248:249] op_sel_hi:[1,0]
    v_pk_mul_f32 v[28:29], v[28:29], v[248:249] op_sel_hi:[1,0]
    v_pk_mul_f32 v[30:31], v[30:31], v[248:249] op_sel_hi:[1,0]
    v_mfma_f32_16x16x32_bf16 v[116:119], v[188:191], v[156:159], v[116:119]
    ds_read_b64_tr_b16 v[188:189], v243
    ds_read_b64_tr_b16 v[190:191], v243 offset:4096
    v_cvt_pk_bf16_f32 v24, v24, v25
    v_cvt_pk_bf16_f32 v25, v26, v27
    v_cvt_pk_bf16_f32 v26, v28, v29
    v_mfma_f32_16x16x32_bf16 v[104:107], v[192:195], v[128:131], v[224:227]
    v_cvt_pk_bf16_f32 v27, v30, v31
    buffer_store_dwordx4 v[24:27], v246, s[24:27], s47 offen offset:3072 sc0 sc1
    v_pk_mul_f32 v[32:33], v[32:33], v[250:251] op_sel_hi:[1,0]
    v_pk_mul_f32 v[34:35], v[34:35], v[250:251] op_sel_hi:[1,0]
    v_pk_mul_f32 v[36:37], v[36:37], v[250:251] op_sel_hi:[1,0]
    v_mfma_f32_16x16x32_bf16 v[120:123], v[192:195], v[144:147], v[228:231]
    ds_read_b64_tr_b16 v[192:193], v236 offset:8192
    ds_read_b64_tr_b16 v[194:195], v236 offset:12288
    v_pk_mul_f32 v[38:39], v[38:39], v[250:251] op_sel_hi:[1,0]
    v_cvt_pk_bf16_f32 v32, v32, v33
    v_cvt_pk_bf16_f32 v33, v34, v35
    v_mfma_f32_16x16x32_bf16 v[104:107], v[196:199], v[132:135], v[104:107]
    v_cvt_pk_bf16_f32 v34, v36, v37
    v_cvt_pk_bf16_f32 v35, v38, v39
    s_add_u32 s47, s47, 131072
    buffer_store_dwordx4 v[32:35], v246, s[24:27], s47 offen sc0 sc1
    v_pk_mul_f32 v[40:41], v[40:41], v[250:251] op_sel_hi:[1,0]
    v_pk_mul_f32 v[42:43], v[42:43], v[250:251] op_sel_hi:[1,0]
    v_mfma_f32_16x16x32_bf16 v[120:123], v[196:199], v[148:151], v[120:123]
    ds_read_b64_tr_b16 v[196:197], v237 offset:8192
    ds_read_b64_tr_b16 v[198:199], v237 offset:12288
    v_pk_mul_f32 v[44:45], v[44:45], v[250:251] op_sel_hi:[1,0]
    v_pk_mul_f32 v[46:47], v[46:47], v[250:251] op_sel_hi:[1,0]
    v_cvt_pk_bf16_f32 v40, v40, v41
    v_mfma_f32_16x16x32_bf16 v[104:107], v[200:203], v[136:139], v[104:107]
    v_cvt_pk_bf16_f32 v41, v42, v43
    v_cvt_pk_bf16_f32 v42, v44, v45
    v_cvt_pk_bf16_f32 v43, v46, v47
    buffer_store_dwordx4 v[40:43], v246, s[24:27], s47 offen offset:1024 sc0 sc1
    v_mfma_f32_16x16x32_bf16 v[120:123], v[200:203], v[152:155], v[120:123]
    ds_read_b64_tr_b16 v[200:201], v238 offset:8192
    ds_read_b64_tr_b16 v[202:203], v238 offset:12288
    v_pk_mul_f32 v[48:49], v[48:49], v[250:251] op_sel_hi:[1,0]
    v_pk_mul_f32 v[50:51], v[50:51], v[250:251] op_sel_hi:[1,0]
    v_pk_mul_f32 v[52:53], v[52:53], v[250:251] op_sel_hi:[1,0]
    v_mfma_f32_16x16x32_bf16 v[104:107], v[204:207], v[140:143], v[104:107]
    v_pk_mul_f32 v[54:55], v[54:55], v[250:251] op_sel_hi:[1,0]
    v_cvt_pk_bf16_f32 v48, v48, v49
    v_cvt_pk_bf16_f32 v49, v50, v51
    v_cvt_pk_bf16_f32 v50, v52, v53
    v_cvt_pk_bf16_f32 v51, v54, v55
    v_mfma_f32_16x16x32_bf16 v[120:123], v[204:207], v[156:159], v[120:123]
    ds_read_b64_tr_b16 v[204:205], v239 offset:8192
    ds_read_b64_tr_b16 v[206:207], v239 offset:12288
    buffer_store_dwordx4 v[48:51], v246, s[24:27], s47 offen offset:2048 sc0 sc1
    v_pk_mul_f32 v[56:57], v[56:57], v[250:251] op_sel_hi:[1,0]
    v_pk_mul_f32 v[58:59], v[58:59], v[250:251] op_sel_hi:[1,0]
    v_mfma_f32_16x16x32_bf16 v[108:111], v[208:211], v[128:131], v[224:227]
    v_pk_mul_f32 v[60:61], v[60:61], v[250:251] op_sel_hi:[1,0]
    v_pk_mul_f32 v[62:63], v[62:63], v[250:251] op_sel_hi:[1,0]
    v_cvt_pk_bf16_f32 v56, v56, v57
    v_cvt_pk_bf16_f32 v57, v58, v59
    v_cvt_pk_bf16_f32 v58, v60, v61
    v_mfma_f32_16x16x32_bf16 v[124:127], v[208:211], v[144:147], v[228:231]
    v_cvt_pk_bf16_f32 v59, v62, v63
    buffer_store_dwordx4 v[56:59], v246, s[24:27], s47 offen offset:3072 sc0 sc1
    s_add_u32 s47, s47, -126976
    ds_read_b64_tr_b16 v[208:209], v240 offset:8192
    ds_read_b64_tr_b16 v[210:211], v240 offset:12288
    v_exp_f32 v80, v80
    v_mfma_f32_16x16x32_bf16 v[108:111], v[212:215], v[132:135], v[108:111]
    v_exp_f32 v81, v81
    v_add_f32 v245, v245, v80
    v_mfma_f32_16x16x32_bf16 v[124:127], v[212:215], v[148:151], v[124:127]
    v_exp_f32 v82, v82
    v_add_f32 v245, v245, v81
    v_exp_f32 v83, v83
    v_mfma_f32_16x16x32_bf16 v[108:111], v[216:219], v[136:139], v[108:111]
    v_cvt_pk_bf16_f32 v80, v80, v81
    v_add_f32 v245, v245, v82
    v_exp_f32 v84, v84
    v_add_f32 v245, v245, v83
    v_mfma_f32_16x16x32_bf16 v[124:127], v[216:219], v[152:155], v[124:127]
    v_exp_f32 v85, v85
    v_cvt_pk_bf16_f32 v81, v82, v83
    v_add_f32 v245, v245, v84
    v_exp_f32 v86, v86
    s_waitcnt lgkmcnt(15)
    v_mfma_f32_16x16x32_bf16 v[108:111], v[220:223], v[140:143], v[108:111]
    v_add_f32 v245, v245, v85
    v_exp_f32 v87, v87
    v_cvt_pk_bf16_f32 v82, v84, v85
    v_mfma_f32_16x16x32_bf16 v[124:127], v[220:223], v[156:159], v[124:127]
    v_add_f32 v245, v245, v86
    v_add_f32 v245, v245, v87
    v_cvt_pk_bf16_f32 v83, v86, v87
    ds_read_b64_tr_b16 v[212:213], v241 offset:8192
    ds_read_b64_tr_b16 v[214:215], v241 offset:12288
    v_mfma_f32_16x16x32_bf16 v[0:3], v[160:163], v[64:67], 0
    ds_read_b64_tr_b16 v[216:217], v242 offset:8192
    ds_read_b64_tr_b16 v[218:219], v242 offset:12288
    ds_read_b64_tr_b16 v[220:221], v243 offset:8192
    ds_read_b64_tr_b16 v[222:223], v243 offset:12288
    v_add_u32 v232, s43, v232
    v_mfma_f32_16x16x32_bf16 v[32:35], v[160:163], v[80:83], 0
    v_add_u32 v233, s43, v233
    v_add_u32 v234, s43, v234
    v_add_u32 v235, s43, v235
    v_exp_f32 v72, v72
    v_mfma_f32_16x16x32_bf16 v[4:7], v[164:167], v[64:67], 0
    v_exp_f32 v73, v73
    v_add_f32 v244, v244, v72
    v_exp_f32 v74, v74
    v_mfma_f32_16x16x32_bf16 v[36:39], v[164:167], v[80:83], 0
    v_add_f32 v244, v244, v73
    v_exp_f32 v75, v75
    v_cvt_pk_bf16_f32 v72, v72, v73
    v_mfma_f32_16x16x32_bf16 v[8:11], v[168:171], v[64:67], 0
    v_add_f32 v244, v244, v74
    v_exp_f32 v76, v76
    v_add_f32 v244, v244, v75
    v_exp_f32 v77, v77
    v_mfma_f32_16x16x32_bf16 v[40:43], v[168:171], v[80:83], 0
    v_cvt_pk_bf16_f32 v73, v74, v75
    v_add_f32 v244, v244, v76
    v_exp_f32 v78, v78
    v_mfma_f32_16x16x32_bf16 v[12:15], v[172:175], v[64:67], 0
    v_add_f32 v244, v244, v77
    v_exp_f32 v79, v79
    v_cvt_pk_bf16_f32 v74, v76, v77
    v_add_f32 v244, v244, v78
    v_mfma_f32_16x16x32_bf16 v[44:47], v[172:175], v[80:83], 0
    v_add_f32 v244, v244, v79
    v_cvt_pk_bf16_f32 v75, v78, v79
    v_exp_f32 v88, v88
    v_exp_f32 v89, v89
    v_mfma_f32_16x16x32_bf16 v[16:19], v[176:179], v[64:67], 0
    s_waitcnt lgkmcnt(0)
    s_barrier
    ds_read_b128 v[160:163], v232
    ds_read_b128 v[164:167], v233
    v_mfma_f32_16x16x32_bf16 v[48:51], v[176:179], v[80:83], 0
    ds_read_b128 v[168:171], v234
    ds_read_b128 v[172:175], v235
    ds_read_b128 v[176:179], v232 offset:4096
    v_add_f32 v245, v245, v88
    v_exp_f32 v90, v90
    v_mfma_f32_16x16x32_bf16 v[20:23], v[180:183], v[64:67], 0
    v_add_f32 v245, v245, v89
    v_exp_f32 v91, v91
    v_cvt_pk_bf16_f32 v88, v88, v89
    v_mfma_f32_16x16x32_bf16 v[52:55], v[180:183], v[80:83], 0
    ds_read_b128 v[180:183], v233 offset:4096
    v_add_f32 v245, v245, v90
    v_exp_f32 v92, v92
    v_add_f32 v245, v245, v91
    v_mfma_f32_16x16x32_bf16 v[24:27], v[184:187], v[64:67], 0
    v_exp_f32 v93, v93
    v_cvt_pk_bf16_f32 v89, v90, v91
    v_add_f32 v245, v245, v92
    v_exp_f32 v94, v94
    v_mfma_f32_16x16x32_bf16 v[56:59], v[184:187], v[80:83], 0
    v_add_f32 v245, v245, v93
    v_exp_f32 v95, v95
    v_cvt_pk_bf16_f32 v90, v92, v93
    v_mfma_f32_16x16x32_bf16 v[28:31], v[188:191], v[64:67], 0
    v_add_f32 v245, v245, v94
    v_add_f32 v245, v245, v95
    v_cvt_pk_bf16_f32 v91, v94, v95
    ds_read_b128 v[184:187], v234 offset:4096
    v_max3_f32 v248, v96, v97, v98
    v_mfma_f32_16x16x32_bf16 v[60:63], v[188:191], v[80:83], 0
    ds_read_b128 v[188:191], v235 offset:4096
    v_max3_f32 v248, v248, v99, v100
    v_max3_f32 v248, v248, v101, v102
    v_max3_f32 v248, v248, v103, v104
    v_mfma_f32_16x16x32_bf16 v[0:3], v[192:195], v[72:75], v[0:3]
    v_max3_f32 v250, v112, v113, v114
    v_max3_f32 v250, v250, v115, v116
    v_max3_f32 v250, v250, v117, v118
    v_max3_f32 v250, v250, v119, v120
    v_max3_f32 v248, v248, v105, v106
    v_mfma_f32_16x16x32_bf16 v[32:35], v[192:195], v[88:91], v[32:35]
    ds_read_b128 v[192:195], v232 offset:8192
    v_max3_f32 v248, v248, v107, v108
    v_max3_f32 v248, v248, v109, v110
    v_max_f32 v248, v248, v111
    v_max3_f32 v250, v250, v121, v122
    v_mfma_f32_16x16x32_bf16 v[4:7], v[196:199], v[72:75], v[4:7]
    v_max3_f32 v250, v250, v123, v124
    v_max3_f32 v250, v250, v125, v126
    v_max_f32 v250, v250, v127
    v_max_f32 v249, v248, v250
    v_add_u32 v236, s44, v236
    v_mfma_f32_16x16x32_bf16 v[36:39], v[196:199], v[88:91], v[36:39]
    ds_read_b128 v[196:199], v233 offset:8192
    v_add_u32 v237, s44, v237
    v_add_u32 v238, s44, v238
    v_add_u32 v239, s44, v239
    v_add_u32 v240, s44, v240
    v_mfma_f32_16x16x32_bf16 v[8:11], v[200:203], v[72:75], v[8:11]
    v_add_u32 v241, s44, v241
    v_add_u32 v242, s44, v242
    v_add_u32 v243, s44, v243
    v_mfma_f32_16x16x32_bf16 v[40:43], v[200:203], v[88:91], v[40:43]
    ds_read_b128 v[200:203], v234 offset:8192
    v_mfma_f32_16x16x32_bf16 v[12:15], v[204:207], v[72:75], v[12:15]
    v_mfma_f32_16x16x32_bf16 v[44:47], v[204:207], v[88:91], v[44:47]
    ds_read_b128 v[204:207], v235 offset:8192
    v_mfma_f32_16x16x32_bf16 v[16:19], v[208:211], v[72:75], v[16:19]
    v_mfma_f32_16x16x32_bf16 v[48:51], v[208:211], v[88:91], v[48:51]
    ds_read_b128 v[208:211], v232 offset:12288
    v_mfma_f32_16x16x32_bf16 v[20:23], v[212:215], v[72:75], v[20:23]
    v_mfma_f32_16x16x32_bf16 v[52:55], v[212:215], v[88:91], v[52:55]
    ds_read_b128 v[212:215], v233 offset:12288
    v_mfma_f32_16x16x32_bf16 v[24:27], v[216:219], v[72:75], v[24:27]
    v_mfma_f32_16x16x32_bf16 v[56:59], v[216:219], v[88:91], v[56:59]
    ds_read_b128 v[216:219], v234 offset:12288
    v_mfma_f32_16x16x32_bf16 v[28:31], v[220:223], v[72:75], v[28:31]
    v_mfma_f32_16x16x32_bf16 v[60:63], v[220:223], v[88:91], v[60:63]
    ds_read_b128 v[220:223], v235 offset:12288
    s_nop 1
    s_branch L_ja_a2
L_fin_a2:
    v_mov_b32 v249, v244
    s_nop 1
    v_permlane16_swap_b32 v244, v249
    v_add_f32 v244, v244, v249
    v_mov_b32 v249, v244
    s_nop 1
    v_permlane32_swap_b32 v244, v249
    v_add_f32 v244, v244, v249
    v_rcp_f32 v248, v244
    v_mov_b32 v244, 0
    v_mov_b32 v251, v245
    s_nop 1
    v_permlane16_swap_b32 v245, v251
    v_add_f32 v245, v245, v251
    v_mov_b32 v251, v245
    s_nop 1
    v_permlane32_swap_b32 v245, v251
    v_add_f32 v245, v245, v251
    v_rcp_f32 v250, v245
    v_mov_b32 v245, 0
    v_pk_mul_f32 v[0:1], v[0:1], v[248:249] op_sel_hi:[1,0]
    v_pk_mul_f32 v[2:3], v[2:3], v[248:249] op_sel_hi:[1,0]
    v_pk_mul_f32 v[4:5], v[4:5], v[248:249] op_sel_hi:[1,0]
    v_pk_mul_f32 v[6:7], v[6:7], v[248:249] op_sel_hi:[1,0]
    v_cvt_pk_bf16_f32 v0, v0, v1
    v_cvt_pk_bf16_f32 v1, v2, v3
    v_cvt_pk_bf16_f32 v2, v4, v5
    v_cvt_pk_bf16_f32 v3, v6, v7
    buffer_store_dwordx4 v[0:3], v246, s[24:27], s47 offen sc0 sc1
    v_pk_mul_f32 v[8:9], v[8:9], v[248:249] op_sel_hi:[1,0]
    v_pk_mul_f32 v[10:11], v[10:11], v[248:249] op_sel_hi:[1,0]
    v_pk_mul_f32 v[12:13], v[12:13], v[248:249] op_sel_hi:[1,0]
    v_pk_mul_f32 v[14:15], v[14:15], v[248:249] op_sel_hi:[1,0]
    v_cvt_pk_bf16_f32 v8, v8, v9
    v_cvt_pk_bf16_f32 v9, v10, v11
    v_cvt_pk_bf16_f32 v10, v12, v13
    v_cvt_pk_bf16_f32 v11, v14, v15
    buffer_store_dwordx4 v[8:11], v246, s[24:27], s47 offen offset:1024 sc0 sc1
    v_pk_mul_f32 v[16:17], v[16:17], v[248:249] op_sel_hi:[1,0]
    v_pk_mul_f32 v[18:19], v[18:19], v[248:249] op_sel_hi:[1,0]
    v_pk_mul_f32 v[20:21], v[20:21], v[248:249] op_sel_hi:[1,0]
    v_pk_mul_f32 v[22:23], v[22:23], v[248:249] op_sel_hi:[1,0]
    v_cvt_pk_bf16_f32 v16, v16, v17
    v_cvt_pk_bf16_f32 v17, v18, v19
    v_cvt_pk_bf16_f32 v18, v20, v21
    v_cvt_pk_bf16_f32 v19, v22, v23
    buffer_store_dwordx4 v[16:19], v246, s[24:27], s47 offen offset:2048 sc0 sc1
    v_pk_mul_f32 v[24:25], v[24:25], v[248:249] op_sel_hi:[1,0]
    v_pk_mul_f32 v[26:27], v[26:27], v[248:249] op_sel_hi:[1,0]
    v_pk_mul_f32 v[28:29], v[28:29], v[248:249] op_sel_hi:[1,0]
    v_pk_mul_f32 v[30:31], v[30:31], v[248:249] op_sel_hi:[1,0]
    v_cvt_pk_bf16_f32 v24, v24, v25
    v_cvt_pk_bf16_f32 v25, v26, v27
    v_cvt_pk_bf16_f32 v26, v28, v29
    v_cvt_pk_bf16_f32 v27, v30, v31
    buffer_store_dwordx4 v[24:27], v246, s[24:27], s47 offen offset:3072 sc0 sc1
    v_pk_mul_f32 v[32:33], v[32:33], v[250:251] op_sel_hi:[1,0]
    v_pk_mul_f32 v[34:35], v[34:35], v[250:251] op_sel_hi:[1,0]
    v_pk_mul_f32 v[36:37], v[36:37], v[250:251] op_sel_hi:[1,0]
    v_pk_mul_f32 v[38:39], v[38:39], v[250:251] op_sel_hi:[1,0]
    v_cvt_pk_bf16_f32 v32, v32, v33
    v_cvt_pk_bf16_f32 v33, v34, v35
    v_cvt_pk_bf16_f32 v34, v36, v37
    v_cvt_pk_bf16_f32 v35, v38, v39
    s_add_u32 s47, s47, 131072
    buffer_store_dwordx4 v[32:35], v246, s[24:27], s47 offen sc0 sc1
    v_pk_mul_f32 v[40:41], v[40:41], v[250:251] op_sel_hi:[1,0]
    v_pk_mul_f32 v[42:43], v[42:43], v[250:251] op_sel_hi:[1,0]
    v_pk_mul_f32 v[44:45], v[44:45], v[250:251] op_sel_hi:[1,0]
    v_pk_mul_f32 v[46:47], v[46:47], v[250:251] op_sel_hi:[1,0]
    v_cvt_pk_bf16_f32 v40, v40, v41
    v_cvt_pk_bf16_f32 v41, v42, v43
    v_cvt_pk_bf16_f32 v42, v44, v45
    v_cvt_pk_bf16_f32 v43, v46, v47
    buffer_store_dwordx4 v[40:43], v246, s[24:27], s47 offen offset:1024 sc0 sc1
    v_pk_mul_f32 v[48:49], v[48:49], v[250:251] op_sel_hi:[1,0]
    v_pk_mul_f32 v[50:51], v[50:51], v[250:251] op_sel_hi:[1,0]
    v_pk_mul_f32 v[52:53], v[52:53], v[250:251] op_sel_hi:[1,0]
    v_pk_mul_f32 v[54:55], v[54:55], v[250:251] op_sel_hi:[1,0]
    v_cvt_pk_bf16_f32 v48, v48, v49
    v_cvt_pk_bf16_f32 v49, v50, v51
    v_cvt_pk_bf16_f32 v50, v52, v53
    v_cvt_pk_bf16_f32 v51, v54, v55
    buffer_store_dwordx4 v[48:51], v246, s[24:27], s47 offen offset:2048 sc0 sc1
    v_pk_mul_f32 v[56:57], v[56:57], v[250:251] op_sel_hi:[1,0]
    v_pk_mul_f32 v[58:59], v[58:59], v[250:251] op_sel_hi:[1,0]
    v_pk_mul_f32 v[60:61], v[60:61], v[250:251] op_sel_hi:[1,0]
    v_pk_mul_f32 v[62:63], v[62:63], v[250:251] op_sel_hi:[1,0]
    v_cvt_pk_bf16_f32 v56, v56, v57
    v_cvt_pk_bf16_f32 v57, v58, v59
    v_cvt_pk_bf16_f32 v58, v60, v61
    v_cvt_pk_bf16_f32 v59, v62, v63
    buffer_store_dwordx4 v[56:59], v246, s[24:27], s47 offen offset:3072 sc0 sc1
    s_add_u32 s47, s47, -126976
    s_waitcnt lgkmcnt(0)
    v_mov_b32 v227, 163832
    v_mov_b32 v225, 1
    v_lshrrev_b32 v252, 4, v246
    s_lshr_b32 s5, s2, 3
    s_mul_i32 s64, s5, 52
    s_lshr_b32 s64, s64, 8
    s_mul_i32 s6, s64, 5
    s_sub_u32 s65, s5, s6
    s_and_b32 s7, s2, 3
    s_mul_i32 s6, s36, 72
    s_mul_i32 s60, s64, 12
    s_add_u32 s6, s6, s60
    s_add_u32 s6, s6, 0
    s_lshl_b32 s6, s6, 2
    s_add_u32 s6, s6, s7
    s_lshl_b32 s60, s6, 15
    s_mul_i32 s61, s7, 1310720
    s_lshl_b32 s6, s65, 8
    s_add_u32 s61, s61, s6
    v_lshrrev_b32 v232, 4, v252
    v_and_b32 v233, 15, v252
    v_lshlrev_b32 v234, 2, v232
    v_xor_b32 v234, v234, v233
    v_lshlrev_b32 v234, 4, v234
    v_mul_u32_u24 v232, 1280, v232
    v_add_u32 v251, v232, v234
    v_xor_b32 v234, 32, v234
    v_add_u32 v252, v232, v234
    s_mul_i32 s66, s64, 3
    s_mul_i32 s6, s65, 2
    s_add_u32 s66, s66, s6
    s_mov_b32 s63, 16
    s_mov_b32 s52, 65536
    s_cmp_lg_u32 s3, 1
    s_cbranch_scc1 L_wls
    s_cmp_ge_u32 s5, 30
    s_cbranch_scc1 L_wls
    s_add_u32 s51, s63, s66
    s_bfe_u32 s49, s51, 0x20002
    s_lshl_b32 s49, s49, 3
    s_and_b32 s51, s51, 3
    s_add_u32 s49, s49, s51
    s_lshr_b32 s51, s63, 4
    s_lshl2_add_u32 s49, s51, s49
    s_add_u32 s63, s63, 1
    s_mul_i32 s48, s49, 40960
    s_add_u32 s48, s48, s61
    s_add_u32 m0, s52, 0
    s_add_u32 s6, s48, 0
    buffer_load_dwordx4 v251, s[28:31], s6 offen lds
    s_add_u32 m0, s52, 1024
    s_add_u32 s6, s48, 5120
    buffer_load_dwordx4 v252, s[28:31], s6 offen lds
    s_add_u32 m0, s52, 2048
    s_add_u32 s6, s48, 10240
    buffer_load_dwordx4 v251, s[28:31], s6 offen lds
    s_add_u32 m0, s52, 3072
    s_add_u32 s6, s48, 15360
    buffer_load_dwordx4 v252, s[28:31], s6 offen lds
    s_add_u32 m0, s52, 4096
    s_add_u32 s6, s48, 20480
    buffer_load_dwordx4 v251, s[28:31], s6 offen lds
    s_add_u32 m0, s52, 5120
    s_add_u32 s6, s48, 25600
    buffer_load_dwordx4 v252, s[28:31], s6 offen lds
    s_add_u32 m0, s52, 6144
    s_add_u32 s6, s48, 30720
    buffer_load_dwordx4 v251, s[28:31], s6 offen lds
    s_add_u32 m0, s52, 7168
    s_add_u32 s6, s48, 35840
    buffer_load_dwordx4 v252, s[28:31], s6 offen lds
    s_add_u32 s52, s52, 8192
    s_add_u32 s51, s63, s66
    s_bfe_u32 s49, s51, 0x20002
    s_lshl_b32 s49, s49, 3
    s_and_b32 s51, s51, 3
    s_add_u32 s49, s49, s51
    s_lshr_b32 s51, s63, 4
    s_lshl2_add_u32 s49, s51, s49
    s_add_u32 s63, s63, 1
    s_mul_i32 s48, s49, 40960
    s_add_u32 s48, s48, s61
    s_add_u32 m0, s52, 0
    s_add_u32 s6, s48, 0
    buffer_load_dwordx4 v251, s[28:31], s6 offen lds
    s_add_u32 m0, s52, 1024
    s_add_u32 s6, s48, 5120
    buffer_load_dwordx4 v252, s[28:31], s6 offen lds
    s_add_u32 m0, s52, 2048
    s_add_u32 s6, s48, 10240
    buffer_load_dwordx4 v251, s[28:31], s6 offen lds
    s_add_u32 m0, s52, 3072
    s_add_u32 s6, s48, 15360
    buffer_load_dwordx4 v252, s[28:31], s6 offen lds
    s_add_u32 m0, s52, 4096
    s_add_u32 s6, s48, 20480
    buffer_load_dwordx4 v251, s[28:31], s6 offen lds
    s_add_u32 m0, s52, 5120
    s_add_u32 s6, s48, 25600
    buffer_load_dwordx4 v252, s[28:31], s6 offen lds
    s_add_u32 m0, s52, 6144
    s_add_u32 s6, s48, 30720
    buffer_load_dwordx4 v251, s[28:31], s6 offen lds
    s_add_u32 m0, s52, 7168
    s_add_u32 s6, s48, 35840
    buffer_load_dwordx4 v252, s[28:31], s6 offen lds
    s_waitcnt vmcnt(16)
    s_branch L_wls2
L_wls:
    s_waitcnt vmcnt(0)
L_wls2:
    s_add_u32 s7, s67, 4096
    s_lshr_b32 s5, s2, 3
    s_mov_b64 exec, 1
    ds_add_rtn_u32 v226, v227, v225
    s_mov_b64 exec, -1
    s_waitcnt lgkmcnt(0)
    v_readfirstlane_b32 s6, v226
    s_nop 0
    s_cmp_lg_u32 s6, 4
    s_cbranch_scc1 L_nosig_a2
    s_lshl_b32 s6, s5, 7
    v_mov_b32 v224, s6
    v_mov_b32 v225, s62
    s_mov_b64 exec, 1
    buffer_store_dword v225, v224, s[24:27], s7 offen sc0 sc1
    s_mov_b64 exec, -1
L_nosig_a2:
    s_cmp_lg_u32 s3, 1
    s_cbranch_scc1 L_end
    s_cmp_ge_u32 s5, 30
    s_cbranch_scc1 L_end
    s_barrier
    s_mov_b32 s50, 6262
L_wl9:
    s_and_b32 s52, s50, 15
    s_lshl_b32 s52, s52, 14
    s_lshr_b32 s50, s50, 4
    s_waitcnt vmcnt(47)
    s_add_u32 s51, s63, s66
    s_bfe_u32 s49, s51, 0x20002
    s_lshl_b32 s49, s49, 3
    s_and_b32 s51, s51, 3
    s_add_u32 s49, s49, s51
    s_lshr_b32 s51, s63, 4
    s_lshl2_add_u32 s49, s51, s49
    s_add_u32 s63, s63, 1
    s_mul_i32 s48, s49, 40960
    s_add_u32 s48, s48, s61
    s_add_u32 m0, s52, 0
    s_add_u32 s6, s48, 0
    buffer_load_dwordx4 v251, s[28:31], s6 offen lds
    s_add_u32 m0, s52, 1024
    s_add_u32 s6, s48, 5120
    buffer_load_dwordx4 v252, s[28:31], s6 offen lds
    s_add_u32 m0, s52, 2048
    s_add_u32 s6, s48, 10240
    buffer_load_dwordx4 v251, s[28:31], s6 offen lds
    s_add_u32 m0, s52, 3072
    s_add_u32 s6, s48, 15360
    buffer_load_dwordx4 v252, s[28:31], s6 offen lds
    s_add_u32 m0, s52, 4096
    s_add_u32 s6, s48, 20480
    buffer_load_dwordx4 v251, s[28:31], s6 offen lds
    s_add_u32 m0, s52, 5120
    s_add_u32 s6, s48, 25600
    buffer_load_dwordx4 v252, s[28:31], s6 offen lds
    s_add_u32 m0, s52, 6144
    s_add_u32 s6, s48, 30720
    buffer_load_dwordx4 v251, s[28:31], s6 offen lds
    s_add_u32 m0, s52, 7168
    s_add_u32 s6, s48, 35840
    buffer_load_dwordx4 v252, s[28:31], s6 offen lds
    s_add_u32 s52, s52, 8192
    s_add_u32 s51, s63, s66
    s_bfe_u32 s49, s51, 0x20002
    s_lshl_b32 s49, s49, 3
    s_and_b32 s51, s51, 3
    s_add_u32 s49, s49, s51
    s_lshr_b32 s51, s63, 4
    s_lshl2_add_u32 s49, s51, s49
    s_add_u32 s63, s63, 1
    s_mul_i32 s48, s49, 40960
    s_add_u32 s48, s48, s61
    s_add_u32 m0, s52, 0
    s_add_u32 s6, s48, 0
    buffer_load_dwordx4 v251, s[28:31], s6 offen lds
    s_add_u32 m0, s52, 1024
    s_add_u32 s6, s48, 5120
    buffer_load_dwordx4 v252, s[28:31], s6 offen lds
    s_add_u32 m0, s52, 2048
    s_add_u32 s6, s48, 10240
    buffer_load_dwordx4 v251, s[28:31], s6 offen lds
    s_add_u32 m0, s52, 3072
    s_add_u32 s6, s48, 15360
    buffer_load_dwordx4 v252, s[28:31], s6 offen lds
    s_add_u32 m0, s52, 4096
    s_add_u32 s6, s48, 20480
    buffer_load_dwordx4 v251, s[28:31], s6 offen lds
    s_add_u32 m0, s52, 5120
    s_add_u32 s6, s48, 25600
    buffer_load_dwordx4 v252, s[28:31], s6 offen lds
    s_add_u32 m0, s52, 6144
    s_add_u32 s6, s48, 30720
    buffer_load_dwordx4 v251, s[28:31], s6 offen lds
    s_add_u32 m0, s52, 7168
    s_add_u32 s6, s48, 35840
    buffer_load_dwordx4 v252, s[28:31], s6 offen lds
    s_cmp_lg_u32 s50, 1
    s_cbranch_scc1 L_wl9
    s_waitcnt vmcnt(48)
    s_barrier
    s_mov_b32 s50, 5378
L_wl12:
    s_and_b32 s52, s50, 15
    s_lshl_b32 s52, s52, 14
    s_lshr_b32 s50, s50, 4
    s_waitcnt vmcnt(47)
    s_add_u32 s51, s63, s66
    s_bfe_u32 s49, s51, 0x20002
    s_lshl_b32 s49, s49, 3
    s_and_b32 s51, s51, 3
    s_add_u32 s49, s49, s51
    s_lshr_b32 s51, s63, 4
    s_lshl2_add_u32 s49, s51, s49
    s_add_u32 s63, s63, 1
    s_mul_i32 s48, s49, 40960
    s_add_u32 s48, s48, s61
    s_add_u32 m0, s52, 0
    s_add_u32 s6, s48, 0
    buffer_load_dwordx4 v251, s[28:31], s6 offen lds
    s_add_u32 m0, s52, 1024
    s_add_u32 s6, s48, 5120
    buffer_load_dwordx4 v252, s[28:31], s6 offen lds
    s_add_u32 m0, s52, 2048
    s_add_u32 s6, s48, 10240
    buffer_load_dwordx4 v251, s[28:31], s6 offen lds
    s_add_u32 m0, s52, 3072
    s_add_u32 s6, s48, 15360
    buffer_load_dwordx4 v252, s[28:31], s6 offen lds
    s_add_u32 m0, s52, 4096
    s_add_u32 s6, s48, 20480
    buffer_load_dwordx4 v251, s[28:31], s6 offen lds
    s_add_u32 m0, s52, 5120
    s_add_u32 s6, s48, 25600
    buffer_load_dwordx4 v252, s[28:31], s6 offen lds
    s_add_u32 m0, s52, 6144
    s_add_u32 s6, s48, 30720
    buffer_load_dwordx4 v251, s[28:31], s6 offen lds
    s_add_u32 m0, s52, 7168
    s_add_u32 s6, s48, 35840
    buffer_load_dwordx4 v252, s[28:31], s6 offen lds
    s_add_u32 s52, s52, 8192
    s_add_u32 s51, s63, s66
    s_bfe_u32 s49, s51, 0x20002
    s_lshl_b32 s49, s49, 3
    s_and_b32 s51, s51, 3
    s_add_u32 s49, s49, s51
    s_lshr_b32 s51, s63, 4
    s_lshl2_add_u32 s49, s51, s49
    s_add_u32 s63, s63, 1
    s_mul_i32 s48, s49, 40960
    s_add_u32 s48, s48, s61
    s_add_u32 m0, s52, 0
    s_add_u32 s6, s48, 0
    buffer_load_dwordx4 v251, s[28:31], s6 offen lds
    s_add_u32 m0, s52, 1024
    s_add_u32 s6, s48, 5120
    buffer_load_dwordx4 v252, s[28:31], s6 offen lds
    s_add_u32 m0, s52, 2048
    s_add_u32 s6, s48, 10240
    buffer_load_dwordx4 v251, s[28:31], s6 offen lds
    s_add_u32 m0, s52, 3072
    s_add_u32 s6, s48, 15360
    buffer_load_dwordx4 v252, s[28:31], s6 offen lds
    s_add_u32 m0, s52, 4096
    s_add_u32 s6, s48, 20480
    buffer_load_dwordx4 v251, s[28:31], s6 offen lds
    s_add_u32 m0, s52, 5120
    s_add_u32 s6, s48, 25600
    buffer_load_dwordx4 v252, s[28:31], s6 offen lds
    s_add_u32 m0, s52, 6144
    s_add_u32 s6, s48, 30720
    buffer_load_dwordx4 v251, s[28:31], s6 offen lds
    s_add_u32 m0, s52, 7168
    s_add_u32 s6, s48, 35840
    buffer_load_dwordx4 v252, s[28:31], s6 offen lds
    s_cmp_lg_u32 s50, 1
    s_cbranch_scc1 L_wl12
    s_waitcnt vmcnt(63)
    s_barrier
    s_mov_b32 s50, 17
L_wl15:
    s_and_b32 s52, s50, 15
    s_lshl_b32 s52, s52, 14
    s_lshr_b32 s50, s50, 4
    s_waitcnt vmcnt(47)
    s_add_u32 s51, s63, s66
    s_bfe_u32 s49, s51, 0x20002
    s_lshl_b32 s49, s49, 3
    s_and_b32 s51, s51, 3
    s_add_u32 s49, s49, s51
    s_lshr_b32 s51, s63, 4
    s_lshl2_add_u32 s49, s51, s49
    s_add_u32 s63, s63, 1
    s_mul_i32 s48, s49, 40960
    s_add_u32 s48, s48, s61
    s_add_u32 m0, s52, 0
    s_add_u32 s6, s48, 0
    buffer_load_dwordx4 v251, s[28:31], s6 offen lds
    s_add_u32 m0, s52, 1024
    s_add_u32 s6, s48, 5120
    buffer_load_dwordx4 v252, s[28:31], s6 offen lds
    s_add_u32 m0, s52, 2048
    s_add_u32 s6, s48, 10240
    buffer_load_dwordx4 v251, s[28:31], s6 offen lds
    s_add_u32 m0, s52, 3072
    s_add_u32 s6, s48, 15360
    buffer_load_dwordx4 v252, s[28:31], s6 offen lds
    s_add_u32 m0, s52, 4096
    s_add_u32 s6, s48, 20480
    buffer_load_dwordx4 v251, s[28:31], s6 offen lds
    s_add_u32 m0, s52, 5120
    s_add_u32 s6, s48, 25600
    buffer_load_dwordx4 v252, s[28:31], s6 offen lds
    s_add_u32 m0, s52, 6144
    s_add_u32 s6, s48, 30720
    buffer_load_dwordx4 v251, s[28:31], s6 offen lds
    s_add_u32 m0, s52, 7168
    s_add_u32 s6, s48, 35840
    buffer_load_dwordx4 v252, s[28:31], s6 offen lds
    s_add_u32 s52, s52, 8192
    s_add_u32 s51, s63, s66
    s_bfe_u32 s49, s51, 0x20002
    s_lshl_b32 s49, s49, 3
    s_and_b32 s51, s51, 3
    s_add_u32 s49, s49, s51
    s_lshr_b32 s51, s63, 4
    s_lshl2_add_u32 s49, s51, s49
    s_add_u32 s63, s63, 1
    s_mul_i32 s48, s49, 40960
    s_add_u32 s48, s48, s61
    s_add_u32 m0, s52, 0
    s_add_u32 s6, s48, 0
    buffer_load_dwordx4 v251, s[28:31], s6 offen lds
    s_add_u32 m0, s52, 1024
    s_add_u32 s6, s48, 5120
    buffer_load_dwordx4 v252, s[28:31], s6 offen lds
    s_add_u32 m0, s52, 2048
    s_add_u32 s6, s48, 10240
    buffer_load_dwordx4 v251, s[28:31], s6 offen lds
    s_add_u32 m0, s52, 3072
    s_add_u32 s6, s48, 15360
    buffer_load_dwordx4 v252, s[28:31], s6 offen lds
    s_add_u32 m0, s52, 4096
    s_add_u32 s6, s48, 20480
    buffer_load_dwordx4 v251, s[28:31], s6 offen lds
    s_add_u32 m0, s52, 5120
    s_add_u32 s6, s48, 25600
    buffer_load_dwordx4 v252, s[28:31], s6 offen lds
    s_add_u32 m0, s52, 6144
    s_add_u32 s6, s48, 30720
    buffer_load_dwordx4 v251, s[28:31], s6 offen lds
    s_add_u32 m0, s52, 7168
    s_add_u32 s6, s48, 35840
    buffer_load_dwordx4 v252, s[28:31], s6 offen lds
    s_cmp_lg_u32 s50, 1
    s_cbranch_scc1 L_wl15
    s_waitcnt vmcnt(48)
    s_barrier
    s_waitcnt vmcnt(16)
    s_barrier
    s_waitcnt vmcnt(0)
    s_barrier
    s_branch L_end
L_q2_a2:
    v_add_u32 v159, s74, v246
    ds_read_b128 v[128:131], v159
    ds_read_b128 v[132:135], v159 offset:1024
    ds_read_b128 v[136:139], v159 offset:2048
    ds_read_b128 v[140:143], v159 offset:3072
    ds_read_b128 v[144:147], v159 offset:4096
    ds_read_b128 v[148:151], v159 offset:5120
    ds_read_b128 v[152:155], v159 offset:6144
    ds_read_b128 v[156:159], v159 offset:7168
    s_waitcnt lgkmcnt(0)
    s_branch L_q2b_a2
L_rare_a2a:
    v_mov_b32 v249, v248
    s_nop 1
    v_permlane16_swap_b32 v248, v249
    v_max_f32 v248, v248, v249
    v_mov_b32 v249, v248
    s_nop 1
    v_permlane32_swap_b32 v248, v249
    v_max_f32 v248, v248, v249
    v_max_f32 v248, 0, v248
    v_exp_f32 v249, -v248
    v_sub_f32 v96, v96, v248
    v_sub_f32 v97, v97, v248
    v_sub_f32 v98, v98, v248
    v_sub_f32 v99, v99, v248
    v_sub_f32 v100, v100, v248
    v_sub_f32 v101, v101, v248
    v_sub_f32 v102, v102, v248
    v_sub_f32 v103, v103, v248
    v_sub_f32 v104, v104, v248
    v_sub_f32 v105, v105, v248
    v_sub_f32 v106, v106, v248
    v_sub_f32 v107, v107, v248
    v_sub_f32 v108, v108, v248
    v_sub_f32 v109, v109, v248
    v_sub_f32 v110, v110, v248
    v_sub_f32 v111, v111, v248
    v_sub_f32 v224, v224, v248
    v_sub_f32 v225, v225, v248
    v_sub_f32 v226, v226, v248
    v_sub_f32 v227, v227, v248
    v_mul_f32 v244, v244, v249
    v_mul_f32 v0, v0, v249
    v_mul_f32 v1, v1, v249
    v_mul_f32 v2, v2, v249
    v_mul_f32 v3, v3, v249
    v_mul_f32 v4, v4, v249
    v_mul_f32 v5, v5, v249
    v_mul_f32 v6, v6, v249
    v_mul_f32 v7, v7, v249
    v_mul_f32 v8, v8, v249
    v_mul_f32 v9, v9, v249
    v_mul_f32 v10, v10, v249
    v_mul_f32 v11, v11, v249
    v_mul_f32 v12, v12, v249
    v_mul_f32 v13, v13, v249
    v_mul_f32 v14, v14, v249
    v_mul_f32 v15, v15, v249
    v_mul_f32 v16, v16, v249
    v_mul_f32 v17, v17, v249
    v_mul_f32 v18, v18, v249
    v_mul_f32 v19, v19, v249
    v_mul_f32 v20, v20, v249
    v_mul_f32 v21, v21, v249
    v_mul_f32 v22, v22, v249
    v_mul_f32 v23, v23, v249
    v_mul_f32 v24, v24, v249
    v_mul_f32 v25, v25, v249
    v_mul_f32 v26, v26, v249
    v_mul_f32 v27, v27, v249
    v_mul_f32 v28, v28, v249
    v_mul_f32 v29, v29, v249
    v_mul_f32 v30, v30, v249
    v_mul_f32 v31, v31, v249
    v_mov_b32 v251, v250
    s_nop 1
    v_permlane16_swap_b32 v250, v251
    v_max_f32 v250, v250, v251
    v_mov_b32 v251, v250
    s_nop 1
    v_permlane32_swap_b32 v250, v251
    v_max_f32 v250, v250, v251
    v_max_f32 v250, 0, v250
    v_exp_f32 v251, -v250
    v_sub_f32 v112, v112, v250
    v_sub_f32 v113, v113, v250
    v_sub_f32 v114, v114, v250
    v_sub_f32 v115, v115, v250
    v_sub_f32 v116, v116, v250
    v_sub_f32 v117, v117, v250
    v_sub_f32 v118, v118, v250
    v_sub_f32 v119, v119, v250
    v_sub_f32 v120, v120, v250
    v_sub_f32 v121, v121, v250
    v_sub_f32 v122, v122, v250
    v_sub_f32 v123, v123, v250
    v_sub_f32 v124, v124, v250
    v_sub_f32 v125, v125, v250
    v_sub_f32 v126, v126, v250
    v_sub_f32 v127, v127, v250
    v_sub_f32 v228, v228, v250
    v_sub_f32 v229, v229, v250
    v_sub_f32 v230, v230, v250
    v_sub_f32 v231, v231, v250
    v_mul_f32 v245, v245, v251
    v_mul_f32 v32, v32, v251
    v_mul_f32 v33, v33, v251
    v_mul_f32 v34, v34, v251
    v_mul_f32 v35, v35, v251
    v_mul_f32 v36, v36, v251
    v_mul_f32 v37, v37, v251
    v_mul_f32 v38, v38, v251
    v_mul_f32 v39, v39, v251
    v_mul_f32 v40, v40, v251
    v_mul_f32 v41, v41, v251
    v_mul_f32 v42, v42, v251
    v_mul_f32 v43, v43, v251
    v_mul_f32 v44, v44, v251
    v_mul_f32 v45, v45, v251
    v_mul_f32 v46, v46, v251
    v_mul_f32 v47, v47, v251
    v_mul_f32 v48, v48, v251
    v_mul_f32 v49, v49, v251
    v_mul_f32 v50, v50, v251
    v_mul_f32 v51, v51, v251
    v_mul_f32 v52, v52, v251
    v_mul_f32 v53, v53, v251
    v_mul_f32 v54, v54, v251
    v_mul_f32 v55, v55, v251
    v_mul_f32 v56, v56, v251
    v_mul_f32 v57, v57, v251
    v_mul_f32 v58, v58, v251
    v_mul_f32 v59, v59, v251
    v_mul_f32 v60, v60, v251
    v_mul_f32 v61, v61, v251
    v_mul_f32 v62, v62, v251
    v_mul_f32 v63, v63, v251
    s_nop 1
    s_branch L_back_a2a
L_rare_a2b:
    v_mov_b32 v249, v248
    s_nop 1
    v_permlane16_swap_b32 v248, v249
    v_max_f32 v248, v248, v249
    v_mov_b32 v249, v248
    s_nop 1
    v_permlane32_swap_b32 v248, v249
    v_max_f32 v248, v248, v249
    v_max_f32 v248, 0, v248
    v_exp_f32 v249, -v248
    v_sub_f32 v64, v64, v248
    v_sub_f32 v65, v65, v248
    v_sub_f32 v66, v66, v248
    v_sub_f32 v67, v67, v248
    v_sub_f32 v68, v68, v248
    v_sub_f32 v69, v69, v248
    v_sub_f32 v70, v70, v248
    v_sub_f32 v71, v71, v248
    v_sub_f32 v72, v72, v248
    v_sub_f32 v73, v73, v248
    v_sub_f32 v74, v74, v248
    v_sub_f32 v75, v75, v248
    v_sub_f32 v76, v76, v248
    v_sub_f32 v77, v77, v248
    v_sub_f32 v78, v78, v248
    v_sub_f32 v79, v79, v248
    v_sub_f32 v224, v224, v248
    v_sub_f32 v225, v225, v248
    v_sub_f32 v226, v226, v248
    v_sub_f32 v227, v227, v248
    v_mul_f32 v244, v244, v249
    v_mul_f32 v0, v0, v249
    v_mul_f32 v1, v1, v249
    v_mul_f32 v2, v2, v249
    v_mul_f32 v3, v3, v249
    v_mul_f32 v4, v4, v249
    v_mul_f32 v5, v5, v249
    v_mul_f32 v6, v6, v249
    v_mul_f32 v7, v7, v249
    v_mul_f32 v8, v8, v249
    v_mul_f32 v9, v9, v249
    v_mul_f32 v10, v10, v249
    v_mul_f32 v11, v11, v249
    v_mul_f32 v12, v12, v249
    v_mul_f32 v13, v13, v249
    v_mul_f32 v14, v14, v249
    v_mul_f32 v15, v15, v249
    v_mul_f32 v16, v16, v249
    v_mul_f32 v17, v17, v249
    v_mul_f32 v18, v18, v249
    v_mul_f32 v19, v19, v249
    v_mul_f32 v20, v20, v249
    v_mul_f32 v21, v21, v249
    v_mul_f32 v22, v22, v249
    v_mul_f32 v23, v23, v249
    v_mul_f32 v24, v24, v249
    v_mul_f32 v25, v25, v249
    v_mul_f32 v26, v26, v249
    v_mul_f32 v27, v27, v249
    v_mul_f32 v28, v28, v249
    v_mul_f32 v29, v29, v249
    v_mul_f32 v30, v30, v249
    v_mul_f32 v31, v31, v249
    v_mov_b32 v251, v250
    s_nop 1
    v_permlane16_swap_b32 v250, v251
    v_max_f32 v250, v250, v251
    v_mov_b32 v251, v250
    s_nop 1
    v_permlane32_swap_b32 v250, v251
    v_max_f32 v250, v250, v251
    v_max_f32 v250, 0, v250
    v_exp_f32 v251, -v250
    v_sub_f32 v80, v80, v250
    v_sub_f32 v81, v81, v250
    v_sub_f32 v82, v82, v250
    v_sub_f32 v83, v83, v250
    v_sub_f32 v84, v84, v250
    v_sub_f32 v85, v85, v250
    v_sub_f32 v86, v86, v250
    v_sub_f32 v87, v87, v250
    v_sub_f32 v88, v88, v250
    v_sub_f32 v89, v89, v250
    v_sub_f32 v90, v90, v250
    v_sub_f32 v91, v91, v250
    v_sub_f32 v92, v92, v250
    v_sub_f32 v93, v93, v250
    v_sub_f32 v94, v94, v250
    v_sub_f32 v95, v95, v250
    v_sub_f32 v228, v228, v250
    v_sub_f32 v229, v229, v250
    v_sub_f32 v230, v230, v250
    v_sub_f32 v231, v231, v250
    v_mul_f32 v245, v245, v251
    v_mul_f32 v32, v32, v251
    v_mul_f32 v33, v33, v251
    v_mul_f32 v34, v34, v251
    v_mul_f32 v35, v35, v251
    v_mul_f32 v36, v36, v251
    v_mul_f32 v37, v37, v251
    v_mul_f32 v38, v38, v251
    v_mul_f32 v39, v39, v251
    v_mul_f32 v40, v40, v251
    v_mul_f32 v41, v41, v251
    v_mul_f32 v42, v42, v251
    v_mul_f32 v43, v43, v251
    v_mul_f32 v44, v44, v251
    v_mul_f32 v45, v45, v251
    v_mul_f32 v46, v46, v251
    v_mul_f32 v47, v47, v251
    v_mul_f32 v48, v48, v251
    v_mul_f32 v49, v49, v251
    v_mul_f32 v50, v50, v251
    v_mul_f32 v51, v51, v251
    v_mul_f32 v52, v52, v251
    v_mul_f32 v53, v53, v251
    v_mul_f32 v54, v54, v251
    v_mul_f32 v55, v55, v251
    v_mul_f32 v56, v56, v251
    v_mul_f32 v57, v57, v251
    v_mul_f32 v58, v58, v251
    v_mul_f32 v59, v59, v251
    v_mul_f32 v60, v60, v251
    v_mul_f32 v61, v61, v251
    v_mul_f32 v62, v62, v251
    v_mul_f32 v63, v63, v251
    s_nop 1
    s_branch L_back_a2b
L_a1:
    v_mov_b32 v0, 163832
    v_mov_b32 v2, 0
    v_mov_b32 v3, 0
    ds_write_b64 v0, v[2:3]
    s_mov_b32 s56, s70
    s_mov_b32 s57, s71
    s_mov_b32 s58, 256
    s_mov_b32 s59, 0x20000
    s_memrealtime s[4:5]
    s_waitcnt lgkmcnt(0)
    s_or_b32 s62, s4, 1
    v_mov_b32 v40, s62
    v_mov_b32 v41, 0
    v_mov_b32 v42, 0
    s_mov_b64 exec, 1
    buffer_atomic_cmpswap v[40:41], v42, s[56:59], 0 offen sc0 sc1
    s_mov_b64 exec, -1
    v_and_b32 v216, 15, v247
    v_lshrrev_b32 v217, 4, v247
    v_xor_b32 v217, v217, v216
    v_lshlrev_b32 v216, 8, v216
    v_lshl_add_u32 v216, v217, 4, v216
    v_xor_b32 v232, 0, v216
    v_xor_b32 v233, 64, v216
    v_xor_b32 v234, 128, v216
    v_xor_b32 v235, 192, v216
    v_bfe_u32 v216, v247, 2, 2
    v_lshrrev_b32 v218, 4, v247
    v_lshl_add_u32 v219, v218, 2, v216
    v_lshlrev_b32 v219, 8, v219
    v_and_b32 v218, 1, v218
    v_lshlrev_b32 v218, 1, v218
    v_lshl_add_u32 v218, v216, 2, v218
    v_bfe_u32 v220, v247, 1, 1
    v_xor_b32 v218, v218, v220
    v_lshl_add_u32 v219, v218, 4, v219
    v_and_b32 v217, 1, v247
    v_lshl_add_u32 v219, v217, 3, v219
    v_add_u32 v219, 49152, v219
    v_xor_b32 v236, 0, v219
    v_xor_b32 v237, 32, v219
    v_xor_b32 v238, 64, v219
    v_xor_b32 v239, 96, v219
    v_xor_b32 v240, 128, v219
    v_xor_b32 v241, 160, v219
    v_xor_b32 v242, 192, v219
    v_xor_b32 v243, 224, v219
    v_mov_b32 v244, 0
    s_mov_b32 s41, 0x41000000
    s_mov_b32 s45, 1
    s_mov_b32 s46, 0
    s_lshl_b32 s6, s3, 13
    s_mov_b32 s7, 57344
    s_cmp_lt_u32 s3, 3
    s_cselect_b32 s7, 135168, s7
    s_add_u32 s6, s6, s7
    v_add_u32 v248, s6, v246
    s_lshr_b32 s5, s2, 3
    s_mul_i32 s64, s5, 52
    s_lshr_b32 s64, s64, 8
    s_mul_i32 s6, s64, 5
    s_sub_u32 s65, s5, s6
    s_and_b32 s7, s2, 3
    s_mul_i32 s6, s36, 72
    s_mul_i32 s60, s64, 12
    s_add_u32 s6, s6, s60
    s_add_u32 s6, s6, 9
    s_lshl_b32 s6, s6, 2
    s_add_u32 s6, s6, s7
    s_lshl_b32 s60, s6, 15
    s_mul_i32 s61, s7, 1310720
    s_lshl_b32 s6, s65, 8
    s_add_u32 s61, s61, s6
    s_mul_i32 s6, s36, 30
    s_add_u32 s6, s6, s5
    s_lshl_b32 s72, s6, 18
    s_add_u32 s72, s72, 33566720
    s_lshl_b32 s6, s6, 2
    s_add_u32 s6, s6, 3
    s_lshl_b32 s69, s6, 9
    s_add_u32 s69, s69, 58785792
    s_mul_i32 s73, s64, 192
    s_add_u32 s73, s73, 144
    s_mul_i32 s66, s64, 3
    s_mul_i32 s6, s65, 2
    s_add_u32 s66, s66, s6
    v_bfe_u32 v56, v247, 2, 2
    v_lshrrev_b32 v58, 4, v247
    v_lshl_add_u32 v59, v58, 2, v56
    v_lshlrev_b32 v59, 8, v59
    v_and_b32 v58, 1, v58
    v_lshlrev_b32 v58, 1, v58
    v_lshl_add_u32 v58, v56, 2, v58
    v_bfe_u32 v60, v247, 1, 1
    v_xor_b32 v58, v58, v60
    v_lshl_add_u32 v59, v58, 4, v59
    v_and_b32 v57, 1, v247
    v_lshl_add_u32 v59, v57, 3, v59
    v_xor_b32 v48, 0, v59
    v_xor_b32 v49, 32, v59
    v_xor_b32 v50, 64, v59
    v_xor_b32 v51, 96, v59
    v_xor_b32 v52, 128, v59
    v_xor_b32 v53, 160, v59
    v_xor_b32 v54, 192, v59
    v_xor_b32 v55, 224, v59
    s_mul_i32 s6, s73, 7282
    s_lshr_b32 s6, s6, 20
    s_and_b32 s6, s6, 7
    s_lshl_b32 s6, s6, 7
    v_lshlrev_b32 v44, 3, v246
    v_and_b32 v44, 3072, v44
    v_add_u32 v44, s6, v44
    v_pk_mov_b32 v[0:1], 0, 0
    v_pk_mov_b32 v[2:3], 0, 0
    v_pk_mov_b32 v[4:5], 0, 0
    v_pk_mov_b32 v[6:7], 0, 0
    v_pk_mov_b32 v[8:9], 0, 0
    v_pk_mov_b32 v[10:11], 0, 0
    v_pk_mov_b32 v[12:13], 0, 0
    v_pk_mov_b32 v[14:15], 0, 0
    v_pk_mov_b32 v[16:17], 0, 0
    v_pk_mov_b32 v[18:19], 0, 0
    v_pk_mov_b32 v[20:21], 0, 0
    v_pk_mov_b32 v[22:23], 0, 0
    v_pk_mov_b32 v[24:25], 0, 0
    v_pk_mov_b32 v[26:27], 0, 0
    v_pk_mov_b32 v[28:29], 0, 0
    v_pk_mov_b32 v[30:31], 0, 0
    s_waitcnt vmcnt(1)
    s_mov_b32 s42, 0
L_qpw:
    s_barrier
    s_add_u32 s42, s42, 1
    s_cmp_lt_u32 s42, 21
    s_cbranch_scc1 L_qpw
    s_waitcnt vmcnt(0)
    v_mov_b32 v224, 0
    v_mov_b32 v225, 0
    v_mov_b32 v226, 0
    v_mov_b32 v227, 0
    s_waitcnt lgkmcnt(0)
    s_barrier
    ds_read_b128 v[128:131], v248
    ds_read_b128 v[132:135], v248 offset:1024
    ds_read_b128 v[136:139], v248 offset:2048
    ds_read_b128 v[140:143], v248 offset:3072
    ds_read_b128 v[160:163], v232
    ds_read_b128 v[164:167], v233
    ds_read_b128 v[168:171], v234
    ds_read_b128 v[172:175], v235
    ds_read_b128 v[176:179], v232 offset:4096
    ds_read_b128 v[180:183], v233 offset:4096
    ds_read_b128 v[184:187], v234 offset:4096
    ds_read_b128 v[188:191], v235 offset:4096
    ds_read_b128 v[192:195], v232 offset:8192
    ds_read_b128 v[196:199], v233 offset:8192
    ds_read_b128 v[200:203], v234 offset:8192
    ds_read_b128 v[204:207], v235 offset:8192
    ds_read_b128 v[208:211], v232 offset:12288
    ds_read_b128 v[212:215], v233 offset:12288
    ds_read_b128 v[216:219], v234 offset:12288
    ds_read_b128 v[220:223], v235 offset:12288
    v_add_u32 v232, 16384, v232
    v_add_u32 v233, 16384, v233
    v_add_u32 v234, 16384, v234
    v_add_u32 v235, 16384, v235
    s_waitcnt lgkmcnt(15)
    v_mfma_f32_16x16x32_bf16 v[64:67], v[160:163], v[128:131], v[224:227]
    s_waitcnt lgkmcnt(14)
    v_mfma_f32_16x16x32_bf16 v[64:67], v[164:167], v[132:135], v[64:67]
    s_waitcnt lgkmcnt(13)
    v_mfma_f32_16x16x32_bf16 v[64:67], v[168:171], v[136:139], v[64:67]
    s_waitcnt lgkmcnt(12)
    v_mfma_f32_16x16x32_bf16 v[64:67], v[172:175], v[140:143], v[64:67]
    s_waitcnt lgkmcnt(11)
    v_mfma_f32_16x16x32_bf16 v[68:71], v[176:179], v[128:131], v[224:227]
    s_waitcnt lgkmcnt(10)
    v_mfma_f32_16x16x32_bf16 v[68:71], v[180:183], v[132:135], v[68:71]
    s_waitcnt lgkmcnt(9)
    v_mfma_f32_16x16x32_bf16 v[68:71], v[184:187], v[136:139], v[68:71]
    s_waitcnt lgkmcnt(8)
    v_mfma_f32_16x16x32_bf16 v[68:71], v[188:191], v[140:143], v[68:71]
    s_waitcnt lgkmcnt(7)
    v_mfma_f32_16x16x32_bf16 v[72:75], v[192:195], v[128:131], v[224:227]
    s_waitcnt lgkmcnt(6)
    v_mfma_f32_16x16x32_bf16 v[72:75], v[196:199], v[132:135], v[72:75]
    s_waitcnt lgkmcnt(5)
    v_mfma_f32_16x16x32_bf16 v[72:75], v[200:203], v[136:139], v[72:75]
    s_waitcnt lgkmcnt(4)
    v_mfma_f32_16x16x32_bf16 v[72:75], v[204:207], v[140:143], v[72:75]
    s_waitcnt lgkmcnt(3)
    v_mfma_f32_16x16x32_bf16 v[76:79], v[208:211], v[128:131], v[224:227]
    s_waitcnt lgkmcnt(2)
    v_mfma_f32_16x16x32_bf16 v[76:79], v[212:215], v[132:135], v[76:79]
    s_waitcnt lgkmcnt(1)
    v_mfma_f32_16x16x32_bf16 v[76:79], v[216:219], v[136:139], v[76:79]
    s_waitcnt lgkmcnt(0)
    v_mfma_f32_16x16x32_bf16 v[76:79], v[220:223], v[140:143], v[76:79]
    v_readfirstlane_b32 s4, v40
    s_nop 0
    s_cmp_eq_u32 s4, 0
    s_cselect_b32 s62, s62, s4
    v_mov_b32 v40, 163824
    v_mov_b32 v41, s62
    ds_write_b32 v40, v41
    s_and_b32 s4, s2, 7
    s_lshl_b32 s67, s4, 13
    s_add_u32 s67, s67, 58720256
    s_mov_b32 s42, 0
    s_waitcnt lgkmcnt(0)
    s_barrier
    ds_read_b128 v[160:163], v232
    ds_read_b128 v[164:167], v233
    ds_read_b128 v[168:171], v234
    ds_read_b128 v[172:175], v235
    ds_read_b128 v[176:179], v232 offset:4096
    ds_read_b128 v[180:183], v233 offset:4096
    ds_read_b128 v[184:187], v234 offset:4096
    ds_read_b128 v[188:191], v235 offset:4096
    ds_read_b128 v[192:195], v232 offset:8192
    ds_read_b128 v[196:199], v233 offset:8192
    ds_read_b128 v[200:203], v234 offset:8192
    ds_read_b128 v[204:207], v235 offset:8192
    ds_read_b128 v[208:211], v232 offset:12288
    ds_read_b128 v[212:215], v233 offset:12288
    ds_read_b128 v[216:219], v234 offset:12288
    ds_read_b128 v[220:223], v235 offset:12288
    v_max3_f32 v248, v64, v65, v66
    v_max3_f32 v248, v248, v67, v68
    v_max3_f32 v248, v248, v69, v70
    v_max3_f32 v248, v248, v71, v72
    v_max3_f32 v248, v248, v73, v74
    v_max3_f32 v248, v248, v75, v76
    v_max3_f32 v248, v248, v77, v78
    v_max_f32 v248, v248, v79
    v_mov_b32 v249, v248
    s_nop 1
    v_permlane16_swap_b32 v248, v249
    v_max_f32 v248, v248, v249
    v_mov_b32 v249, v248
    s_nop 1
    v_permlane32_swap_b32 v248, v249
    v_max_f32 v248, v248, v249
    v_sub_f32 v64, v64, v248
    v_sub_f32 v65, v65, v248
    v_sub_f32 v66, v66, v248
    v_sub_f32 v67, v67, v248
    v_sub_f32 v68, v68, v248
    v_sub_f32 v69, v69, v248
    v_sub_f32 v70, v70, v248
    v_sub_f32 v71, v71, v248
    v_sub_f32 v72, v72, v248
    v_sub_f32 v73, v73, v248
    v_sub_f32 v74, v74, v248
    v_sub_f32 v75, v75, v248
    v_sub_f32 v76, v76, v248
    v_sub_f32 v77, v77, v248
    v_sub_f32 v78, v78, v248
    v_sub_f32 v79, v79, v248
    v_sub_f32 v224, v224, v248
    v_sub_f32 v225, v225, v248
    v_sub_f32 v226, v226, v248
    v_sub_f32 v227, v227, v248
    s_setprio 1
    s_nop 1
.p2align 3
L_loop_a1:
    s_add_u32 s45, s45, 1
    s_cmp_eq_u32 s45, 3
    s_cselect_b32 s43, -32768, s75
    s_cselect_b32 s45, 0, s45
    s_add_u32 s46, s46, 1
    s_cmp_eq_u32 s46, 3
    s_cselect_b32 s44, -32768, s75
    s_cselect_b32 s46, 0, s46
    s_waitcnt lgkmcnt(15)
    v_mfma_f32_16x16x32_bf16 v[96:99], v[160:163], v[128:131], v[224:227]
    ds_read_b64_tr_b16 v[160:161], v236
    ds_read_b64_tr_b16 v[162:163], v236 offset:4096
    v_exp_f32 v64, v64
    v_exp_f32 v65, v65
    s_waitcnt lgkmcnt(15)
    v_mfma_f32_16x16x32_bf16 v[96:99], v[164:167], v[132:135], v[96:99]
    ds_read_b64_tr_b16 v[164:165], v237
    ds_read_b64_tr_b16 v[166:167], v237 offset:4096
    v_add_f32 v244, v244, v64
    v_mfma_f32_16x16x32_bf16 v[96:99], v[168:171], v[136:139], v[96:99]
    ds_read_b64_tr_b16 v[168:169], v238
    ds_read_b64_tr_b16 v[170:171], v238 offset:4096
    v_exp_f32 v66, v66
    s_waitcnt lgkmcnt(15)
    v_mfma_f32_16x16x32_bf16 v[96:99], v[172:175], v[140:143], v[96:99]
    ds_read_b64_tr_b16 v[172:173], v239
    ds_read_b64_tr_b16 v[174:175], v239 offset:4096
    v_add_f32 v244, v244, v65
    v_exp_f32 v67, v67
    v_mfma_f32_16x16x32_bf16 v[100:103], v[176:179], v[128:131], v[224:227]
    ds_read_b64_tr_b16 v[176:177], v240
    ds_read_b64_tr_b16 v[178:179], v240 offset:4096
    v_cvt_pk_bf16_f32 v64, v64, v65
    v_mfma_f32_16x16x32_bf16 v[100:103], v[180:183], v[132:135], v[100:103]
    ds_read_b64_tr_b16 v[180:181], v241
    ds_read_b64_tr_b16 v[182:183], v241 offset:4096
    v_add_f32 v244, v244, v66
    v_exp_f32 v68, v68
    v_mfma_f32_16x16x32_bf16 v[100:103], v[184:187], v[136:139], v[100:103]
    ds_read_b64_tr_b16 v[184:185], v242
    ds_read_b64_tr_b16 v[186:187], v242 offset:4096
    v_add_f32 v244, v244, v67
    s_waitcnt lgkmcnt(15)
    v_mfma_f32_16x16x32_bf16 v[100:103], v[188:191], v[140:143], v[100:103]
    ds_read_b64_tr_b16 v[188:189], v243
    ds_read_b64_tr_b16 v[190:191], v243 offset:4096
    v_exp_f32 v69, v69
    v_mfma_f32_16x16x32_bf16 v[104:107], v[192:195], v[128:131], v[224:227]
    ds_read_b64_tr_b16 v[192:193], v236 offset:8192
    ds_read_b64_tr_b16 v[194:195], v236 offset:12288
    v_cvt_pk_bf16_f32 v65, v66, v67
    v_add_f32 v244, v244, v68
    v_mfma_f32_16x16x32_bf16 v[104:107], v[196:199], v[132:135], v[104:107]
    ds_read_b64_tr_b16 v[196:197], v237 offset:8192
    ds_read_b64_tr_b16 v[198:199], v237 offset:12288
    v_exp_f32 v70, v70
    v_mfma_f32_16x16x32_bf16 v[104:107], v[200:203], v[136:139], v[104:107]
    ds_read_b64_tr_b16 v[200:201], v238 offset:8192
    ds_read_b64_tr_b16 v[202:203], v238 offset:12288
    v_add_f32 v244, v244, v69
    v_exp_f32 v71, v71
    v_mfma_f32_16x16x32_bf16 v[104:107], v[204:207], v[140:143], v[104:107]
    ds_read_b64_tr_b16 v[204:205], v239 offset:8192
    ds_read_b64_tr_b16 v[206:207], v239 offset:12288
    v_cvt_pk_bf16_f32 v66, v68, v69
    v_mfma_f32_16x16x32_bf16 v[108:111], v[208:211], v[128:131], v[224:227]
    v_add_f32 v244, v244, v70
    v_add_f32 v244, v244, v71
    v_cvt_pk_bf16_f32 v67, v70, v71
    ds_read_b64_tr_b16 v[208:209], v240 offset:8192
    v_mfma_f32_16x16x32_bf16 v[108:111], v[212:215], v[132:135], v[108:111]
    ds_read_b64_tr_b16 v[210:211], v240 offset:12288
    ds_read_b64_tr_b16 v[212:213], v241 offset:8192
    ds_read_b64_tr_b16 v[214:215], v241 offset:12288
    v_add_u32 v232, s43, v232
    v_mfma_f32_16x16x32_bf16 v[108:111], v[216:219], v[136:139], v[108:111]
    ds_read_b64_tr_b16 v[216:217], v242 offset:8192
    ds_read_b64_tr_b16 v[218:219], v242 offset:12288
    v_add_u32 v233, s43, v233
    v_add_u32 v234, s43, v234
    s_waitcnt lgkmcnt(15)
    v_mfma_f32_16x16x32_bf16 v[108:111], v[220:223], v[140:143], v[108:111]
    ds_read_b64_tr_b16 v[220:221], v243 offset:8192
    ds_read_b64_tr_b16 v[222:223], v243 offset:12288
    v_add_u32 v235, s43, v235
    v_exp_f32 v72, v72
    s_cmp_eq_u32 s42, 7
    s_cbranch_scc1 L_q2_a1
L_q2b_a1:
    v_mfma_f32_16x16x32_bf16 v[0:3], v[160:163], v[64:67], v[0:3]
    v_exp_f32 v73, v73
    v_add_f32 v244, v244, v72
    v_mfma_f32_16x16x32_bf16 v[4:7], v[164:167], v[64:67], v[4:7]
    v_exp_f32 v74, v74
    v_add_f32 v244, v244, v73
    v_exp_f32 v75, v75
    v_mfma_f32_16x16x32_bf16 v[8:11], v[168:171], v[64:67], v[8:11]
    v_cvt_pk_bf16_f32 v72, v72, v73
    v_add_f32 v244, v244, v74
    v_exp_f32 v76, v76
    v_mfma_f32_16x16x32_bf16 v[12:15], v[172:175], v[64:67], v[12:15]
    v_add_f32 v244, v244, v75
    v_exp_f32 v77, v77
    v_mfma_f32_16x16x32_bf16 v[16:19], v[176:179], v[64:67], v[16:19]
    s_waitcnt lgkmcnt(0)
    s_barrier
    ds_read_b128 v[160:163], v232
    ds_read_b128 v[164:167], v233
    ds_read_b128 v[168:171], v234
    v_mfma_f32_16x16x32_bf16 v[20:23], v[180:183], v[64:67], v[20:23]
    ds_read_b128 v[172:175], v235
    ds_read_b128 v[176:179], v232 offset:4096
    ds_read_b128 v[180:183], v233 offset:4096
    v_cvt_pk_bf16_f32 v73, v74, v75
    v_mfma_f32_16x16x32_bf16 v[24:27], v[184:187], v[64:67], v[24:27]
    v_add_f32 v244, v244, v76
    v_exp_f32 v78, v78
    v_add_f32 v244, v244, v77
    v_exp_f32 v79, v79
    v_cvt_pk_bf16_f32 v74, v76, v77
    v_add_f32 v244, v244, v78
    v_add_f32 v244, v244, v79
    v_cvt_pk_bf16_f32 v75, v78, v79
    v_mfma_f32_16x16x32_bf16 v[28:31], v[188:191], v[64:67], v[28:31]
    ds_read_b128 v[184:187], v234 offset:4096
    v_mfma_f32_16x16x32_bf16 v[0:3], v[192:195], v[72:75], v[0:3]
    ds_read_b128 v[188:191], v235 offset:4096
    v_mfma_f32_16x16x32_bf16 v[4:7], v[196:199], v[72:75], v[4:7]
    ds_read_b128 v[192:195], v232 offset:8192
    ds_read_b128 v[196:199], v233 offset:8192
    v_max3_f32 v248, v96, v97, v98
    v_max3_f32 v248, v248, v99, v100
    v_mfma_f32_16x16x32_bf16 v[8:11], v[200:203], v[72:75], v[8:11]
    ds_read_b128 v[200:203], v234 offset:8192
    v_max3_f32 v248, v248, v101, v102
    v_max3_f32 v248, v248, v103, v104
    v_max3_f32 v248, v248, v105, v106
    v_mfma_f32_16x16x32_bf16 v[12:15], v[204:207], v[72:75], v[12:15]
    ds_read_b128 v[204:207], v235 offset:8192
    v_max3_f32 v248, v248, v107, v108
    v_max3_f32 v248, v248, v109, v110
    v_max_f32 v248, v248, v111
    v_mfma_f32_16x16x32_bf16 v[16:19], v[208:211], v[72:75], v[16:19]
    ds_read_b128 v[208:211], v232 offset:12288
    v_add_u32 v236, s44, v236
    v_add_u32 v237, s44, v237
    v_add_u32 v238, s44, v238
    v_mfma_f32_16x16x32_bf16 v[20:23], v[212:215], v[72:75], v[20:23]
    ds_read_b128 v[212:215], v233 offset:12288
    v_add_u32 v239, s44, v239
    v_add_u32 v240, s44, v240
    v_add_u32 v241, s44, v241
    v_mfma_f32_16x16x32_bf16 v[24:27], v[216:219], v[72:75], v[24:27]
    ds_read_b128 v[216:219], v234 offset:12288
    v_add_u32 v242, s44, v242
    v_add_u32 v243, s44, v243
    v_mfma_f32_16x16x32_bf16 v[28:31], v[220:223], v[72:75], v[28:31]
    ds_read_b128 v[220:223], v235 offset:12288
L_ja_a1:
    v_cmp_lt_f32 vcc, s41, v248
    s_nop 0
    s_cbranch_vccnz L_rare_a1a
L_back_a1a:
    s_add_u32 s45, s45, 1
    s_cmp_eq_u32 s45, 3
    s_cselect_b32 s43, -32768, s75
    s_cselect_b32 s45, 0, s45
    s_add_u32 s46, s46, 1
    s_cmp_eq_u32 s46, 3
    s_cselect_b32 s44, -32768, s75
    s_cselect_b32 s46, 0, s46
    s_waitcnt lgkmcnt(15)
    v_mfma_f32_16x16x32_bf16 v[64:67], v[160:163], v[128:131], v[224:227]
    ds_read_b64_tr_b16 v[160:161], v236
    ds_read_b64_tr_b16 v[162:163], v236 offset:4096
    v_exp_f32 v96, v96
    v_exp_f32 v97, v97
    s_waitcnt lgkmcnt(15)
    v_mfma_f32_16x16x32_bf16 v[64:67], v[164:167], v[132:135], v[64:67]
    ds_read_b64_tr_b16 v[164:165], v237
    ds_read_b64_tr_b16 v[166:167], v237 offset:4096
    v_add_f32 v244, v244, v96
    v_mfma_f32_16x16x32_bf16 v[64:67], v[168:171], v[136:139], v[64:67]
    ds_read_b64_tr_b16 v[168:169], v238
    ds_read_b64_tr_b16 v[170:171], v238 offset:4096
    v_exp_f32 v98, v98
    s_waitcnt lgkmcnt(15)
    v_mfma_f32_16x16x32_bf16 v[64:67], v[172:175], v[140:143], v[64:67]
    ds_read_b64_tr_b16 v[172:173], v239
    ds_read_b64_tr_b16 v[174:175], v239 offset:4096
    v_add_f32 v244, v244, v97
    v_exp_f32 v99, v99
    v_mfma_f32_16x16x32_bf16 v[68:71], v[176:179], v[128:131], v[224:227]
    ds_read_b64_tr_b16 v[176:177], v240
    ds_read_b64_tr_b16 v[178:179], v240 offset:4096
    v_cvt_pk_bf16_f32 v96, v96, v97
    v_mfma_f32_16x16x32_bf16 v[68:71], v[180:183], v[132:135], v[68:71]
    ds_read_b64_tr_b16 v[180:181], v241
    ds_read_b64_tr_b16 v[182:183], v241 offset:4096
    v_add_f32 v244, v244, v98
    v_exp_f32 v100, v100
    v_mfma_f32_16x16x32_bf16 v[68:71], v[184:187], v[136:139], v[68:71]
    ds_read_b64_tr_b16 v[184:185], v242
    ds_read_b64_tr_b16 v[186:187], v242 offset:4096
    v_add_f32 v244, v244, v99
    s_waitcnt lgkmcnt(15)
    v_mfma_f32_16x16x32_bf16 v[68:71], v[188:191], v[140:143], v[68:71]
    ds_read_b64_tr_b16 v[188:189], v243
    ds_read_b64_tr_b16 v[190:191], v243 offset:4096
    v_exp_f32 v101, v101
    v_mfma_f32_16x16x32_bf16 v[72:75], v[192:195], v[128:131], v[224:227]
    ds_read_b64_tr_b16 v[192:193], v236 offset:8192
    ds_read_b64_tr_b16 v[194:195], v236 offset:12288
    v_cvt_pk_bf16_f32 v97, v98, v99
    v_add_f32 v244, v244, v100
    v_mfma_f32_16x16x32_bf16 v[72:75], v[196:199], v[132:135], v[72:75]
    ds_read_b64_tr_b16 v[196:197], v237 offset:8192
    ds_read_b64_tr_b16 v[198:199], v237 offset:12288
    v_exp_f32 v102, v102
    v_mfma_f32_16x16x32_bf16 v[72:75], v[200:203], v[136:139], v[72:75]
    ds_read_b64_tr_b16 v[200:201], v238 offset:8192
    ds_read_b64_tr_b16 v[202:203], v238 offset:12288
    v_add_f32 v244, v244, v101
    v_exp_f32 v103, v103
    v_mfma_f32_16x16x32_bf16 v[72:75], v[204:207], v[140:143], v[72:75]
    ds_read_b64_tr_b16 v[204:205], v239 offset:8192
    ds_read_b64_tr_b16 v[206:207], v239 offset:12288
    v_cvt_pk_bf16_f32 v98, v100, v101
    v_mfma_f32_16x16x32_bf16 v[76:79], v[208:211], v[128:131], v[224:227]
    v_add_f32 v244, v244, v102
    v_add_f32 v244, v244, v103
    v_cvt_pk_bf16_f32 v99, v102, v103
    ds_read_b64_tr_b16 v[208:209], v240 offset:8192
    v_mfma_f32_16x16x32_bf16 v[76:79], v[212:215], v[132:135], v[76:79]
    ds_read_b64_tr_b16 v[210:211], v240 offset:12288
    ds_read_b64_tr_b16 v[212:213], v241 offset:8192
    ds_read_b64_tr_b16 v[214:215], v241 offset:12288
    v_add_u32 v232, s43, v232
    v_mfma_f32_16x16x32_bf16 v[76:79], v[216:219], v[136:139], v[76:79]
    ds_read_b64_tr_b16 v[216:217], v242 offset:8192
    ds_read_b64_tr_b16 v[218:219], v242 offset:12288
    v_add_u32 v233, s43, v233
    v_add_u32 v234, s43, v234
    s_waitcnt lgkmcnt(15)
    v_mfma_f32_16x16x32_bf16 v[76:79], v[220:223], v[140:143], v[76:79]
    ds_read_b64_tr_b16 v[220:221], v243 offset:8192
    ds_read_b64_tr_b16 v[222:223], v243 offset:12288
    v_add_u32 v235, s43, v235
    v_exp_f32 v104, v104
    v_mfma_f32_16x16x32_bf16 v[0:3], v[160:163], v[96:99], v[0:3]
    v_exp_f32 v105, v105
    v_add_f32 v244, v244, v104
    v_mfma_f32_16x16x32_bf16 v[4:7], v[164:167], v[96:99], v[4:7]
    v_exp_f32 v106, v106
    v_add_f32 v244, v244, v105
    v_exp_f32 v107, v107
    v_mfma_f32_16x16x32_bf16 v[8:11], v[168:171], v[96:99], v[8:11]
    v_cvt_pk_bf16_f32 v104, v104, v105
    v_add_f32 v244, v244, v106
    v_exp_f32 v108, v108
    v_mfma_f32_16x16x32_bf16 v[12:15], v[172:175], v[96:99], v[12:15]
    v_add_f32 v244, v244, v107
    v_exp_f32 v109, v109
    v_mfma_f32_16x16x32_bf16 v[16:19], v[176:179], v[96:99], v[16:19]
    s_waitcnt vmcnt(0) lgkmcnt(0)
    s_barrier
    ds_read_b128 v[160:163], v232
    ds_read_b128 v[164:167], v233
    ds_read_b128 v[168:171], v234
    v_mfma_f32_16x16x32_bf16 v[20:23], v[180:183], v[96:99], v[20:23]
    ds_read_b128 v[172:175], v235
    ds_read_b128 v[176:179], v232 offset:4096
    ds_read_b128 v[180:183], v233 offset:4096
    v_cvt_pk_bf16_f32 v105, v106, v107
    v_mfma_f32_16x16x32_bf16 v[24:27], v[184:187], v[96:99], v[24:27]
    v_add_f32 v244, v244, v108
    v_exp_f32 v110, v110
    v_add_f32 v244, v244, v109
    v_exp_f32 v111, v111
    v_cvt_pk_bf16_f32 v106, v108, v109
    v_add_f32 v244, v244, v110
    v_add_f32 v244, v244, v111
    v_cvt_pk_bf16_f32 v107, v110, v111
    v_mfma_f32_16x16x32_bf16 v[28:31], v[188:191], v[96:99], v[28:31]
    ds_read_b128 v[184:187], v234 offset:4096
    v_mfma_f32_16x16x32_bf16 v[0:3], v[192:195], v[104:107], v[0:3]
    ds_read_b128 v[188:191], v235 offset:4096
    v_mfma_f32_16x16x32_bf16 v[4:7], v[196:199], v[104:107], v[4:7]
    ds_read_b128 v[192:195], v232 offset:8192
    ds_read_b128 v[196:199], v233 offset:8192
    v_max3_f32 v248, v64, v65, v66
    v_max3_f32 v248, v248, v67, v68
    v_mfma_f32_16x16x32_bf16 v[8:11], v[200:203], v[104:107], v[8:11]
    ds_read_b128 v[200:203], v234 offset:8192
    v_max3_f32 v248, v248, v69, v70
    v_max3_f32 v248, v248, v71, v72
    v_max3_f32 v248, v248, v73, v74
    v_mfma_f32_16x16x32_bf16 v[12:15], v[204:207], v[104:107], v[12:15]
    ds_read_b128 v[204:207], v235 offset:8192
    v_max3_f32 v248, v248, v75, v76
    v_max3_f32 v248, v248, v77, v78
    v_max_f32 v248, v248, v79
    v_mfma_f32_16x16x32_bf16 v[16:19], v[208:211], v[104:107], v[16:19]
    ds_read_b128 v[208:211], v232 offset:12288
    v_add_u32 v236, s44, v236
    v_add_u32 v237, s44, v237
    v_add_u32 v238, s44, v238
    v_mfma_f32_16x16x32_bf16 v[20:23], v[212:215], v[104:107], v[20:23]
    ds_read_b128 v[212:215], v233 offset:12288
    v_add_u32 v239, s44, v239
    v_add_u32 v240, s44, v240
    v_add_u32 v241, s44, v241
    v_mfma_f32_16x16x32_bf16 v[24:27], v[216:219], v[104:107], v[24:27]
    ds_read_b128 v[216:219], v234 offset:12288
    v_add_u32 v242, s44, v242
    v_add_u32 v243, s44, v243
    v_mfma_f32_16x16x32_bf16 v[28:31], v[220:223], v[104:107], v[28:31]
    ds_read_b128 v[220:223], v235 offset:12288
    s_add_u32 s42, s42, 1
    s_cmp_eq_u32 s42, 9
    s_cbranch_scc1 L_s1_a1
L_s1b_a1:
    s_cmp_eq_u32 s42, 15
    s_cbranch_scc1 L_p1_a1
L_p1b_a1:
    s_and_b32 s4, s42, 7
    s_cmp_eq_u32 s4, 0
    s_cbranch_scc1 L_sw_a1
    v_cmp_lt_f32 vcc, s41, v248
    s_nop 0
    s_cbranch_vccnz L_rare_a1b
L_back_a1b:
    s_branch L_loop_a1
L_sw_a1:
    s_cmp_eq_u32 s42, 16
    s_cbranch_scc1 L_fin_a1
    v_mov_b32 v249, v248
    s_nop 1
    v_permlane16_swap_b32 v248, v249
    v_max_f32 v248, v248, v249
    v_mov_b32 v249, v248
    s_nop 1
    v_permlane32_swap_b32 v248, v249
    v_max_f32 v248, v248, v249
    v_sub_f32 v64, v64, v248
    v_sub_f32 v65, v65, v248
    v_sub_f32 v66, v66, v248
    v_sub_f32 v67, v67, v248
    v_sub_f32 v68, v68, v248
    v_sub_f32 v69, v69, v248
    v_sub_f32 v70, v70, v248
    v_sub_f32 v71, v71, v248
    v_sub_f32 v72, v72, v248
    v_sub_f32 v73, v73, v248
    v_sub_f32 v74, v74, v248
    v_sub_f32 v75, v75, v248
    v_sub_f32 v76, v76, v248
    v_sub_f32 v77, v77, v248
    v_sub_f32 v78, v78, v248
    v_sub_f32 v79, v79, v248
    v_sub_f32 v224, v224, v248
    v_sub_f32 v225, v225, v248
    v_sub_f32 v226, v226, v248
    v_sub_f32 v227, v227, v248
    v_mov_b32 v249, v244
    s_nop 1
    v_permlane16_swap_b32 v244, v249
    v_add_f32 v244, v244, v249
    v_mov_b32 v249, v244
    s_nop 1
    v_permlane32_swap_b32 v244, v249
    v_add_f32 v244, v244, v249
    v_rcp_f32 v248, v244
    v_mov_b32 v244, 0
    s_add_u32 s45, s45, 1
    s_cmp_eq_u32 s45, 3
    s_cselect_b32 s43, -32768, s75
    s_cselect_b32 s45, 0, s45
    s_add_u32 s46, s46, 1
    s_cmp_eq_u32 s46, 3
    s_cselect_b32 s44, -32768, s75
    s_cselect_b32 s46, 0, s46
    s_waitcnt lgkmcnt(15)
    v_mfma_f32_16x16x32_bf16 v[96:99], v[160:163], v[128:131], v[224:227]
    ds_read_b64_tr_b16 v[160:161], v236
    ds_read_b64_tr_b16 v[162:163], v236 offset:4096
    v_exp_f32 v64, v64
    v_exp_f32 v65, v65
    s_waitcnt lgkmcnt(15)
    v_mfma_f32_16x16x32_bf16 v[96:99], v[164:167], v[132:135], v[96:99]
    ds_read_b64_tr_b16 v[164:165], v237
    ds_read_b64_tr_b16 v[166:167], v237 offset:4096
    v_add_f32 v244, v244, v64
    v_exp_f32 v66, v66
    v_add_f32 v244, v244, v65
    v_mfma_f32_16x16x32_bf16 v[96:99], v[168:171], v[136:139], v[96:99]
    ds_read_b64_tr_b16 v[168:169], v238
    ds_read_b64_tr_b16 v[170:171], v238 offset:4096
    v_exp_f32 v67, v67
    v_cvt_pk_bf16_f32 v64, v64, v65
    v_add_f32 v244, v244, v66
    s_waitcnt lgkmcnt(15)
    v_mfma_f32_16x16x32_bf16 v[96:99], v[172:175], v[140:143], v[96:99]
    ds_read_b64_tr_b16 v[172:173], v239
    ds_read_b64_tr_b16 v[174:175], v239 offset:4096
    v_exp_f32 v68, v68
    v_add_f32 v244, v244, v67
    v_exp_f32 v69, v69
    v_mfma_f32_16x16x32_bf16 v[100:103], v[176:179], v[128:131], v[224:227]
    ds_read_b64_tr_b16 v[176:177], v240
    ds_read_b64_tr_b16 v[178:179], v240 offset:4096
    v_cvt_pk_bf16_f32 v65, v66, v67
    v_add_f32 v244, v244, v68
    v_exp_f32 v70, v70
    v_mfma_f32_16x16x32_bf16 v[100:103], v[180:183], v[132:135], v[100:103]
    ds_read_b64_tr_b16 v[180:181], v241
    ds_read_b64_tr_b16 v[182:183], v241 offset:4096
    v_add_f32 v244, v244, v69
    v_exp_f32 v71, v71
    v_mfma_f32_16x16x32_bf16 v[100:103], v[184:187], v[136:139], v[100:103]
    ds_read_b64_tr_b16 v[184:185], v242
    ds_read_b64_tr_b16 v[186:187], v242 offset:4096
    v_cvt_pk_bf16_f32 v66, v68, v69
    v_add_f32 v244, v244, v70
    v_add_f32 v244, v244, v71
    v_cvt_pk_bf16_f32 v67, v70, v71
    s_waitcnt lgkmcnt(15)
    v_mfma_f32_16x16x32_bf16 v[100:103], v[188:191], v[140:143], v[100:103]
    ds_read_b64_tr_b16 v[188:189], v243
    ds_read_b64_tr_b16 v[190:191], v243 offset:4096
    v_pk_mul_f32 v[0:1], v[0:1], v[248:249] op_sel_hi:[1,0]
    v_pk_mul_f32 v[2:3], v[2:3], v[248:249] op_sel_hi:[1,0]
    v_pk_mul_f32 v[4:5], v[4:5], v[248:249] op_sel_hi:[1,0]
    v_pk_mul_f32 v[6:7], v[6:7], v[248:249] op_sel_hi:[1,0]
    v_mfma_f32_16x16x32_bf16 v[104:107], v[192:195], v[128:131], v[224:227]
    ds_read_b64_tr_b16 v[192:193], v236 offset:8192
    ds_read_b64_tr_b16 v[194:195], v236 offset:12288
    v_cvt_pk_bf16_f32 v0, v0, v1
    v_cvt_pk_bf16_f32 v1, v2, v3
    v_cvt_pk_bf16_f32 v2, v4, v5
    v_cvt_pk_bf16_f32 v3, v6, v7
    v_mfma_f32_16x16x32_bf16 v[104:107], v[196:199], v[132:135], v[104:107]
    ds_read_b64_tr_b16 v[196:197], v237 offset:8192
    ds_read_b64_tr_b16 v[198:199], v237 offset:12288
    buffer_store_dwordx4 v[0:3], v246, s[24:27], s47 offen sc0 sc1
    v_pk_mul_f32 v[8:9], v[8:9], v[248:249] op_sel_hi:[1,0]
    v_pk_mul_f32 v[10:11], v[10:11], v[248:249] op_sel_hi:[1,0]
    v_pk_mul_f32 v[12:13], v[12:13], v[248:249] op_sel_hi:[1,0]
    v_mfma_f32_16x16x32_bf16 v[104:107], v[200:203], v[136:139], v[104:107]
    ds_read_b64_tr_b16 v[200:201], v238 offset:8192
    ds_read_b64_tr_b16 v[202:203], v238 offset:12288
    v_pk_mul_f32 v[14:15], v[14:15], v[248:249] op_sel_hi:[1,0]
    v_cvt_pk_bf16_f32 v8, v8, v9
    v_cvt_pk_bf16_f32 v9, v10, v11
    v_cvt_pk_bf16_f32 v10, v12, v13
    v_mfma_f32_16x16x32_bf16 v[104:107], v[204:207], v[140:143], v[104:107]
    ds_read_b64_tr_b16 v[204:205], v239 offset:8192
    ds_read_b64_tr_b16 v[206:207], v239 offset:12288
    v_cvt_pk_bf16_f32 v11, v14, v15
    buffer_store_dwordx4 v[8:11], v246, s[24:27], s47 offen offset:1024 sc0 sc1
    v_pk_mul_f32 v[16:17], v[16:17], v[248:249] op_sel_hi:[1,0]
    v_pk_mul_f32 v[18:19], v[18:19], v[248:249] op_sel_hi:[1,0]
    v_mfma_f32_16x16x32_bf16 v[108:111], v[208:211], v[128:131], v[224:227]
    v_pk_mul_f32 v[20:21], v[20:21], v[248:249] op_sel_hi:[1,0]
    v_pk_mul_f32 v[22:23], v[22:23], v[248:249] op_sel_hi:[1,0]
    v_cvt_pk_bf16_f32 v16, v16, v17
    v_cvt_pk_bf16_f32 v17, v18, v19
    v_cvt_pk_bf16_f32 v18, v20, v21
    v_cvt_pk_bf16_f32 v19, v22, v23
    v_mfma_f32_16x16x32_bf16 v[108:111], v[212:215], v[132:135], v[108:111]
    buffer_store_dwordx4 v[16:19], v246, s[24:27], s47 offen offset:2048 sc0 sc1
    v_pk_mul_f32 v[24:25], v[24:25], v[248:249] op_sel_hi:[1,0]
    v_pk_mul_f32 v[26:27], v[26:27], v[248:249] op_sel_hi:[1,0]
    v_pk_mul_f32 v[28:29], v[28:29], v[248:249] op_sel_hi:[1,0]
    v_pk_mul_f32 v[30:31], v[30:31], v[248:249] op_sel_hi:[1,0]
    v_cvt_pk_bf16_f32 v24, v24, v25
    v_mfma_f32_16x16x32_bf16 v[108:111], v[216:219], v[136:139], v[108:111]
    v_cvt_pk_bf16_f32 v25, v26, v27
    v_cvt_pk_bf16_f32 v26, v28, v29
    v_cvt_pk_bf16_f32 v27, v30, v31
    buffer_store_dwordx4 v[24:27], v246, s[24:27], s47 offen offset:3072 sc0 sc1
    s_add_u32 s47, s47, 4096
    ds_read_b64_tr_b16 v[208:209], v240 offset:8192
    ds_read_b64_tr_b16 v[210:211], v240 offset:12288
    s_waitcnt lgkmcnt(15)
    v_mfma_f32_16x16x32_bf16 v[108:111], v[220:223], v[140:143], v[108:111]
    ds_read_b64_tr_b16 v[212:213], v241 offset:8192
    ds_read_b64_tr_b16 v[214:215], v241 offset:12288
    ds_read_b64_tr_b16 v[216:217], v242 offset:8192
    ds_read_b64_tr_b16 v[218:219], v242 offset:12288
    ds_read_b64_tr_b16 v[220:221], v243 offset:8192
    ds_read_b64_tr_b16 v[222:223], v243 offset:12288
    v_mfma_f32_16x16x32_bf16 v[0:3], v[160:163], v[64:67], 0
    v_add_u32 v232, s43, v232
    v_add_u32 v233, s43, v233
    v_add_u32 v234, s43, v234
    v_add_u32 v235, s43, v235
    v_exp_f32 v72, v72
    v_mfma_f32_16x16x32_bf16 v[4:7], v[164:167], v[64:67], 0
    v_exp_f32 v73, v73
    v_add_f32 v244, v244, v72
    v_exp_f32 v74, v74
    v_add_f32 v244, v244, v73
    v_mfma_f32_16x16x32_bf16 v[8:11], v[168:171], v[64:67], 0
    v_exp_f32 v75, v75
    v_cvt_pk_bf16_f32 v72, v72, v73
    v_add_f32 v244, v244, v74
    v_exp_f32 v76, v76
    v_mfma_f32_16x16x32_bf16 v[12:15], v[172:175], v[64:67], 0
    v_add_f32 v244, v244, v75
    v_exp_f32 v77, v77
    v_cvt_pk_bf16_f32 v73, v74, v75
    v_add_f32 v244, v244, v76
    v_exp_f32 v78, v78
    v_mfma_f32_16x16x32_bf16 v[16:19], v[176:179], v[64:67], 0
    s_waitcnt lgkmcnt(0)
    s_barrier
    ds_read_b128 v[160:163], v232
    ds_read_b128 v[164:167], v233
    ds_read_b128 v[168:171], v234
    ds_read_b128 v[172:175], v235
    v_mfma_f32_16x16x32_bf16 v[20:23], v[180:183], v[64:67], 0
    ds_read_b128 v[176:179], v232 offset:4096
    ds_read_b128 v[180:183], v233 offset:4096
    v_add_f32 v244, v244, v77
    v_exp_f32 v79, v79
    v_cvt_pk_bf16_f32 v74, v76, v77
    v_mfma_f32_16x16x32_bf16 v[24:27], v[184:187], v[64:67], 0
    v_add_f32 v244, v244, v78
    v_add_f32 v244, v244, v79
    v_cvt_pk_bf16_f32 v75, v78, v79
    ds_read_b128 v[184:187], v234 offset:4096
    v_max3_f32 v248, v96, v97, v98
    v_max3_f32 v248, v248, v99, v100
    v_mfma_f32_16x16x32_bf16 v[28:31], v[188:191], v[64:67], 0
    ds_read_b128 v[188:191], v235 offset:4096
    v_max3_f32 v248, v248, v101, v102
    v_max3_f32 v248, v248, v103, v104
    v_max3_f32 v248, v248, v105, v106
    v_max3_f32 v248, v248, v107, v108
    v_max3_f32 v248, v248, v109, v110
    v_mfma_f32_16x16x32_bf16 v[0:3], v[192:195], v[72:75], v[0:3]
    ds_read_b128 v[192:195], v232 offset:8192
    v_max_f32 v248, v248, v111
    v_add_u32 v236, s44, v236
    v_add_u32 v237, s44, v237
    v_add_u32 v238, s44, v238
    v_add_u32 v239, s44, v239
    v_mfma_f32_16x16x32_bf16 v[4:7], v[196:199], v[72:75], v[4:7]
    ds_read_b128 v[196:199], v233 offset:8192
    v_add_u32 v240, s44, v240
    v_add_u32 v241, s44, v241
    v_add_u32 v242, s44, v242
    v_add_u32 v243, s44, v243
    v_mfma_f32_16x16x32_bf16 v[8:11], v[200:203], v[72:75], v[8:11]
    ds_read_b128 v[200:203], v234 offset:8192
    v_mfma_f32_16x16x32_bf16 v[12:15], v[204:207], v[72:75], v[12:15]
    ds_read_b128 v[204:207], v235 offset:8192
    v_mfma_f32_16x16x32_bf16 v[16:19], v[208:211], v[72:75], v[16:19]
    ds_read_b128 v[208:211], v232 offset:12288
    v_mfma_f32_16x16x32_bf16 v[20:23], v[212:215], v[72:75], v[20:23]
    ds_read_b128 v[212:215], v233 offset:12288
    v_mfma_f32_16x16x32_bf16 v[24:27], v[216:219], v[72:75], v[24:27]
    ds_read_b128 v[216:219], v234 offset:12288
    v_mfma_f32_16x16x32_bf16 v[28:31], v[220:223], v[72:75], v[28:31]
    ds_read_b128 v[220:223], v235 offset:12288
    s_nop 1
    s_branch L_ja_a1
L_fin_a1:
    v_mov_b32 v249, v244
    s_nop 1
    v_permlane16_swap_b32 v244, v249
    v_add_f32 v244, v244, v249
    v_mov_b32 v249, v244
    s_nop 1
    v_permlane32_swap_b32 v244, v249
    v_add_f32 v244, v244, v249
    v_rcp_f32 v248, v244
    v_mov_b32 v244, 0
    v_pk_mul_f32 v[0:1], v[0:1], v[248:249] op_sel_hi:[1,0]
    v_pk_mul_f32 v[2:3], v[2:3], v[248:249] op_sel_hi:[1,0]
    v_pk_mul_f32 v[4:5], v[4:5], v[248:249] op_sel_hi:[1,0]
    v_pk_mul_f32 v[6:7], v[6:7], v[248:249] op_sel_hi:[1,0]
    v_cvt_pk_bf16_f32 v0, v0, v1
    v_cvt_pk_bf16_f32 v1, v2, v3
    v_cvt_pk_bf16_f32 v2, v4, v5
    v_cvt_pk_bf16_f32 v3, v6, v7
    buffer_store_dwordx4 v[0:3], v246, s[24:27], s47 offen sc0 sc1
    v_pk_mul_f32 v[8:9], v[8:9], v[248:249] op_sel_hi:[1,0]
    v_pk_mul_f32 v[10:11], v[10:11], v[248:249] op_sel_hi:[1,0]
    v_pk_mul_f32 v[12:13], v[12:13], v[248:249] op_sel_hi:[1,0]
    v_pk_mul_f32 v[14:15], v[14:15], v[248:249] op_sel_hi:[1,0]
    v_cvt_pk_bf16_f32 v8, v8, v9
    v_cvt_pk_bf16_f32 v9, v10, v11
    v_cvt_pk_bf16_f32 v10, v12, v13
    v_cvt_pk_bf16_f32 v11, v14, v15
    buffer_store_dwordx4 v[8:11], v246, s[24:27], s47 offen offset:1024 sc0 sc1
    v_pk_mul_f32 v[16:17], v[16:17], v[248:249] op_sel_hi:[1,0]
    v_pk_mul_f32 v[18:19], v[18:19], v[248:249] op_sel_hi:[1,0]
    v_pk_mul_f32 v[20:21], v[20:21], v[248:249] op_sel_hi:[1,0]
    v_pk_mul_f32 v[22:23], v[22:23], v[248:249] op_sel_hi:[1,0]
    v_cvt_pk_bf16_f32 v16, v16, v17
    v_cvt_pk_bf16_f32 v17, v18, v19
    v_cvt_pk_bf16_f32 v18, v20, v21
    v_cvt_pk_bf16_f32 v19, v22, v23
    buffer_store_dwordx4 v[16:19], v246, s[24:27], s47 offen offset:2048 sc0 sc1
    v_pk_mul_f32 v[24:25], v[24:25], v[248:249] op_sel_hi:[1,0]
    v_pk_mul_f32 v[26:27], v[26:27], v[248:249] op_sel_hi:[1,0]
    v_pk_mul_f32 v[28:29], v[28:29], v[248:249] op_sel_hi:[1,0]
    v_pk_mul_f32 v[30:31], v[30:31], v[248:249] op_sel_hi:[1,0]
    v_cvt_pk_bf16_f32 v24, v24, v25
    v_cvt_pk_bf16_f32 v25, v26, v27
    v_cvt_pk_bf16_f32 v26, v28, v29
    v_cvt_pk_bf16_f32 v27, v30, v31
    buffer_store_dwordx4 v[24:27], v246, s[24:27], s47 offen offset:3072 sc0 sc1
    s_add_u32 s47, s47, 4096
    s_waitcnt lgkmcnt(0)
    v_mov_b32 v99, 163832
    v_mov_b32 v97, 1
    s_add_u32 s7, s67, 4096
    s_lshr_b32 s5, s2, 3
    s_cmp_ge_u32 s5, 30
    s_cbranch_scc1 L_a1w
    v_mov_b32 v249, v44
    v_mov_b32 v250, v45
    v_cmp_ne_u32 vcc, s62, v250
    s_nop 0
    s_cmp_eq_u64 vcc, 0
    s_cbranch_scc1 L_spx_o1a
    s_mov_b32 s53, 0
L_sp_o1a:
    s_add_u32 s53, s53, 1
    s_cmp_gt_u32 s53, 400000
    s_cbranch_scc1 L_spx_o1a
    buffer_load_dword v250, v249, s[24:27], s67 offen sc1
    s_waitcnt vmcnt(0)
    v_cmp_ne_u32 vcc, s62, v250
    s_nop 0
    s_cmp_eq_u64 vcc, 0
    s_cbranch_scc0 L_sp_o1a
L_spx_o1a:
    s_mov_b32 s63, 0
    s_add_u32 s51, s63, s66
    s_bfe_u32 s49, s51, 0x20002
    s_lshl_b32 s49, s49, 3
    s_and_b32 s51, s51, 3
    s_add_u32 s49, s49, s51
    s_lshr_b32 s51, s63, 4
    s_lshl2_add_u32 s49, s51, s49
    s_add_u32 s63, s63, 1
    s_lshl_b32 s49, s49, 10
    s_add_u32 s49, s49, s60
    s_add_u32 s6, s49, 0
    buffer_load_dwordx4 v[128:131], v246, s[24:27], s6 offen sc1
    s_add_u32 s6, s49, 131072
    buffer_load_dwordx4 v[132:135], v246, s[24:27], s6 offen sc1
    s_add_u32 s6, s49, 262144
    buffer_load_dwordx4 v[136:139], v246, s[24:27], s6 offen sc1
    s_add_u32 s51, s63, s66
    s_bfe_u32 s49, s51, 0x20002
    s_lshl_b32 s49, s49, 3
    s_and_b32 s51, s51, 3
    s_add_u32 s49, s49, s51
    s_lshr_b32 s51, s63, 4
    s_lshl2_add_u32 s49, s51, s49
    s_add_u32 s63, s63, 1
    s_lshl_b32 s49, s49, 10
    s_add_u32 s49, s49, s60
    s_add_u32 s6, s49, 0
    buffer_load_dwordx4 v[144:147], v246, s[24:27], s6 offen sc1
    s_add_u32 s6, s49, 131072
    buffer_load_dwordx4 v[148:151], v246, s[24:27], s6 offen sc1
    s_add_u32 s6, s49, 262144
    buffer_load_dwordx4 v[152:155], v246, s[24:27], s6 offen sc1
    s_add_u32 s51, s63, s66
    s_bfe_u32 s49, s51, 0x20002
    s_lshl_b32 s49, s49, 3
    s_and_b32 s51, s51, 3
    s_add_u32 s49, s49, s51
    s_lshr_b32 s51, s63, 4
    s_lshl2_add_u32 s49, s51, s49
    s_add_u32 s63, s63, 1
    s_lshl_b32 s49, s49, 10
    s_add_u32 s49, s49, s60
    s_add_u32 s6, s49, 0
    buffer_load_dwordx4 v[160:163], v246, s[24:27], s6 offen sc1
    s_add_u32 s6, s49, 131072
    buffer_load_dwordx4 v[164:167], v246, s[24:27], s6 offen sc1
    s_add_u32 s6, s49, 262144
    buffer_load_dwordx4 v[168:171], v246, s[24:27], s6 offen sc1
    v_mov_b32 v232, v48
    v_mov_b32 v233, v49
    v_mov_b32 v234, v50
    v_mov_b32 v235, v51
    v_mov_b32 v236, v52
    v_mov_b32 v237, v53
    v_mov_b32 v238, v54
    v_mov_b32 v239, v55
    s_mov_b32 s50, 0
    s_mov_b32 s58, 0x43150287
    s_mov_b32 s59, 0x31502876
    s_add_u32 s54, s67, 4096
    v_add_u32 v224, 98304, v232
    v_add_u32 v225, 98304, v233
    v_add_u32 v226, 98304, v234
    v_add_u32 v227, 98304, v235
    v_add_u32 v228, 98304, v236
    v_add_u32 v229, 98304, v237
    v_add_u32 v230, 98304, v238
    v_add_u32 v231, 98304, v239
    ds_read_b64_tr_b16 v[192:193], v224
    ds_read_b64_tr_b16 v[194:195], v224 offset:4096
    ds_read_b64_tr_b16 v[196:197], v225
    ds_read_b64_tr_b16 v[198:199], v225 offset:4096
    ds_read_b64_tr_b16 v[200:201], v226
    ds_read_b64_tr_b16 v[202:203], v226 offset:4096
    ds_read_b64_tr_b16 v[204:205], v227
    ds_read_b64_tr_b16 v[206:207], v227 offset:4096
    ds_read_b64_tr_b16 v[208:209], v228
    ds_read_b64_tr_b16 v[210:211], v228 offset:4096
    ds_read_b64_tr_b16 v[212:213], v229
    ds_read_b64_tr_b16 v[214:215], v229 offset:4096
    ds_read_b64_tr_b16 v[216:217], v230
    ds_read_b64_tr_b16 v[218:219], v230 offset:4096
    ds_read_b64_tr_b16 v[220:221], v231
    ds_read_b64_tr_b16 v[222:223], v231 offset:4096
    s_waitcnt vmcnt(9)
    s_branch L_a1v
L_a1w:
    s_waitcnt vmcnt(0)
L_a1v:
    s_mov_b64 exec, 1
    ds_add_rtn_u32 v98, v99, v97
    s_mov_b64 exec, -1
    s_waitcnt lgkmcnt(0)
    v_readfirstlane_b32 s6, v98
    s_nop 0
    s_cmp_lg_u32 s6, 4
    s_cbranch_scc1 L_nosig_a1
    s_lshl_b32 s6, s5, 7
    v_mov_b32 v96, s6
    v_mov_b32 v97, s62
    s_mov_b64 exec, 1
    buffer_store_dword v97, v96, s[24:27], s7 offen sc0 sc1
    s_mov_b64 exec, -1
L_nosig_a1:
    s_cmp_ge_u32 s5, 30
    s_cbranch_scc1 L_a1x
    v_pk_mov_b32 v[0:1], 0, 0
    v_pk_mov_b32 v[2:3], 0, 0
    v_pk_mov_b32 v[4:5], 0, 0
    v_pk_mov_b32 v[6:7], 0, 0
    v_pk_mov_b32 v[8:9], 0, 0
    v_pk_mov_b32 v[10:11], 0, 0
    v_pk_mov_b32 v[12:13], 0, 0
    v_pk_mov_b32 v[14:15], 0, 0
    v_pk_mov_b32 v[16:17], 0, 0
    v_pk_mov_b32 v[18:19], 0, 0
    v_pk_mov_b32 v[20:21], 0, 0
    v_pk_mov_b32 v[22:23], 0, 0
    v_pk_mov_b32 v[24:25], 0, 0
    v_pk_mov_b32 v[26:27], 0, 0
    v_pk_mov_b32 v[28:29], 0, 0
    v_pk_mov_b32 v[30:31], 0, 0
    v_pk_mov_b32 v[32:33], 0, 0
    v_pk_mov_b32 v[34:35], 0, 0
    v_pk_mov_b32 v[36:37], 0, 0
    v_pk_mov_b32 v[38:39], 0, 0
    v_pk_mov_b32 v[40:41], 0, 0
    v_pk_mov_b32 v[42:43], 0, 0
    v_pk_mov_b32 v[44:45], 0, 0
    v_pk_mov_b32 v[46:47], 0, 0
    v_pk_mov_b32 v[48:49], 0, 0
    v_pk_mov_b32 v[50:51], 0, 0
    v_pk_mov_b32 v[52:53], 0, 0
    v_pk_mov_b32 v[54:55], 0, 0
    v_pk_mov_b32 v[56:57], 0, 0
    v_pk_mov_b32 v[58:59], 0, 0
    v_pk_mov_b32 v[60:61], 0, 0
    v_pk_mov_b32 v[62:63], 0, 0
    v_pk_mov_b32 v[64:65], 0, 0
    v_pk_mov_b32 v[66:67], 0, 0
    v_pk_mov_b32 v[68:69], 0, 0
    v_pk_mov_b32 v[70:71], 0, 0
    v_pk_mov_b32 v[72:73], 0, 0
    v_pk_mov_b32 v[74:75], 0, 0
    v_pk_mov_b32 v[76:77], 0, 0
    v_pk_mov_b32 v[78:79], 0, 0
    v_pk_mov_b32 v[80:81], 0, 0
    v_pk_mov_b32 v[82:83], 0, 0
    v_pk_mov_b32 v[84:85], 0, 0
    v_pk_mov_b32 v[86:87], 0, 0
    v_pk_mov_b32 v[88:89], 0, 0
    v_pk_mov_b32 v[90:91], 0, 0
    v_pk_mov_b32 v[92:93], 0, 0
    v_pk_mov_b32 v[94:95], 0, 0
    s_nop 0
    s_branch L_t
L_a1x:
    s_branch L_end
L_q2_a1:
    v_add_u32 v143, s74, v246
    ds_read_b128 v[128:131], v143
    ds_read_b128 v[132:135], v143 offset:1024
    ds_read_b128 v[136:139], v143 offset:2048
    ds_read_b128 v[140:143], v143 offset:3072
    s_waitcnt lgkmcnt(0)
    s_branch L_q2b_a1
L_s1_a1:
    s_lshr_b32 s5, s2, 3
    s_lshl_b32 s6, s5, 7
    v_mov_b32 v40, s6
    v_mov_b32 v41, s62
    s_mov_b64 exec, 1
    buffer_store_dword v41, v40, s[24:27], s67 offen sc0 sc1
    s_mov_b64 exec, -1
    s_branch L_s1b_a1
L_p1_a1:
    buffer_load_dword v45, v44, s[24:27], s67 offen sc1
    s_branch L_p1b_a1
L_rare_a1a:
    v_mov_b32 v249, v248
    s_nop 1
    v_permlane16_swap_b32 v248, v249
    v_max_f32 v248, v248, v249
    v_mov_b32 v249, v248
    s_nop 1
    v_permlane32_swap_b32 v248, v249
    v_max_f32 v248, v248, v249
    v_max_f32 v248, 0, v248
    v_exp_f32 v249, -v248
    v_sub_f32 v96, v96, v248
    v_sub_f32 v97, v97, v248
    v_sub_f32 v98, v98, v248
    v_sub_f32 v99, v99, v248
    v_sub_f32 v100, v100, v248
    v_sub_f32 v101, v101, v248
    v_sub_f32 v102, v102, v248
    v_sub_f32 v103, v103, v248
    v_sub_f32 v104, v104, v248
    v_sub_f32 v105, v105, v248
    v_sub_f32 v106, v106, v248
    v_sub_f32 v107, v107, v248
    v_sub_f32 v108, v108, v248
    v_sub_f32 v109, v109, v248
    v_sub_f32 v110, v110, v248
    v_sub_f32 v111, v111, v248
    v_sub_f32 v224, v224, v248
    v_sub_f32 v225, v225, v248
    v_sub_f32 v226, v226, v248
    v_sub_f32 v227, v227, v248
    v_mul_f32 v244, v244, v249
    v_mul_f32 v0, v0, v249
    v_mul_f32 v1, v1, v249
    v_mul_f32 v2, v2, v249
    v_mul_f32 v3, v3, v249
    v_mul_f32 v4, v4, v249
    v_mul_f32 v5, v5, v249
    v_mul_f32 v6, v6, v249
    v_mul_f32 v7, v7, v249
    v_mul_f32 v8, v8, v249
    v_mul_f32 v9, v9, v249
    v_mul_f32 v10, v10, v249
    v_mul_f32 v11, v11, v249
    v_mul_f32 v12, v12, v249
    v_mul_f32 v13, v13, v249
    v_mul_f32 v14, v14, v249
    v_mul_f32 v15, v15, v249
    v_mul_f32 v16, v16, v249
    v_mul_f32 v17, v17, v249
    v_mul_f32 v18, v18, v249
    v_mul_f32 v19, v19, v249
    v_mul_f32 v20, v20, v249
    v_mul_f32 v21, v21, v249
    v_mul_f32 v22, v22, v249
    v_mul_f32 v23, v23, v249
    v_mul_f32 v24, v24, v249
    v_mul_f32 v25, v25, v249
    v_mul_f32 v26, v26, v249
    v_mul_f32 v27, v27, v249
    v_mul_f32 v28, v28, v249
    v_mul_f32 v29, v29, v249
    v_mul_f32 v30, v30, v249
    v_mul_f32 v31, v31, v249
    s_nop 1
    s_branch L_back_a1a
L_rare_a1b:
    v_mov_b32 v249, v248
    s_nop 1
    v_permlane16_swap_b32 v248, v249
    v_max_f32 v248, v248, v249
    v_mov_b32 v249, v248
    s_nop 1
    v_permlane32_swap_b32 v248, v249
    v_max_f32 v248, v248, v249
    v_max_f32 v248, 0, v248
    v_exp_f32 v249, -v248
    v_sub_f32 v64, v64, v248
    v_sub_f32 v65, v65, v248
    v_sub_f32 v66, v66, v248
    v_sub_f32 v67, v67, v248
    v_sub_f32 v68, v68, v248
    v_sub_f32 v69, v69, v248
    v_sub_f32 v70, v70, v248
    v_sub_f32 v71, v71, v248
    v_sub_f32 v72, v72, v248
    v_sub_f32 v73, v73, v248
    v_sub_f32 v74, v74, v248
    v_sub_f32 v75, v75, v248
    v_sub_f32 v76, v76, v248
    v_sub_f32 v77, v77, v248
    v_sub_f32 v78, v78, v248
    v_sub_f32 v79, v79, v248
    v_sub_f32 v224, v224, v248
    v_sub_f32 v225, v225, v248
    v_sub_f32 v226, v226, v248
    v_sub_f32 v227, v227, v248
    v_mul_f32 v244, v244, v249
    v_mul_f32 v0, v0, v249
    v_mul_f32 v1, v1, v249
    v_mul_f32 v2, v2, v249
    v_mul_f32 v3, v3, v249
    v_mul_f32 v4, v4, v249
    v_mul_f32 v5, v5, v249
    v_mul_f32 v6, v6, v249
    v_mul_f32 v7, v7, v249
    v_mul_f32 v8, v8, v249
    v_mul_f32 v9, v9, v249
    v_mul_f32 v10, v10, v249
    v_mul_f32 v11, v11, v249
    v_mul_f32 v12, v12, v249
    v_mul_f32 v13, v13, v249
    v_mul_f32 v14, v14, v249
    v_mul_f32 v15, v15, v249
    v_mul_f32 v16, v16, v249
    v_mul_f32 v17, v17, v249
    v_mul_f32 v18, v18, v249
    v_mul_f32 v19, v19, v249
    v_mul_f32 v20, v20, v249
    v_mul_f32 v21, v21, v249
    v_mul_f32 v22, v22, v249
    v_mul_f32 v23, v23, v249
    v_mul_f32 v24, v24, v249
    v_mul_f32 v25, v25, v249
    v_mul_f32 v26, v26, v249
    v_mul_f32 v27, v27, v249
    v_mul_f32 v28, v28, v249
    v_mul_f32 v29, v29, v249
    v_mul_f32 v30, v30, v249
    v_mul_f32 v31, v31, v249
    s_nop 1
    s_branch L_back_a1b
L_h0:
    v_lshrrev_b32 v1, 4, v247
    v_and_b32 v2, 15, v247
    v_lshlrev_b32 v3, 2, v1
    v_xor_b32 v3, v3, v2
    v_lshlrev_b32 v3, 4, v3
    v_lshl_add_u32 v232, v1, 13, v3
    v_xor_b32 v233, 32, v232
    v_lshrrev_b32 v5, 3, v247
    v_mul_u32_u24 v5, 1280, v5
    v_and_b32 v6, 7, v247
    v_xor_b32 v4, 0, v1
    v_xor_b32 v4, v4, v6
    v_lshl_add_u32 v234, v4, 4, v5
    v_xor_b32 v4, 4, v1
    v_xor_b32 v4, v4, v6
    v_lshl_add_u32 v235, v4, 4, v5
    s_lshl_b32 s48, s38, 8
    s_mul_i32 s49, s37, 184320
    s_mov_b32 s52, 49152
    s_mov_b32 s53, 32768
    s_mov_b32 s54, 65536
    s_mov_b32 s55, 81920
    s_mov_b32 s56, 98304
    s_mov_b32 s60, s101
    s_mov_b32 s101, 0
    s_mov_b32 s57, s101
    s_mov_b32 s50, s48
    s_add_u32 s101, s60, 1
    s_add_u32 s57, s60, 1
    s_mov_b32 s52, 32768
    s_mov_b32 s53, 65536
    s_mov_b32 s54, 81920
    s_mov_b32 s55, 49152
    s_mov_b32 s56, 116736
    s_add_u32 m0, s52, 0
    s_add_u32 s6, s50, 262144
    buffer_load_dwordx4 v232, s[20:23], s6 offen lds
    s_add_u32 m0, s52, 1024
    s_add_u32 s6, s50, 294912
    buffer_load_dwordx4 v232, s[20:23], s6 offen lds
    s_add_u32 m0, s52, 2048
    s_add_u32 s6, s50, 327680
    buffer_load_dwordx4 v233, s[20:23], s6 offen lds
    s_add_u32 m0, s52, 3072
    s_add_u32 s6, s50, 360448
    buffer_load_dwordx4 v233, s[20:23], s6 offen lds
    s_add_u32 m0, s52, 4096
    s_add_u32 s6, s50, 393216
    buffer_load_dwordx4 v232, s[20:23], s6 offen lds
    s_mov_b32 s4, s52
    s_mov_b32 s52, s53
    s_mov_b32 s53, s54
    s_mov_b32 s54, s55
    s_mov_b32 s55, s4
    s_lshl_b32 s50, s101, 19
    s_add_u32 s50, s50, s48
    s_add_u32 s101, s101, 1
    s_cmp_eq_u32 s101, 10
    s_cselect_b32 s101, 1, s101
    s_add_u32 m0, s52, 0
    s_add_u32 s6, s50, 0
    buffer_load_dwordx4 v232, s[20:23], s6 offen lds
    s_add_u32 m0, s52, 1024
    s_add_u32 s6, s50, 32768
    buffer_load_dwordx4 v232, s[20:23], s6 offen lds
    s_add_u32 m0, s52, 2048
    s_add_u32 s6, s50, 65536
    buffer_load_dwordx4 v233, s[20:23], s6 offen lds
    s_add_u32 m0, s52, 3072
    s_add_u32 s6, s50, 98304
    buffer_load_dwordx4 v233, s[20:23], s6 offen lds
    s_add_u32 m0, s52, 4096
    s_add_u32 s6, s50, 131072
    buffer_load_dwordx4 v232, s[20:23], s6 offen lds
    s_mov_b32 s4, s52
    s_mov_b32 s52, s53
    s_mov_b32 s53, s54
    s_mov_b32 s54, s55
    s_mov_b32 s55, s4
    s_lshl_b32 s51, s57, 7
    s_add_u32 s51, s51, s49
    s_add_u32 s57, s57, 1
    s_cmp_eq_u32 s57, 10
    s_cselect_b32 s57, 1, s57
    s_add_u32 m0, s56, 0
    s_add_u32 s6, s51, 0
    buffer_load_dwordx4 v234, s[16:19], s6 offen lds
    s_add_u32 m0, s56, 1024
    s_add_u32 s6, s51, 10240
    buffer_load_dwordx4 v235, s[16:19], s6 offen lds
    s_add_u32 m0, s56, 2048
    s_add_u32 s6, s51, 20480
    buffer_load_dwordx4 v234, s[16:19], s6 offen lds
    s_add_u32 m0, s56, 3072
    s_add_u32 s6, s51, 30720
    buffer_load_dwordx4 v235, s[16:19], s6 offen lds
    s_add_u32 m0, s56, 4096
    s_add_u32 s6, s51, 40960
    buffer_load_dwordx4 v234, s[16:19], s6 offen lds
    s_add_u32 m0, s56, 5120
    s_add_u32 s6, s51, 51200
    buffer_load_dwordx4 v235, s[16:19], s6 offen lds
    s_add_u32 s56, s56, 18432
    s_cmp_eq_u32 s56, 153600
    s_cselect_b32 s56, 98304, s56
    v_add_u32 v4, 0, v1
    v_xor_b32 v4, v4, v2
    v_lshlrev_b32 v4, 4, v4
    v_lshl_add_u32 v240, v1, 8, v4
    v_add_u32 v4, 4, v1
    v_xor_b32 v4, v4, v2
    v_lshlrev_b32 v4, 4, v4
    v_lshl_add_u32 v241, v1, 8, v4
    v_add_u32 v4, 8, v1
    v_xor_b32 v4, v4, v2
    v_lshlrev_b32 v4, 4, v4
    v_lshl_add_u32 v242, v1, 8, v4
    v_add_u32 v4, 12, v1
    v_xor_b32 v4, v4, v2
    v_lshlrev_b32 v4, 4, v4
    v_lshl_add_u32 v243, v1, 8, v4
    v_lshl_add_u32 v244, v1, 8, v3
    v_xor_b32 v245, 32, v244
    s_waitcnt vmcnt(16)
    s_barrier
    s_add_u32 m0, s52, 0
    s_add_u32 s6, s50, 262144
    buffer_load_dwordx4 v232, s[20:23], s6 offen lds
    s_add_u32 m0, s52, 1024
    s_add_u32 s6, s50, 294912
    buffer_load_dwordx4 v232, s[20:23], s6 offen lds
    s_add_u32 m0, s52, 2048
    s_add_u32 s6, s50, 327680
    buffer_load_dwordx4 v233, s[20:23], s6 offen lds
    s_add_u32 m0, s52, 3072
    s_add_u32 s6, s50, 360448
    buffer_load_dwordx4 v233, s[20:23], s6 offen lds
    s_add_u32 m0, s52, 4096
    s_add_u32 s6, s50, 393216
    buffer_load_dwordx4 v232, s[20:23], s6 offen lds
    s_mov_b32 s4, s52
    s_mov_b32 s52, s53
    s_mov_b32 s53, s54
    s_mov_b32 s54, s55
    s_mov_b32 s55, s4
    s_waitcnt vmcnt(16)
    s_barrier
    s_lshl_b32 s50, s101, 19
    s_add_u32 s50, s50, s48
    s_add_u32 s101, s101, 1
    s_cmp_eq_u32 s101, 10
    s_cselect_b32 s101, 1, s101
    s_add_u32 m0, s52, 0
    s_add_u32 s6, s50, 0
    buffer_load_dwordx4 v232, s[20:23], s6 offen lds
    s_add_u32 m0, s52, 1024
    s_add_u32 s6, s50, 32768
    buffer_load_dwordx4 v232, s[20:23], s6 offen lds
    s_add_u32 m0, s52, 2048
    s_add_u32 s6, s50, 65536
    buffer_load_dwordx4 v233, s[20:23], s6 offen lds
    s_add_u32 m0, s52, 3072
    s_add_u32 s6, s50, 98304
    buffer_load_dwordx4 v233, s[20:23], s6 offen lds
    s_add_u32 m0, s52, 4096
    s_add_u32 s6, s50, 131072
    buffer_load_dwordx4 v232, s[20:23], s6 offen lds
    s_mov_b32 s4, s52
    s_mov_b32 s52, s53
    s_mov_b32 s53, s54
    s_mov_b32 s54, s55
    s_mov_b32 s55, s4
    s_lshl_b32 s51, s57, 7
    s_add_u32 s51, s51, s49
    s_add_u32 s57, s57, 1
    s_cmp_eq_u32 s57, 10
    s_cselect_b32 s57, 1, s57
    s_add_u32 m0, s56, 0
    s_add_u32 s6, s51, 0
    buffer_load_dwordx4 v234, s[16:19], s6 offen lds
    s_add_u32 m0, s56, 1024
    s_add_u32 s6, s51, 10240
    buffer_load_dwordx4 v235, s[16:19], s6 offen lds
    s_add_u32 m0, s56, 2048
    s_add_u32 s6, s51, 20480
    buffer_load_dwordx4 v234, s[16:19], s6 offen lds
    s_add_u32 m0, s56, 3072
    s_add_u32 s6, s51, 30720
    buffer_load_dwordx4 v235, s[16:19], s6 offen lds
    s_add_u32 m0, s56, 4096
    s_add_u32 s6, s51, 40960
    buffer_load_dwordx4 v234, s[16:19], s6 offen lds
    s_add_u32 m0, s56, 5120
    s_add_u32 s6, s51, 51200
    buffer_load_dwordx4 v235, s[16:19], s6 offen lds
    s_add_u32 s56, s56, 18432
    s_cmp_eq_u32 s56, 153600
    s_cselect_b32 s56, 98304, s56
    s_waitcnt vmcnt(16)
    s_barrier
    s_add_u32 m0, s52, 0
    s_add_u32 s6, s50, 262144
    buffer_load_dwordx4 v232, s[20:23], s6 offen lds
    s_add_u32 m0, s52, 1024
    s_add_u32 s6, s50, 294912
    buffer_load_dwordx4 v232, s[20:23], s6 offen lds
    s_add_u32 m0, s52, 2048
    s_add_u32 s6, s50, 327680
    buffer_load_dwordx4 v233, s[20:23], s6 offen lds
    s_add_u32 m0, s52, 3072
    s_add_u32 s6, s50, 360448
    buffer_load_dwordx4 v233, s[20:23], s6 offen lds
    s_add_u32 m0, s52, 4096
    s_add_u32 s6, s50, 393216
    buffer_load_dwordx4 v232, s[20:23], s6 offen lds
    s_mov_b32 s4, s52
    s_mov_b32 s52, s53
    s_mov_b32 s53, s54
    s_mov_b32 s54, s55
    s_mov_b32 s55, s4
    s_mov_b32 m0, 0
    s_add_u32 s6, s39, 0
    buffer_load_dwordx4 v240, s[8:11], s6 offen nt lds
    buffer_load_dwordx4 v241, s[8:11], s6 offen offset:1024 nt lds
    buffer_load_dwordx4 v242, s[8:11], s6 offen offset:2048 nt lds
    buffer_load_dwordx4 v243, s[8:11], s6 offen offset:3072 nt lds
    s_mov_b32 m0, 12288
    s_add_u32 s6, s39, 12288
    buffer_load_dwordx4 v240, s[8:11], s6 offen nt lds
    buffer_load_dwordx4 v241, s[8:11], s6 offen offset:1024 nt lds
    buffer_load_dwordx4 v242, s[8:11], s6 offen offset:2048 nt lds
    buffer_load_dwordx4 v243, s[8:11], s6 offen offset:3072 nt lds
    s_waitcnt vmcnt(24)
    s_barrier
    s_lshl_b32 s50, s101, 19
    s_add_u32 s50, s50, s48
    s_add_u32 s101, s101, 1
    s_cmp_eq_u32 s101, 10
    s_cselect_b32 s101, 1, s101
    s_add_u32 m0, s52, 0
    s_add_u32 s6, s50, 0
    buffer_load_dwordx4 v232, s[20:23], s6 offen lds
    s_add_u32 m0, s52, 1024
    s_add_u32 s6, s50, 32768
    buffer_load_dwordx4 v232, s[20:23], s6 offen lds
    s_add_u32 m0, s52, 2048
    s_add_u32 s6, s50, 65536
    buffer_load_dwordx4 v233, s[20:23], s6 offen lds
    s_add_u32 m0, s52, 3072
    s_add_u32 s6, s50, 98304
    buffer_load_dwordx4 v233, s[20:23], s6 offen lds
    s_add_u32 m0, s52, 4096
    s_add_u32 s6, s50, 131072
    buffer_load_dwordx4 v232, s[20:23], s6 offen lds
    s_mov_b32 s4, s52
    s_mov_b32 s52, s53
    s_mov_b32 s53, s54
    s_mov_b32 s54, s55
    s_mov_b32 s55, s4
    s_lshl_b32 s51, s57, 7
    s_add_u32 s51, s51, s49
    s_add_u32 s57, s57, 1
    s_cmp_eq_u32 s57, 10
    s_cselect_b32 s57, 1, s57
    s_add_u32 m0, s56, 0
    s_add_u32 s6, s51, 0
    buffer_load_dwordx4 v234, s[16:19], s6 offen lds
    s_add_u32 m0, s56, 1024
    s_add_u32 s6, s51, 10240
    buffer_load_dwordx4 v235, s[16:19], s6 offen lds
    s_add_u32 m0, s56, 2048
    s_add_u32 s6, s51, 20480
    buffer_load_dwordx4 v234, s[16:19], s6 offen lds
    s_add_u32 m0, s56, 3072
    s_add_u32 s6, s51, 30720
    buffer_load_dwordx4 v235, s[16:19], s6 offen lds
    s_add_u32 m0, s56, 4096
    s_add_u32 s6, s51, 40960
    buffer_load_dwordx4 v234, s[16:19], s6 offen lds
    s_add_u32 m0, s56, 5120
    s_add_u32 s6, s51, 51200
    buffer_load_dwordx4 v235, s[16:19], s6 offen lds
    s_add_u32 s56, s56, 18432
    s_cmp_eq_u32 s56, 153600
    s_cselect_b32 s56, 98304, s56
    s_waitcnt vmcnt(24)
    s_barrier
    s_add_u32 m0, s52, 0
    s_add_u32 s6, s50, 262144
    buffer_load_dwordx4 v232, s[20:23], s6 offen lds
    s_add_u32 m0, s52, 1024
    s_add_u32 s6, s50, 294912
    buffer_load_dwordx4 v232, s[20:23], s6 offen lds
    s_add_u32 m0, s52, 2048
    s_add_u32 s6, s50, 327680
    buffer_load_dwordx4 v233, s[20:23], s6 offen lds
    s_add_u32 m0, s52, 3072
    s_add_u32 s6, s50, 360448
    buffer_load_dwordx4 v233, s[20:23], s6 offen lds
    s_add_u32 m0, s52, 4096
    s_add_u32 s6, s50, 393216
    buffer_load_dwordx4 v232, s[20:23], s6 offen lds
    s_mov_b32 s4, s52
    s_mov_b32 s52, s53
    s_mov_b32 s53, s54
    s_mov_b32 s54, s55
    s_mov_b32 s55, s4
    s_mov_b32 m0, 16384
    s_add_u32 s6, s39, 16384
    buffer_load_dwordx4 v240, s[8:11], s6 offen nt lds
    buffer_load_dwordx4 v241, s[8:11], s6 offen offset:1024 nt lds
    buffer_load_dwordx4 v242, s[8:11], s6 offen offset:2048 nt lds
    buffer_load_dwordx4 v243, s[8:11], s6 offen offset:3072 nt lds
    s_mov_b32 s42, 2
L_p_h0:
    s_waitcnt vmcnt(16)
    s_barrier
    s_lshl_b32 s50, s101, 19
    s_add_u32 s50, s50, s48
    s_add_u32 s101, s101, 1
    s_cmp_eq_u32 s101, 10
    s_cselect_b32 s101, 1, s101
    s_add_u32 m0, s52, 0
    s_add_u32 s6, s50, 0
    buffer_load_dwordx4 v232, s[20:23], s6 offen lds
    s_add_u32 m0, s52, 1024
    s_add_u32 s6, s50, 32768
    buffer_load_dwordx4 v232, s[20:23], s6 offen lds
    s_add_u32 m0, s52, 2048
    s_add_u32 s6, s50, 65536
    buffer_load_dwordx4 v233, s[20:23], s6 offen lds
    s_add_u32 m0, s52, 3072
    s_add_u32 s6, s50, 98304
    buffer_load_dwordx4 v233, s[20:23], s6 offen lds
    s_add_u32 m0, s52, 4096
    s_add_u32 s6, s50, 131072
    buffer_load_dwordx4 v232, s[20:23], s6 offen lds
    s_mov_b32 s4, s52
    s_mov_b32 s52, s53
    s_mov_b32 s53, s54
    s_mov_b32 s54, s55
    s_mov_b32 s55, s4
    s_lshl_b32 s51, s57, 7
    s_add_u32 s51, s51, s49
    s_add_u32 s57, s57, 1
    s_cmp_eq_u32 s57, 10
    s_cselect_b32 s57, 1, s57
    s_add_u32 m0, s56, 0
    s_add_u32 s6, s51, 0
    buffer_load_dwordx4 v234, s[16:19], s6 offen lds
    s_add_u32 m0, s56, 1024
    s_add_u32 s6, s51, 10240
    buffer_load_dwordx4 v235, s[16:19], s6 offen lds
    s_add_u32 m0, s56, 2048
    s_add_u32 s6, s51, 20480
    buffer_load_dwordx4 v234, s[16:19], s6 offen lds
    s_add_u32 m0, s56, 3072
    s_add_u32 s6, s51, 30720
    buffer_load_dwordx4 v235, s[16:19], s6 offen lds
    s_add_u32 m0, s56, 4096
    s_add_u32 s6, s51, 40960
    buffer_load_dwordx4 v234, s[16:19], s6 offen lds
    s_add_u32 m0, s56, 5120
    s_add_u32 s6, s51, 51200
    buffer_load_dwordx4 v235, s[16:19], s6 offen lds
    s_add_u32 s56, s56, 18432
    s_cmp_eq_u32 s56, 153600
    s_cselect_b32 s56, 98304, s56
    s_waitcnt vmcnt(16)
    s_barrier
    s_add_u32 m0, s52, 0
    s_add_u32 s6, s50, 262144
    buffer_load_dwordx4 v232, s[20:23], s6 offen lds
    s_add_u32 m0, s52, 1024
    s_add_u32 s6, s50, 294912
    buffer_load_dwordx4 v232, s[20:23], s6 offen lds
    s_add_u32 m0, s52, 2048
    s_add_u32 s6, s50, 327680
    buffer_load_dwordx4 v233, s[20:23], s6 offen lds
    s_add_u32 m0, s52, 3072
    s_add_u32 s6, s50, 360448
    buffer_load_dwordx4 v233, s[20:23], s6 offen lds
    s_add_u32 m0, s52, 4096
    s_add_u32 s6, s50, 393216
    buffer_load_dwordx4 v232, s[20:23], s6 offen lds
    s_mov_b32 s4, s52
    s_mov_b32 s52, s53
    s_mov_b32 s53, s54
    s_mov_b32 s54, s55
    s_mov_b32 s55, s4
    s_add_u32 s42, s42, 1
    s_cmp_lt_u32 s42, 8
    s_cbranch_scc1 L_p_h0
    s_waitcnt vmcnt(16)
    s_barrier
    s_mov_b32 m0, 49152
    s_add_u32 s6, s39, 0
    buffer_load_dwordx4 v244, s[12:15], s6 offen nt lds
    buffer_load_dwordx4 v245, s[12:15], s6 offen offset:1024 nt lds
    buffer_load_dwordx4 v244, s[12:15], s6 offen offset:2048 nt lds
    buffer_load_dwordx4 v245, s[12:15], s6 offen offset:3072 nt lds
    s_waitcnt vmcnt(9)
    s_barrier
    s_mov_b32 m0, 32768
    s_add_u32 s6, s39, 32768
    buffer_load_dwordx4 v240, s[8:11], s6 offen nt lds
    buffer_load_dwordx4 v241, s[8:11], s6 offen offset:1024 nt lds
    buffer_load_dwordx4 v242, s[8:11], s6 offen offset:2048 nt lds
    buffer_load_dwordx4 v243, s[8:11], s6 offen offset:3072 nt lds
    s_mov_b32 m0, 45056
    s_add_u32 s6, s39, 45056
    buffer_load_dwordx4 v240, s[8:11], s6 offen nt lds
    buffer_load_dwordx4 v241, s[8:11], s6 offen offset:1024 nt lds
    buffer_load_dwordx4 v242, s[8:11], s6 offen offset:2048 nt lds
    buffer_load_dwordx4 v243, s[8:11], s6 offen offset:3072 nt lds
    s_waitcnt vmcnt(12)
    s_barrier
    s_mov_b32 m0, 65536
    s_add_u32 s6, s39, 16384
    buffer_load_dwordx4 v244, s[12:15], s6 offen nt lds
    buffer_load_dwordx4 v245, s[12:15], s6 offen offset:1024 nt lds
    buffer_load_dwordx4 v244, s[12:15], s6 offen offset:2048 nt lds
    buffer_load_dwordx4 v245, s[12:15], s6 offen offset:3072 nt lds
    s_barrier
    s_barrier
    s_waitcnt vmcnt(12) lgkmcnt(0)
    s_barrier
    s_mov_b32 m0, 81920
    s_add_u32 s6, s39, 32768
    buffer_load_dwordx4 v244, s[12:15], s6 offen nt lds
    buffer_load_dwordx4 v245, s[12:15], s6 offen offset:1024 nt lds
    buffer_load_dwordx4 v244, s[12:15], s6 offen offset:2048 nt lds
    buffer_load_dwordx4 v245, s[12:15], s6 offen offset:3072 nt lds
    s_mov_b32 m0, 0
    s_add_u32 s6, s39, 49152
    buffer_load_dwordx4 v240, s[8:11], s6 offen nt lds
    buffer_load_dwordx4 v241, s[8:11], s6 offen offset:1024 nt lds
    buffer_load_dwordx4 v242, s[8:11], s6 offen offset:2048 nt lds
    buffer_load_dwordx4 v243, s[8:11], s6 offen offset:3072 nt lds
    s_mov_b32 m0, 12288
    s_add_u32 s6, s39, 61440
    buffer_load_dwordx4 v240, s[8:11], s6 offen nt lds
    buffer_load_dwordx4 v241, s[8:11], s6 offen offset:1024 nt lds
    buffer_load_dwordx4 v242, s[8:11], s6 offen offset:2048 nt lds
    buffer_load_dwordx4 v243, s[8:11], s6 offen offset:3072 nt lds
    s_mov_b32 s45, 16384
    s_mov_b32 s46, 49152
    s_add_u32 s43, s39, 65536
    s_add_u32 s44, s39, 49152
    s_waitcnt vmcnt(12)
    s_barrier
    s_add_u32 m0, s45, 0
    s_add_u32 s7, s43, 0
    s_waitcnt vmcnt(5)
    buffer_load_dwordx4 v240, s[8:11], s7 offen nt lds
    s_waitcnt vmcnt(5)
    buffer_load_dwordx4 v241, s[8:11], s7 offen offset:1024 nt lds
    s_waitcnt vmcnt(5)
    buffer_load_dwordx4 v242, s[8:11], s7 offen offset:2048 nt lds
    s_waitcnt vmcnt(5)
    buffer_load_dwordx4 v243, s[8:11], s7 offen offset:3072 nt lds
    s_add_u32 m0, s45, 4096
    s_add_u32 s7, s43, 4096
    s_waitcnt vmcnt(5)
    buffer_load_dwordx4 v240, s[8:11], s7 offen nt lds
    s_waitcnt vmcnt(5)
    buffer_load_dwordx4 v241, s[8:11], s7 offen offset:1024 nt lds
    s_waitcnt vmcnt(5)
    buffer_load_dwordx4 v242, s[8:11], s7 offen offset:2048 nt lds
    s_waitcnt vmcnt(5)
    buffer_load_dwordx4 v243, s[8:11], s7 offen offset:3072 nt lds
    s_add_u32 m0, s45, 8192
    s_add_u32 s7, s43, 8192
    s_waitcnt vmcnt(5)
    buffer_load_dwordx4 v240, s[8:11], s7 offen nt lds
    s_waitcnt vmcnt(5)
    buffer_load_dwordx4 v241, s[8:11], s7 offen offset:1024 nt lds
    s_waitcnt vmcnt(5)
    buffer_load_dwordx4 v242, s[8:11], s7 offen offset:2048 nt lds
    s_add_u32 s45, s45, 16384
    s_cmp_eq_u32 s45, 49152
    s_cselect_b32 s45, 0, s45
    s_add_u32 s43, s43, 16384
    s_add_u32 s46, s46, 16384
    s_cmp_eq_u32 s46, 98304
    s_cselect_b32 s46, 49152, s46
    s_add_u32 s44, s44, 16384
    v_mov_b32 v249, 163824
    ds_read_b32 v250, v249
    s_and_b32 s4, s2, 7
    s_lshl_b32 s67, s4, 13
    s_add_u32 s67, s67, 58720256
    s_waitcnt lgkmcnt(0)
    v_readfirstlane_b32 s62, v250
    s_lshr_b32 s5, s2, 3
    s_mul_i32 s64, s5, 52
    s_lshr_b32 s64, s64, 8
    s_mul_i32 s6, s64, 5
    s_sub_u32 s65, s5, s6
    s_and_b32 s7, s2, 3
    s_mul_i32 s6, s36, 72
    s_mul_i32 s60, s64, 12
    s_add_u32 s6, s6, s60
    s_add_u32 s6, s6, 0
    s_lshl_b32 s6, s6, 2
    s_add_u32 s6, s6, s7
    s_lshl_b32 s60, s6, 15
    s_mul_i32 s61, s7, 1310720
    s_lshl_b32 s6, s65, 8
    s_add_u32 s61, s61, s6
    s_mul_i32 s6, s36, 30
    s_add_u32 s6, s6, s5
    s_lshl_b32 s72, s6, 18
    s_add_u32 s72, s72, 33554432
    s_lshl_b32 s6, s6, 2
    s_add_u32 s6, s6, 0
    s_lshl_b32 s69, s6, 9
    s_add_u32 s69, s69, 58785792
    s_mul_i32 s73, s64, 192
    s_add_u32 s73, s73, 0
    s_cmp_lt_u32 s5, 30
    s_cselect_b32 s68, 1, 0
    v_bfe_u32 v128, v247, 2, 2
    v_lshrrev_b32 v130, 4, v247
    v_lshl_add_u32 v131, v130, 2, v128
    v_lshlrev_b32 v131, 8, v131
    v_and_b32 v130, 1, v130
    v_lshlrev_b32 v130, 1, v130
    v_lshl_add_u32 v130, v128, 2, v130
    v_bfe_u32 v132, v247, 1, 1
    v_xor_b32 v130, v130, v132
    v_lshl_add_u32 v131, v130, 4, v131
    v_and_b32 v129, 1, v247
    v_lshl_add_u32 v131, v129, 3, v131
    v_xor_b32 v232, 0, v131
    v_xor_b32 v233, 32, v131
    v_xor_b32 v234, 64, v131
    v_xor_b32 v235, 96, v131
    v_xor_b32 v236, 128, v131
    v_xor_b32 v237, 160, v131
    v_xor_b32 v238, 192, v131
    v_xor_b32 v239, 224, v131
    v_lshrrev_b32 v128, 4, v247
    v_and_b32 v129, 15, v247
    v_lshlrev_b32 v130, 2, v128
    v_xor_b32 v130, v130, v129
    v_lshlrev_b32 v130, 4, v130
    v_mul_u32_u24 v128, 1280, v128
    v_add_u32 v251, v128, v130
    v_xor_b32 v130, 32, v130
    v_add_u32 v252, v128, v130
    s_waitcnt vmcnt(11)
    s_barrier
    s_add_u32 m0, s45, 0
    s_add_u32 s7, s43, 0
    s_waitcnt vmcnt(5)
    buffer_load_dwordx4 v240, s[8:11], s7 offen nt lds
    s_waitcnt vmcnt(5)
    buffer_load_dwordx4 v241, s[8:11], s7 offen offset:1024 nt lds
    s_waitcnt vmcnt(5)
    buffer_load_dwordx4 v242, s[8:11], s7 offen offset:2048 nt lds
    s_waitcnt vmcnt(5)
    buffer_load_dwordx4 v243, s[8:11], s7 offen offset:3072 nt lds
    s_add_u32 m0, s45, 4096
    s_add_u32 s7, s43, 4096
    s_waitcnt vmcnt(5)
    buffer_load_dwordx4 v240, s[8:11], s7 offen nt lds
    s_waitcnt vmcnt(5)
    buffer_load_dwordx4 v241, s[8:11], s7 offen offset:1024 nt lds
    s_waitcnt vmcnt(5)
    buffer_load_dwordx4 v242, s[8:11], s7 offen offset:2048 nt lds
    s_waitcnt vmcnt(5)
    buffer_load_dwordx4 v243, s[8:11], s7 offen offset:3072 nt lds
    s_add_u32 m0, s45, 8192
    s_add_u32 s7, s43, 8192
    s_waitcnt vmcnt(5)
    buffer_load_dwordx4 v240, s[8:11], s7 offen nt lds
    s_waitcnt vmcnt(5)
    buffer_load_dwordx4 v241, s[8:11], s7 offen offset:1024 nt lds
    s_waitcnt vmcnt(5)
    buffer_load_dwordx4 v242, s[8:11], s7 offen offset:2048 nt lds
    s_add_u32 s45, s45, 16384
    s_cmp_eq_u32 s45, 49152
    s_cselect_b32 s45, 0, s45
    s_add_u32 s43, s43, 16384
    s_add_u32 s46, s46, 16384
    s_cmp_eq_u32 s46, 98304
    s_cselect_b32 s46, 49152, s46
    s_add_u32 s44, s44, 16384
    v_mov_b32 v0, 0
    v_mov_b32 v1, 0
    v_mov_b32 v2, 0
    v_mov_b32 v3, 0
    v_mov_b32 v4, 0
    v_mov_b32 v5, 0
    v_mov_b32 v6, 0
    v_mov_b32 v7, 0
    v_mov_b32 v8, 0
    v_mov_b32 v9, 0
    v_mov_b32 v10, 0
    v_mov_b32 v11, 0
    v_mov_b32 v12, 0
    v_mov_b32 v13, 0
    v_mov_b32 v14, 0
    v_mov_b32 v15, 0
    v_mov_b32 v16, 0
    v_mov_b32 v17, 0
    v_mov_b32 v18, 0
    v_mov_b32 v19, 0
    v_mov_b32 v20, 0
    v_mov_b32 v21, 0
    v_mov_b32 v22, 0
    v_mov_b32 v23, 0
    v_mov_b32 v24, 0
    v_mov_b32 v25, 0
    v_mov_b32 v26, 0
    v_mov_b32 v27, 0
    v_mov_b32 v28, 0
    v_mov_b32 v29, 0
    v_mov_b32 v30, 0
    v_mov_b32 v31, 0
    v_mov_b32 v32, 0
    v_mov_b32 v33, 0
    v_mov_b32 v34, 0
    v_mov_b32 v35, 0
    v_mov_b32 v36, 0
    v_mov_b32 v37, 0
    v_mov_b32 v38, 0
    v_mov_b32 v39, 0
    v_mov_b32 v40, 0
    v_mov_b32 v41, 0
    v_mov_b32 v42, 0
    v_mov_b32 v43, 0
    v_mov_b32 v44, 0
    v_mov_b32 v45, 0
    v_mov_b32 v46, 0
    v_mov_b32 v47, 0
    v_mov_b32 v48, 0
    v_mov_b32 v49, 0
    v_mov_b32 v50, 0
    v_mov_b32 v51, 0
    v_mov_b32 v52, 0
    v_mov_b32 v53, 0
    v_mov_b32 v54, 0
    v_mov_b32 v55, 0
    v_mov_b32 v56, 0
    v_mov_b32 v57, 0
    v_mov_b32 v58, 0
    v_mov_b32 v59, 0
    v_mov_b32 v60, 0
    v_mov_b32 v61, 0
    v_mov_b32 v62, 0
    v_mov_b32 v63, 0
    v_mov_b32 v64, 0
    v_mov_b32 v65, 0
    v_mov_b32 v66, 0
    v_mov_b32 v67, 0
    v_mov_b32 v68, 0
    v_mov_b32 v69, 0
    v_mov_b32 v70, 0
    v_mov_b32 v71, 0
    v_mov_b32 v72, 0
    v_mov_b32 v73, 0
    v_mov_b32 v74, 0
    v_mov_b32 v75, 0
    v_mov_b32 v76, 0
    v_mov_b32 v77, 0
    v_mov_b32 v78, 0
    v_mov_b32 v79, 0
    v_mov_b32 v80, 0
    v_mov_b32 v81, 0
    v_mov_b32 v82, 0
    v_mov_b32 v83, 0
    v_mov_b32 v84, 0
    v_mov_b32 v85, 0
    v_mov_b32 v86, 0
    v_mov_b32 v87, 0
    v_mov_b32 v88, 0
    v_mov_b32 v89, 0
    v_mov_b32 v90, 0
    v_mov_b32 v91, 0
    v_mov_b32 v92, 0
    v_mov_b32 v93, 0
    v_mov_b32 v94, 0
    v_mov_b32 v95, 0
    v_mov_b32 v128, 0
    s_and_b32 s6, s2, 3
    s_mul_i32 s6, s6, 81920
    s_add_u32 s6, s6, s72
    buffer_load_dword v129, v128, s[24:27], s6 offen
    s_waitcnt vmcnt(12)
    s_mul_i32 s66, s64, 3
    s_mul_i32 s6, s65, 2
    s_add_u32 s66, s66, s6
    s_mov_b32 s42, 3
L_kva_h0:
    s_barrier
    s_add_u32 m0, s45, 0
    s_add_u32 s7, s43, 0
    s_waitcnt vmcnt(5)
    buffer_load_dwordx4 v240, s[8:11], s7 offen nt lds
    s_waitcnt vmcnt(5)
    buffer_load_dwordx4 v241, s[8:11], s7 offen offset:1024 nt lds
    s_waitcnt vmcnt(5)
    buffer_load_dwordx4 v242, s[8:11], s7 offen offset:2048 nt lds
    s_waitcnt vmcnt(5)
    buffer_load_dwordx4 v243, s[8:11], s7 offen offset:3072 nt lds
    s_add_u32 m0, s45, 4096
    s_add_u32 s7, s43, 4096
    s_waitcnt vmcnt(5)
    buffer_load_dwordx4 v240, s[8:11], s7 offen nt lds
    s_waitcnt vmcnt(5)
    buffer_load_dwordx4 v241, s[8:11], s7 offen offset:1024 nt lds
    s_waitcnt vmcnt(5)
    buffer_load_dwordx4 v242, s[8:11], s7 offen offset:2048 nt lds
    s_waitcnt vmcnt(5)
    buffer_load_dwordx4 v243, s[8:11], s7 offen offset:3072 nt lds
    s_add_u32 m0, s45, 8192
    s_add_u32 s7, s43, 8192
    s_waitcnt vmcnt(5)
    buffer_load_dwordx4 v240, s[8:11], s7 offen nt lds
    s_waitcnt vmcnt(5)
    buffer_load_dwordx4 v241, s[8:11], s7 offen offset:1024 nt lds
    s_waitcnt vmcnt(5)
    buffer_load_dwordx4 v242, s[8:11], s7 offen offset:2048 nt lds
    s_add_u32 s45, s45, 16384
    s_cmp_eq_u32 s45, 49152
    s_cselect_b32 s45, 0, s45
    s_add_u32 s43, s43, 16384
    s_add_u32 s46, s46, 16384
    s_cmp_eq_u32 s46, 98304
    s_cselect_b32 s46, 49152, s46
    s_add_u32 s44, s44, 16384
    s_add_u32 s42, s42, 1
    s_cmp_le_u32 s42, 18
    s_waitcnt vmcnt(11)
    s_cbranch_scc1 L_kva_h0
    s_mov_b32 s42, 19
L_kvb_h0:
    s_barrier
    s_add_u32 m0, s45, 0
    s_add_u32 s7, s43, 0
    s_waitcnt vmcnt(5)
    buffer_load_dwordx4 v240, s[8:11], s7 offen nt lds
    s_waitcnt vmcnt(5)
    buffer_load_dwordx4 v241, s[8:11], s7 offen offset:1024 nt lds
    s_waitcnt vmcnt(5)
    buffer_load_dwordx4 v242, s[8:11], s7 offen offset:2048 nt lds
    s_waitcnt vmcnt(5)
    buffer_load_dwordx4 v243, s[8:11], s7 offen offset:3072 nt lds
    s_add_u32 m0, s45, 4096
    s_add_u32 s7, s43, 4096
    s_waitcnt vmcnt(5)
    buffer_load_dwordx4 v240, s[8:11], s7 offen nt lds
    s_waitcnt vmcnt(5)
    buffer_load_dwordx4 v241, s[8:11], s7 offen offset:1024 nt lds
    s_waitcnt vmcnt(5)
    buffer_load_dwordx4 v242, s[8:11], s7 offen offset:2048 nt lds
    s_waitcnt vmcnt(5)
    buffer_load_dwordx4 v243, s[8:11], s7 offen offset:3072 nt lds
    s_add_u32 m0, s45, 8192
    s_add_u32 s7, s43, 8192
    s_waitcnt vmcnt(5)
    buffer_load_dwordx4 v240, s[8:11], s7 offen nt lds
    s_waitcnt vmcnt(5)
    buffer_load_dwordx4 v241, s[8:11], s7 offen offset:1024 nt lds
    s_waitcnt vmcnt(5)
    buffer_load_dwordx4 v242, s[8:11], s7 offen offset:2048 nt lds
    s_add_u32 s45, s45, 16384
    s_cmp_eq_u32 s45, 49152
    s_cselect_b32 s45, 0, s45
    s_add_u32 s43, s43, 16384
    s_add_u32 s46, s46, 16384
    s_cmp_eq_u32 s46, 98304
    s_cselect_b32 s46, 49152, s46
    s_add_u32 s44, s44, 16384
    s_add_u32 s42, s42, 1
    s_cmp_le_u32 s42, 28
    s_waitcnt vmcnt(11)
    s_cbranch_scc1 L_kvb_h0
    s_barrier
    s_cmp_eq_u32 s68, 0
    s_cbranch_scc1 L_notile_h0
    s_mov_b32 s63, 0
    s_mov_b32 s52, 98304
    s_add_u32 s51, s63, s66
    s_bfe_u32 s49, s51, 0x20002
    s_lshl_b32 s49, s49, 3
    s_and_b32 s51, s51, 3
    s_add_u32 s49, s49, s51
    s_lshr_b32 s51, s63, 4
    s_lshl2_add_u32 s49, s51, s49
    s_add_u32 s63, s63, 1
    s_mul_i32 s48, s49, 40960
    s_add_u32 s48, s48, s61
    s_add_u32 m0, s52, 0
    s_add_u32 s6, s48, 0
    buffer_load_dwordx4 v251, s[28:31], s6 offen lds
    s_add_u32 m0, s52, 1024
    s_add_u32 s6, s48, 5120
    buffer_load_dwordx4 v252, s[28:31], s6 offen lds
    s_mov_b32 s63, 1
    s_mov_b32 s52, 106496
    s_add_u32 s51, s63, s66
    s_bfe_u32 s49, s51, 0x20002
    s_lshl_b32 s49, s49, 3
    s_and_b32 s51, s51, 3
    s_add_u32 s49, s49, s51
    s_lshr_b32 s51, s63, 4
    s_lshl2_add_u32 s49, s51, s49
    s_add_u32 s63, s63, 1
    s_mul_i32 s48, s49, 40960
    s_add_u32 s48, s48, s61
    s_add_u32 m0, s52, 0
    s_add_u32 s6, s48, 0
    buffer_load_dwordx4 v251, s[28:31], s6 offen lds
    s_add_u32 m0, s52, 1024
    s_add_u32 s6, s48, 5120
    buffer_load_dwordx4 v252, s[28:31], s6 offen lds
    s_mov_b32 s63, 2
    s_mov_b32 s52, 114688
    s_add_u32 s51, s63, s66
    s_bfe_u32 s49, s51, 0x20002
    s_lshl_b32 s49, s49, 3
    s_and_b32 s51, s51, 3
    s_add_u32 s49, s49, s51
    s_lshr_b32 s51, s63, 4
    s_lshl2_add_u32 s49, s51, s49
    s_add_u32 s63, s63, 1
    s_mul_i32 s48, s49, 40960
    s_add_u32 s48, s48, s61
    s_add_u32 m0, s52, 0
    s_add_u32 s6, s48, 0
    buffer_load_dwordx4 v251, s[28:31], s6 offen lds
    s_add_u32 m0, s52, 1024
    s_add_u32 s6, s48, 5120
    buffer_load_dwordx4 v252, s[28:31], s6 offen lds
    s_mov_b32 s63, 3
    s_mov_b32 s52, 122880
    s_add_u32 s51, s63, s66
    s_bfe_u32 s49, s51, 0x20002
    s_lshl_b32 s49, s49, 3
    s_and_b32 s51, s51, 3
    s_add_u32 s49, s49, s51
    s_lshr_b32 s51, s63, 4
    s_lshl2_add_u32 s49, s51, s49
    s_add_u32 s63, s63, 1
    s_mul_i32 s48, s49, 40960
    s_add_u32 s48, s48, s61
    s_add_u32 m0, s52, 0
    s_add_u32 s6, s48, 0
    buffer_load_dwordx4 v251, s[28:31], s6 offen lds
    s_add_u32 m0, s52, 1024
    s_add_u32 s6, s48, 5120
    buffer_load_dwordx4 v252, s[28:31], s6 offen lds
    s_mov_b32 s63, 4
    s_mov_b32 s52, 131072
    s_add_u32 s51, s63, s66
    s_bfe_u32 s49, s51, 0x20002
    s_lshl_b32 s49, s49, 3
    s_and_b32 s51, s51, 3
    s_add_u32 s49, s49, s51
    s_lshr_b32 s51, s63, 4
    s_lshl2_add_u32 s49, s51, s49
    s_add_u32 s63, s63, 1
    s_mul_i32 s48, s49, 40960
    s_add_u32 s48, s48, s61
    s_add_u32 m0, s52, 0
    s_add_u32 s6, s48, 0
    buffer_load_dwordx4 v251, s[28:31], s6 offen lds
    s_add_u32 m0, s52, 1024
    s_add_u32 s6, s48, 5120
    buffer_load_dwordx4 v252, s[28:31], s6 offen lds
    s_mov_b32 s63, 5
    s_mov_b32 s52, 139264
    s_add_u32 s51, s63, s66
    s_bfe_u32 s49, s51, 0x20002
    s_lshl_b32 s49, s49, 3
    s_and_b32 s51, s51, 3
    s_add_u32 s49, s49, s51
    s_lshr_b32 s51, s63, 4
    s_lshl2_add_u32 s49, s51, s49
    s_add_u32 s63, s63, 1
    s_mul_i32 s48, s49, 40960
    s_add_u32 s48, s48, s61
    s_add_u32 m0, s52, 0
    s_add_u32 s6, s48, 0
    buffer_load_dwordx4 v251, s[28:31], s6 offen lds
    s_add_u32 m0, s52, 1024
    s_add_u32 s6, s48, 5120
    buffer_load_dwordx4 v252, s[28:31], s6 offen lds
    s_mov_b32 s63, 6
    s_mov_b32 s52, 32768
    s_add_u32 s51, s63, s66
    s_bfe_u32 s49, s51, 0x20002
    s_lshl_b32 s49, s49, 3
    s_and_b32 s51, s51, 3
    s_add_u32 s49, s49, s51
    s_lshr_b32 s51, s63, 4
    s_lshl2_add_u32 s49, s51, s49
    s_add_u32 s63, s63, 1
    s_mul_i32 s48, s49, 40960
    s_add_u32 s48, s48, s61
    s_add_u32 m0, s52, 0
    s_add_u32 s6, s48, 0
    buffer_load_dwordx4 v251, s[28:31], s6 offen lds
    s_add_u32 m0, s52, 1024
    s_add_u32 s6, s48, 5120
    buffer_load_dwordx4 v252, s[28:31], s6 offen lds
    s_mov_b32 s63, 7
    s_mov_b32 s52, 40960
    s_add_u32 s51, s63, s66
    s_bfe_u32 s49, s51, 0x20002
    s_lshl_b32 s49, s49, 3
    s_and_b32 s51, s51, 3
    s_add_u32 s49, s49, s51
    s_lshr_b32 s51, s63, 4
    s_lshl2_add_u32 s49, s51, s49
    s_add_u32 s63, s63, 1
    s_mul_i32 s48, s49, 40960
    s_add_u32 s48, s48, s61
    s_add_u32 m0, s52, 0
    s_add_u32 s6, s48, 0
    buffer_load_dwordx4 v251, s[28:31], s6 offen lds
    s_add_u32 m0, s52, 1024
    s_add_u32 s6, s48, 5120
    buffer_load_dwordx4 v252, s[28:31], s6 offen lds
    s_mul_i32 s6, s73, 7282
    s_lshr_b32 s6, s6, 20
    s_and_b32 s6, s6, 7
    s_lshl_b32 s6, s6, 7
    v_lshlrev_b32 v249, 3, v246
    v_and_b32 v249, 3072, v249
    v_add_u32 v249, s6, v249
    buffer_load_dword v250, v249, s[24:27], s67 offen sc1
    s_waitcnt vmcnt(17)
    s_barrier
    s_mov_b32 s63, 8
    s_mov_b32 s52, 0
    s_add_u32 s51, s63, s66
    s_bfe_u32 s49, s51, 0x20002
    s_lshl_b32 s49, s49, 3
    s_and_b32 s51, s51, 3
    s_add_u32 s49, s49, s51
    s_lshr_b32 s51, s63, 4
    s_lshl2_add_u32 s49, s51, s49
    s_add_u32 s63, s63, 1
    s_mul_i32 s48, s49, 40960
    s_add_u32 s48, s48, s61
    s_add_u32 m0, s52, 0
    s_add_u32 s6, s48, 0
    buffer_load_dwordx4 v251, s[28:31], s6 offen lds
    s_add_u32 m0, s52, 1024
    s_add_u32 s6, s48, 5120
    buffer_load_dwordx4 v252, s[28:31], s6 offen lds
    s_mov_b32 s63, 9
    s_mov_b32 s52, 8192
    s_add_u32 s51, s63, s66
    s_bfe_u32 s49, s51, 0x20002
    s_lshl_b32 s49, s49, 3
    s_and_b32 s51, s51, 3
    s_add_u32 s49, s49, s51
    s_lshr_b32 s51, s63, 4
    s_lshl2_add_u32 s49, s51, s49
    s_add_u32 s63, s63, 1
    s_mul_i32 s48, s49, 40960
    s_add_u32 s48, s48, s61
    s_add_u32 m0, s52, 0
    s_add_u32 s6, s48, 0
    buffer_load_dwordx4 v251, s[28:31], s6 offen lds
    s_add_u32 m0, s52, 1024
    s_add_u32 s6, s48, 5120
    buffer_load_dwordx4 v252, s[28:31], s6 offen lds
    s_mov_b32 s63, 10
    s_mov_b32 s52, 81920
    s_add_u32 s51, s63, s66
    s_bfe_u32 s49, s51, 0x20002
    s_lshl_b32 s49, s49, 3
    s_and_b32 s51, s51, 3
    s_add_u32 s49, s49, s51
    s_lshr_b32 s51, s63, 4
    s_lshl2_add_u32 s49, s51, s49
    s_add_u32 s63, s63, 1
    s_mul_i32 s48, s49, 40960
    s_add_u32 s48, s48, s61
    s_add_u32 m0, s52, 0
    s_add_u32 s6, s48, 0
    buffer_load_dwordx4 v251, s[28:31], s6 offen lds
    s_add_u32 m0, s52, 1024
    s_add_u32 s6, s48, 5120
    buffer_load_dwordx4 v252, s[28:31], s6 offen lds
    s_mov_b32 s63, 11
    s_mov_b32 s52, 90112
    s_add_u32 s51, s63, s66
    s_bfe_u32 s49, s51, 0x20002
    s_lshl_b32 s49, s49, 3
    s_and_b32 s51, s51, 3
    s_add_u32 s49, s49, s51
    s_lshr_b32 s51, s63, 4
    s_lshl2_add_u32 s49, s51, s49
    s_add_u32 s63, s63, 1
    s_mul_i32 s48, s49, 40960
    s_add_u32 s48, s48, s61
    s_add_u32 m0, s52, 0
    s_add_u32 s6, s48, 0
    buffer_load_dwordx4 v251, s[28:31], s6 offen lds
    s_add_u32 m0, s52, 1024
    s_add_u32 s6, s48, 5120
    buffer_load_dwordx4 v252, s[28:31], s6 offen lds
    s_waitcnt vmcnt(8)
    v_cmp_ne_u32 vcc, s62, v250
    s_nop 0
    s_cmp_eq_u64 vcc, 0
    s_cbranch_scc1 L_spx_o1h0
    s_mov_b32 s53, 0
L_sp_o1h0:
    s_add_u32 s53, s53, 1
    s_cmp_gt_u32 s53, 400000
    s_cbranch_scc1 L_spx_o1h0
    buffer_load_dword v250, v249, s[24:27], s67 offen sc1
    s_waitcnt vmcnt(0)
    v_cmp_ne_u32 vcc, s62, v250
    s_nop 0
    s_cmp_eq_u64 vcc, 0
    s_cbranch_scc0 L_sp_o1h0
L_spx_o1h0:
    s_mov_b32 s63, 0
    s_add_u32 s51, s63, s66
    s_bfe_u32 s49, s51, 0x20002
    s_lshl_b32 s49, s49, 3
    s_and_b32 s51, s51, 3
    s_add_u32 s49, s49, s51
    s_lshr_b32 s51, s63, 4
    s_lshl2_add_u32 s49, s51, s49
    s_add_u32 s63, s63, 1
    s_lshl_b32 s49, s49, 10
    s_add_u32 s49, s49, s60
    s_add_u32 s6, s49, 0
    buffer_load_dwordx4 v[128:131], v246, s[24:27], s6 offen sc1
    s_add_u32 s6, s49, 131072
    buffer_load_dwordx4 v[132:135], v246, s[24:27], s6 offen sc1
    s_add_u32 s6, s49, 262144
    buffer_load_dwordx4 v[136:139], v246, s[24:27], s6 offen sc1
    s_add_u32 s51, s63, s66
    s_bfe_u32 s49, s51, 0x20002
    s_lshl_b32 s49, s49, 3
    s_and_b32 s51, s51, 3
    s_add_u32 s49, s49, s51
    s_lshr_b32 s51, s63, 4
    s_lshl2_add_u32 s49, s51, s49
    s_add_u32 s63, s63, 1
    s_lshl_b32 s49, s49, 10
    s_add_u32 s49, s49, s60
    s_add_u32 s6, s49, 0
    buffer_load_dwordx4 v[144:147], v246, s[24:27], s6 offen sc1
    s_add_u32 s6, s49, 131072
    buffer_load_dwordx4 v[148:151], v246, s[24:27], s6 offen sc1
    s_add_u32 s6, s49, 262144
    buffer_load_dwordx4 v[152:155], v246, s[24:27], s6 offen sc1
    s_add_u32 s51, s63, s66
    s_bfe_u32 s49, s51, 0x20002
    s_lshl_b32 s49, s49, 3
    s_and_b32 s51, s51, 3
    s_add_u32 s49, s49, s51
    s_lshr_b32 s51, s63, 4
    s_lshl2_add_u32 s49, s51, s49
    s_add_u32 s63, s63, 1
    s_lshl_b32 s49, s49, 10
    s_add_u32 s49, s49, s60
    s_add_u32 s6, s49, 0
    buffer_load_dwordx4 v[160:163], v246, s[24:27], s6 offen sc1
    s_add_u32 s6, s49, 131072
    buffer_load_dwordx4 v[164:167], v246, s[24:27], s6 offen sc1
    s_add_u32 s6, s49, 262144
    buffer_load_dwordx4 v[168:171], v246, s[24:27], s6 offen sc1
    s_barrier
    s_mov_b32 s63, 12
    s_mov_b32 s52, 16384
    s_add_u32 s51, s63, s66
    s_bfe_u32 s49, s51, 0x20002
    s_lshl_b32 s49, s49, 3
    s_and_b32 s51, s51, 3
    s_add_u32 s49, s49, s51
    s_lshr_b32 s51, s63, 4
    s_lshl2_add_u32 s49, s51, s49
    s_add_u32 s63, s63, 1
    s_mul_i32 s48, s49, 40960
    s_add_u32 s48, s48, s61
    s_add_u32 m0, s52, 0
    s_add_u32 s6, s48, 0
    buffer_load_dwordx4 v251, s[28:31], s6 offen lds
    s_add_u32 m0, s52, 1024
    s_add_u32 s6, s48, 5120
    buffer_load_dwordx4 v252, s[28:31], s6 offen lds
    s_mov_b32 s63, 13
    s_mov_b32 s52, 24576
    s_add_u32 s51, s63, s66
    s_bfe_u32 s49, s51, 0x20002
    s_lshl_b32 s49, s49, 3
    s_and_b32 s51, s51, 3
    s_add_u32 s49, s49, s51
    s_lshr_b32 s51, s63, 4
    s_lshl2_add_u32 s49, s51, s49
    s_add_u32 s63, s63, 1
    s_mul_i32 s48, s49, 40960
    s_add_u32 s48, s48, s61
    s_add_u32 m0, s52, 0
    s_add_u32 s6, s48, 0
    buffer_load_dwordx4 v251, s[28:31], s6 offen lds
    s_add_u32 m0, s52, 1024
    s_add_u32 s6, s48, 5120
    buffer_load_dwordx4 v252, s[28:31], s6 offen lds
    s_mov_b32 s63, 14
    s_mov_b32 s52, 49152
    s_add_u32 s51, s63, s66
    s_bfe_u32 s49, s51, 0x20002
    s_lshl_b32 s49, s49, 3
    s_and_b32 s51, s51, 3
    s_add_u32 s49, s49, s51
    s_lshr_b32 s51, s63, 4
    s_lshl2_add_u32 s49, s51, s49
    s_add_u32 s63, s63, 1
    s_mul_i32 s48, s49, 40960
    s_add_u32 s48, s48, s61
    s_add_u32 m0, s52, 0
    s_add_u32 s6, s48, 0
    buffer_load_dwordx4 v251, s[28:31], s6 offen lds
    s_add_u32 m0, s52, 1024
    s_add_u32 s6, s48, 5120
    buffer_load_dwordx4 v252, s[28:31], s6 offen lds
    s_mov_b32 s63, 15
    s_mov_b32 s52, 57344
    s_add_u32 s51, s63, s66
    s_bfe_u32 s49, s51, 0x20002
    s_lshl_b32 s49, s49, 3
    s_and_b32 s51, s51, 3
    s_add_u32 s49, s49, s51
    s_lshr_b32 s51, s63, 4
    s_lshl2_add_u32 s49, s51, s49
    s_add_u32 s63, s63, 1
    s_mul_i32 s48, s49, 40960
    s_add_u32 s48, s48, s61
    s_add_u32 m0, s52, 0
    s_add_u32 s6, s48, 0
    buffer_load_dwordx4 v251, s[28:31], s6 offen lds
    s_add_u32 m0, s52, 1024
    s_add_u32 s6, s48, 5120
    buffer_load_dwordx4 v252, s[28:31], s6 offen lds
    s_mov_b32 s63, 3
    s_mov_b32 s50, 0
    s_mov_b32 s58, 0x43150287
    s_mov_b32 s59, 0x31502876
    s_add_u32 s54, s67, 4096
    v_add_u32 v224, 98304, v232
    v_add_u32 v225, 98304, v233
    v_add_u32 v226, 98304, v234
    v_add_u32 v227, 98304, v235
    v_add_u32 v228, 98304, v236
    v_add_u32 v229, 98304, v237
    v_add_u32 v230, 98304, v238
    v_add_u32 v231, 98304, v239
    ds_read_b64_tr_b16 v[192:193], v224
    ds_read_b64_tr_b16 v[194:195], v224 offset:4096
    ds_read_b64_tr_b16 v[196:197], v225
    ds_read_b64_tr_b16 v[198:199], v225 offset:4096
    ds_read_b64_tr_b16 v[200:201], v226
    ds_read_b64_tr_b16 v[202:203], v226 offset:4096
    ds_read_b64_tr_b16 v[204:205], v227
    ds_read_b64_tr_b16 v[206:207], v227 offset:4096
    ds_read_b64_tr_b16 v[208:209], v228
    ds_read_b64_tr_b16 v[210:211], v228 offset:4096
    ds_read_b64_tr_b16 v[212:213], v229
    ds_read_b64_tr_b16 v[214:215], v229 offset:4096
    ds_read_b64_tr_b16 v[216:217], v230
    ds_read_b64_tr_b16 v[218:219], v230 offset:4096
    ds_read_b64_tr_b16 v[220:221], v231
    ds_read_b64_tr_b16 v[222:223], v231 offset:4096
    s_waitcnt vmcnt(6)
    s_barrier
    s_branch L_t
L_notile_h0:
    s_waitcnt vmcnt(0)
    s_barrier
    s_waitcnt vmcnt(0)
    s_barrier
    s_branch L_end
L_h1:
    v_lshrrev_b32 v1, 4, v247
    v_and_b32 v2, 15, v247
    v_lshlrev_b32 v3, 2, v1
    v_xor_b32 v3, v3, v2
    v_lshlrev_b32 v3, 4, v3
    v_lshl_add_u32 v232, v1, 13, v3
    v_xor_b32 v233, 32, v232
    v_lshrrev_b32 v5, 3, v247
    v_mul_u32_u24 v5, 1280, v5
    v_and_b32 v6, 7, v247
    v_xor_b32 v4, 0, v1
    v_xor_b32 v4, v4, v6
    v_lshl_add_u32 v234, v4, 4, v5
    v_xor_b32 v4, 4, v1
    v_xor_b32 v4, v4, v6
    v_lshl_add_u32 v235, v4, 4, v5
    s_lshl_b32 s48, s38, 8
    s_mul_i32 s49, s37, 184320
    s_mov_b32 s52, 49152
    s_mov_b32 s53, 32768
    s_mov_b32 s54, 65536
    s_mov_b32 s55, 81920
    s_mov_b32 s56, 98304
    s_mov_b32 s60, s101
    s_mov_b32 s101, 0
    s_mov_b32 s57, s101
    s_mov_b32 s50, s48
    s_add_u32 s101, s60, 1
    s_add_u32 s57, s60, 1
    s_mov_b32 s52, 32768
    s_mov_b32 s53, 65536
    s_mov_b32 s54, 81920
    s_mov_b32 s55, 49152
    s_mov_b32 s56, 116736
    s_add_u32 m0, s52, 5120
    s_add_u32 s6, s50, 425984
    buffer_load_dwordx4 v232, s[20:23], s6 offen lds
    s_add_u32 m0, s52, 6144
    s_add_u32 s6, s50, 458752
    buffer_load_dwordx4 v233, s[20:23], s6 offen lds
    s_add_u32 m0, s52, 7168
    s_add_u32 s6, s50, 491520
    buffer_load_dwordx4 v233, s[20:23], s6 offen lds
    s_add_u32 m0, s52, 8192
    s_add_u32 s6, s50, 262400
    buffer_load_dwordx4 v232, s[20:23], s6 offen lds
    s_add_u32 m0, s52, 9216
    s_add_u32 s6, s50, 295168
    buffer_load_dwordx4 v232, s[20:23], s6 offen lds
    s_add_u32 m0, s52, 10240
    s_add_u32 s6, s50, 327936
    buffer_load_dwordx4 v233, s[20:23], s6 offen lds
    s_mov_b32 s4, s52
    s_mov_b32 s52, s53
    s_mov_b32 s53, s54
    s_mov_b32 s54, s55
    s_mov_b32 s55, s4
    s_lshl_b32 s50, s101, 19
    s_add_u32 s50, s50, s48
    s_add_u32 s101, s101, 1
    s_cmp_eq_u32 s101, 10
    s_cselect_b32 s101, 1, s101
    s_add_u32 m0, s52, 5120
    s_add_u32 s6, s50, 163840
    buffer_load_dwordx4 v232, s[20:23], s6 offen lds
    s_add_u32 m0, s52, 6144
    s_add_u32 s6, s50, 196608
    buffer_load_dwordx4 v233, s[20:23], s6 offen lds
    s_add_u32 m0, s52, 7168
    s_add_u32 s6, s50, 229376
    buffer_load_dwordx4 v233, s[20:23], s6 offen lds
    s_add_u32 m0, s52, 8192
    s_add_u32 s6, s50, 256
    buffer_load_dwordx4 v232, s[20:23], s6 offen lds
    s_add_u32 m0, s52, 9216
    s_add_u32 s6, s50, 33024
    buffer_load_dwordx4 v232, s[20:23], s6 offen lds
    s_add_u32 m0, s52, 10240
    s_add_u32 s6, s50, 65792
    buffer_load_dwordx4 v233, s[20:23], s6 offen lds
    s_mov_b32 s4, s52
    s_mov_b32 s52, s53
    s_mov_b32 s53, s54
    s_mov_b32 s54, s55
    s_mov_b32 s55, s4
    s_lshl_b32 s51, s57, 7
    s_add_u32 s51, s51, s49
    s_add_u32 s57, s57, 1
    s_cmp_eq_u32 s57, 10
    s_cselect_b32 s57, 1, s57
    s_add_u32 m0, s56, 6144
    s_add_u32 s6, s51, 61440
    buffer_load_dwordx4 v234, s[16:19], s6 offen lds
    s_add_u32 m0, s56, 7168
    s_add_u32 s6, s51, 71680
    buffer_load_dwordx4 v235, s[16:19], s6 offen lds
    s_add_u32 m0, s56, 8192
    s_add_u32 s6, s51, 81920
    buffer_load_dwordx4 v234, s[16:19], s6 offen lds
    s_add_u32 m0, s56, 9216
    s_add_u32 s6, s51, 92160
    buffer_load_dwordx4 v235, s[16:19], s6 offen lds
    s_add_u32 m0, s56, 10240
    s_add_u32 s6, s51, 102400
    buffer_load_dwordx4 v234, s[16:19], s6 offen lds
    s_add_u32 m0, s56, 11264
    s_add_u32 s6, s51, 112640
    buffer_load_dwordx4 v235, s[16:19], s6 offen lds
    s_add_u32 s56, s56, 18432
    s_cmp_eq_u32 s56, 153600
    s_cselect_b32 s56, 98304, s56
    v_add_u32 v4, 0, v1
    v_xor_b32 v4, v4, v2
    v_lshlrev_b32 v4, 4, v4
    v_lshl_add_u32 v240, v1, 8, v4
    v_add_u32 v4, 4, v1
    v_xor_b32 v4, v4, v2
    v_lshlrev_b32 v4, 4, v4
    v_lshl_add_u32 v241, v1, 8, v4
    v_add_u32 v4, 8, v1
    v_xor_b32 v4, v4, v2
    v_lshlrev_b32 v4, 4, v4
    v_lshl_add_u32 v242, v1, 8, v4
    v_add_u32 v4, 12, v1
    v_xor_b32 v4, v4, v2
    v_lshlrev_b32 v4, 4, v4
    v_lshl_add_u32 v243, v1, 8, v4
    v_lshl_add_u32 v244, v1, 8, v3
    v_xor_b32 v245, 32, v244
    s_waitcnt vmcnt(18)
    s_barrier
    s_add_u32 m0, s52, 5120
    s_add_u32 s6, s50, 425984
    buffer_load_dwordx4 v232, s[20:23], s6 offen lds
    s_add_u32 m0, s52, 6144
    s_add_u32 s6, s50, 458752
    buffer_load_dwordx4 v233, s[20:23], s6 offen lds
    s_add_u32 m0, s52, 7168
    s_add_u32 s6, s50, 491520
    buffer_load_dwordx4 v233, s[20:23], s6 offen lds
    s_add_u32 m0, s52, 8192
    s_add_u32 s6, s50, 262400
    buffer_load_dwordx4 v232, s[20:23], s6 offen lds
    s_add_u32 m0, s52, 9216
    s_add_u32 s6, s50, 295168
    buffer_load_dwordx4 v232, s[20:23], s6 offen lds
    s_add_u32 m0, s52, 10240
    s_add_u32 s6, s50, 327936
    buffer_load_dwordx4 v233, s[20:23], s6 offen lds
    s_mov_b32 s4, s52
    s_mov_b32 s52, s53
    s_mov_b32 s53, s54
    s_mov_b32 s54, s55
    s_mov_b32 s55, s4
    s_waitcnt vmcnt(18)
    s_barrier
    s_lshl_b32 s50, s101, 19
    s_add_u32 s50, s50, s48
    s_add_u32 s101, s101, 1
    s_cmp_eq_u32 s101, 10
    s_cselect_b32 s101, 1, s101
    s_add_u32 m0, s52, 5120
    s_add_u32 s6, s50, 163840
    buffer_load_dwordx4 v232, s[20:23], s6 offen lds
    s_add_u32 m0, s52, 6144
    s_add_u32 s6, s50, 196608
    buffer_load_dwordx4 v233, s[20:23], s6 offen lds
    s_add_u32 m0, s52, 7168
    s_add_u32 s6, s50, 229376
    buffer_load_dwordx4 v233, s[20:23], s6 offen lds
    s_add_u32 m0, s52, 8192
    s_add_u32 s6, s50, 256
    buffer_load_dwordx4 v232, s[20:23], s6 offen lds
    s_add_u32 m0, s52, 9216
    s_add_u32 s6, s50, 33024
    buffer_load_dwordx4 v232, s[20:23], s6 offen lds
    s_add_u32 m0, s52, 10240
    s_add_u32 s6, s50, 65792
    buffer_load_dwordx4 v233, s[20:23], s6 offen lds
    s_mov_b32 s4, s52
    s_mov_b32 s52, s53
    s_mov_b32 s53, s54
    s_mov_b32 s54, s55
    s_mov_b32 s55, s4
    s_lshl_b32 s51, s57, 7
    s_add_u32 s51, s51, s49
    s_add_u32 s57, s57, 1
    s_cmp_eq_u32 s57, 10
    s_cselect_b32 s57, 1, s57
    s_add_u32 m0, s56, 6144
    s_add_u32 s6, s51, 61440
    buffer_load_dwordx4 v234, s[16:19], s6 offen lds
    s_add_u32 m0, s56, 7168
    s_add_u32 s6, s51, 71680
    buffer_load_dwordx4 v235, s[16:19], s6 offen lds
    s_add_u32 m0, s56, 8192
    s_add_u32 s6, s51, 81920
    buffer_load_dwordx4 v234, s[16:19], s6 offen lds
    s_add_u32 m0, s56, 9216
    s_add_u32 s6, s51, 92160
    buffer_load_dwordx4 v235, s[16:19], s6 offen lds
    s_add_u32 m0, s56, 10240
    s_add_u32 s6, s51, 102400
    buffer_load_dwordx4 v234, s[16:19], s6 offen lds
    s_add_u32 m0, s56, 11264
    s_add_u32 s6, s51, 112640
    buffer_load_dwordx4 v235, s[16:19], s6 offen lds
    s_add_u32 s56, s56, 18432
    s_cmp_eq_u32 s56, 153600
    s_cselect_b32 s56, 98304, s56
    s_waitcnt vmcnt(18)
    s_barrier
    s_add_u32 m0, s52, 5120
    s_add_u32 s6, s50, 425984
    buffer_load_dwordx4 v232, s[20:23], s6 offen lds
    s_add_u32 m0, s52, 6144
    s_add_u32 s6, s50, 458752
    buffer_load_dwordx4 v233, s[20:23], s6 offen lds
    s_add_u32 m0, s52, 7168
    s_add_u32 s6, s50, 491520
    buffer_load_dwordx4 v233, s[20:23], s6 offen lds
    s_add_u32 m0, s52, 8192
    s_add_u32 s6, s50, 262400
    buffer_load_dwordx4 v232, s[20:23], s6 offen lds
    s_add_u32 m0, s52, 9216
    s_add_u32 s6, s50, 295168
    buffer_load_dwordx4 v232, s[20:23], s6 offen lds
    s_add_u32 m0, s52, 10240
    s_add_u32 s6, s50, 327936
    buffer_load_dwordx4 v233, s[20:23], s6 offen lds
    s_mov_b32 s4, s52
    s_mov_b32 s52, s53
    s_mov_b32 s53, s54
    s_mov_b32 s54, s55
    s_mov_b32 s55, s4
    s_mov_b32 m0, 4096
    s_add_u32 s6, s39, 4096
    buffer_load_dwordx4 v240, s[8:11], s6 offen nt lds
    buffer_load_dwordx4 v241, s[8:11], s6 offen offset:1024 nt lds
    buffer_load_dwordx4 v242, s[8:11], s6 offen offset:2048 nt lds
    buffer_load_dwordx4 v243, s[8:11], s6 offen offset:3072 nt lds
    s_waitcnt vmcnt(22)
    s_barrier
    s_lshl_b32 s50, s101, 19
    s_add_u32 s50, s50, s48
    s_add_u32 s101, s101, 1
    s_cmp_eq_u32 s101, 10
    s_cselect_b32 s101, 1, s101
    s_add_u32 m0, s52, 5120
    s_add_u32 s6, s50, 163840
    buffer_load_dwordx4 v232, s[20:23], s6 offen lds
    s_add_u32 m0, s52, 6144
    s_add_u32 s6, s50, 196608
    buffer_load_dwordx4 v233, s[20:23], s6 offen lds
    s_add_u32 m0, s52, 7168
    s_add_u32 s6, s50, 229376
    buffer_load_dwordx4 v233, s[20:23], s6 offen lds
    s_add_u32 m0, s52, 8192
    s_add_u32 s6, s50, 256
    buffer_load_dwordx4 v232, s[20:23], s6 offen lds
    s_add_u32 m0, s52, 9216
    s_add_u32 s6, s50, 33024
    buffer_load_dwordx4 v232, s[20:23], s6 offen lds
    s_add_u32 m0, s52, 10240
    s_add_u32 s6, s50, 65792
    buffer_load_dwordx4 v233, s[20:23], s6 offen lds
    s_mov_b32 s4, s52
    s_mov_b32 s52, s53
    s_mov_b32 s53, s54
    s_mov_b32 s54, s55
    s_mov_b32 s55, s4
    s_lshl_b32 s51, s57, 7
    s_add_u32 s51, s51, s49
    s_add_u32 s57, s57, 1
    s_cmp_eq_u32 s57, 10
    s_cselect_b32 s57, 1, s57
    s_add_u32 m0, s56, 6144
    s_add_u32 s6, s51, 61440
    buffer_load_dwordx4 v234, s[16:19], s6 offen lds
    s_add_u32 m0, s56, 7168
    s_add_u32 s6, s51, 71680
    buffer_load_dwordx4 v235, s[16:19], s6 offen lds
    s_add_u32 m0, s56, 8192
    s_add_u32 s6, s51, 81920
    buffer_load_dwordx4 v234, s[16:19], s6 offen lds
    s_add_u32 m0, s56, 9216
    s_add_u32 s6, s51, 92160
    buffer_load_dwordx4 v235, s[16:19], s6 offen lds
    s_add_u32 m0, s56, 10240
    s_add_u32 s6, s51, 102400
    buffer_load_dwordx4 v234, s[16:19], s6 offen lds
    s_add_u32 m0, s56, 11264
    s_add_u32 s6, s51, 112640
    buffer_load_dwordx4 v235, s[16:19], s6 offen lds
    s_add_u32 s56, s56, 18432
    s_cmp_eq_u32 s56, 153600
    s_cselect_b32 s56, 98304, s56
    s_waitcnt vmcnt(22)
    s_barrier
    s_add_u32 m0, s52, 5120
    s_add_u32 s6, s50, 425984
    buffer_load_dwordx4 v232, s[20:23], s6 offen lds
    s_add_u32 m0, s52, 6144
    s_add_u32 s6, s50, 458752
    buffer_load_dwordx4 v233, s[20:23], s6 offen lds
    s_add_u32 m0, s52, 7168
    s_add_u32 s6, s50, 491520
    buffer_load_dwordx4 v233, s[20:23], s6 offen lds
    s_add_u32 m0, s52, 8192
    s_add_u32 s6, s50, 262400
    buffer_load_dwordx4 v232, s[20:23], s6 offen lds
    s_add_u32 m0, s52, 9216
    s_add_u32 s6, s50, 295168
    buffer_load_dwordx4 v232, s[20:23], s6 offen lds
    s_add_u32 m0, s52, 10240
    s_add_u32 s6, s50, 327936
    buffer_load_dwordx4 v233, s[20:23], s6 offen lds
    s_mov_b32 s4, s52
    s_mov_b32 s52, s53
    s_mov_b32 s53, s54
    s_mov_b32 s54, s55
    s_mov_b32 s55, s4
    s_mov_b32 m0, 20480
    s_add_u32 s6, s39, 20480
    buffer_load_dwordx4 v240, s[8:11], s6 offen nt lds
    buffer_load_dwordx4 v241, s[8:11], s6 offen offset:1024 nt lds
    buffer_load_dwordx4 v242, s[8:11], s6 offen offset:2048 nt lds
    buffer_load_dwordx4 v243, s[8:11], s6 offen offset:3072 nt lds
    s_mov_b32 m0, 28672
    s_add_u32 s6, s39, 28672
    buffer_load_dwordx4 v240, s[8:11], s6 offen nt lds
    buffer_load_dwordx4 v241, s[8:11], s6 offen offset:1024 nt lds
    buffer_load_dwordx4 v242, s[8:11], s6 offen offset:2048 nt lds
    buffer_load_dwordx4 v243, s[8:11], s6 offen offset:3072 nt lds
    s_mov_b32 s42, 2
L_p_h1:
    s_waitcnt vmcnt(18)
    s_barrier
    s_lshl_b32 s50, s101, 19
    s_add_u32 s50, s50, s48
    s_add_u32 s101, s101, 1
    s_cmp_eq_u32 s101, 10
    s_cselect_b32 s101, 1, s101
    s_add_u32 m0, s52, 5120
    s_add_u32 s6, s50, 163840
    buffer_load_dwordx4 v232, s[20:23], s6 offen lds
    s_add_u32 m0, s52, 6144
    s_add_u32 s6, s50, 196608
    buffer_load_dwordx4 v233, s[20:23], s6 offen lds
    s_add_u32 m0, s52, 7168
    s_add_u32 s6, s50, 229376
    buffer_load_dwordx4 v233, s[20:23], s6 offen lds
    s_add_u32 m0, s52, 8192
    s_add_u32 s6, s50, 256
    buffer_load_dwordx4 v232, s[20:23], s6 offen lds
    s_add_u32 m0, s52, 9216
    s_add_u32 s6, s50, 33024
    buffer_load_dwordx4 v232, s[20:23], s6 offen lds
    s_add_u32 m0, s52, 10240
    s_add_u32 s6, s50, 65792
    buffer_load_dwordx4 v233, s[20:23], s6 offen lds
    s_mov_b32 s4, s52
    s_mov_b32 s52, s53
    s_mov_b32 s53, s54
    s_mov_b32 s54, s55
    s_mov_b32 s55, s4
    s_lshl_b32 s51, s57, 7
    s_add_u32 s51, s51, s49
    s_add_u32 s57, s57, 1
    s_cmp_eq_u32 s57, 10
    s_cselect_b32 s57, 1, s57
    s_add_u32 m0, s56, 6144
    s_add_u32 s6, s51, 61440
    buffer_load_dwordx4 v234, s[16:19], s6 offen lds
    s_add_u32 m0, s56, 7168
    s_add_u32 s6, s51, 71680
    buffer_load_dwordx4 v235, s[16:19], s6 offen lds
    s_add_u32 m0, s56, 8192
    s_add_u32 s6, s51, 81920
    buffer_load_dwordx4 v234, s[16:19], s6 offen lds
    s_add_u32 m0, s56, 9216
    s_add_u32 s6, s51, 92160
    buffer_load_dwordx4 v235, s[16:19], s6 offen lds
    s_add_u32 m0, s56, 10240
    s_add_u32 s6, s51, 102400
    buffer_load_dwordx4 v234, s[16:19], s6 offen lds
    s_add_u32 m0, s56, 11264
    s_add_u32 s6, s51, 112640
    buffer_load_dwordx4 v235, s[16:19], s6 offen lds
    s_add_u32 s56, s56, 18432
    s_cmp_eq_u32 s56, 153600
    s_cselect_b32 s56, 98304, s56
    s_waitcnt vmcnt(18)
    s_barrier
    s_add_u32 m0, s52, 5120
    s_add_u32 s6, s50, 425984
    buffer_load_dwordx4 v232, s[20:23], s6 offen lds
    s_add_u32 m0, s52, 6144
    s_add_u32 s6, s50, 458752
    buffer_load_dwordx4 v233, s[20:23], s6 offen lds
    s_add_u32 m0, s52, 7168
    s_add_u32 s6, s50, 491520
    buffer_load_dwordx4 v233, s[20:23], s6 offen lds
    s_add_u32 m0, s52, 8192
    s_add_u32 s6, s50, 262400
    buffer_load_dwordx4 v232, s[20:23], s6 offen lds
    s_add_u32 m0, s52, 9216
    s_add_u32 s6, s50, 295168
    buffer_load_dwordx4 v232, s[20:23], s6 offen lds
    s_add_u32 m0, s52, 10240
    s_add_u32 s6, s50, 327936
    buffer_load_dwordx4 v233, s[20:23], s6 offen lds
    s_mov_b32 s4, s52
    s_mov_b32 s52, s53
    s_mov_b32 s53, s54
    s_mov_b32 s54, s55
    s_mov_b32 s55, s4
    s_add_u32 s42, s42, 1
    s_cmp_lt_u32 s42, 8
    s_cbranch_scc1 L_p_h1
    s_waitcnt vmcnt(18)
    s_barrier
    s_mov_b32 m0, 53248
    s_add_u32 s6, s39, 4096
    buffer_load_dwordx4 v244, s[12:15], s6 offen nt lds
    buffer_load_dwordx4 v245, s[12:15], s6 offen offset:1024 nt lds
    buffer_load_dwordx4 v244, s[12:15], s6 offen offset:2048 nt lds
    buffer_load_dwordx4 v245, s[12:15], s6 offen offset:3072 nt lds
    s_waitcnt vmcnt(10)
    s_barrier
    s_mov_b32 m0, 36864
    s_add_u32 s6, s39, 36864
    buffer_load_dwordx4 v240, s[8:11], s6 offen nt lds
    buffer_load_dwordx4 v241, s[8:11], s6 offen offset:1024 nt lds
    buffer_load_dwordx4 v242, s[8:11], s6 offen offset:2048 nt lds
    buffer_load_dwordx4 v243, s[8:11], s6 offen offset:3072 nt lds
    s_waitcnt vmcnt(8)
    s_barrier
    s_mov_b32 m0, 69632
    s_add_u32 s6, s39, 20480
    buffer_load_dwordx4 v244, s[12:15], s6 offen nt lds
    buffer_load_dwordx4 v245, s[12:15], s6 offen offset:1024 nt lds
    buffer_load_dwordx4 v244, s[12:15], s6 offen offset:2048 nt lds
    buffer_load_dwordx4 v245, s[12:15], s6 offen offset:3072 nt lds
    s_mov_b32 m0, 77824
    s_add_u32 s6, s39, 28672
    buffer_load_dwordx4 v244, s[12:15], s6 offen nt lds
    buffer_load_dwordx4 v245, s[12:15], s6 offen offset:1024 nt lds
    buffer_load_dwordx4 v244, s[12:15], s6 offen offset:2048 nt lds
    buffer_load_dwordx4 v245, s[12:15], s6 offen offset:3072 nt lds
    s_barrier
    s_barrier
    s_waitcnt vmcnt(12) lgkmcnt(0)
    s_barrier
    s_mov_b32 m0, 86016
    s_add_u32 s6, s39, 36864
    buffer_load_dwordx4 v244, s[12:15], s6 offen nt lds
    buffer_load_dwordx4 v245, s[12:15], s6 offen offset:1024 nt lds
    buffer_load_dwordx4 v244, s[12:15], s6 offen offset:2048 nt lds
    buffer_load_dwordx4 v245, s[12:15], s6 offen offset:3072 nt lds
    s_mov_b32 m0, 4096
    s_add_u32 s6, s39, 53248
    buffer_load_dwordx4 v240, s[8:11], s6 offen nt lds
    buffer_load_dwordx4 v241, s[8:11], s6 offen offset:1024 nt lds
    buffer_load_dwordx4 v242, s[8:11], s6 offen offset:2048 nt lds
    buffer_load_dwordx4 v243, s[8:11], s6 offen offset:3072 nt lds
    s_mov_b32 s45, 16384
    s_mov_b32 s46, 49152
    s_add_u32 s43, s39, 65536
    s_add_u32 s44, s39, 49152
    s_waitcnt vmcnt(8)
    s_barrier
    s_add_u32 m0, s45, 8192
    s_add_u32 s7, s43, 8192
    s_waitcnt vmcnt(5)
    buffer_load_dwordx4 v243, s[8:11], s7 offen offset:3072 nt lds
    s_add_u32 m0, s45, 12288
    s_add_u32 s7, s43, 12288
    s_waitcnt vmcnt(5)
    buffer_load_dwordx4 v240, s[8:11], s7 offen nt lds
    s_waitcnt vmcnt(5)
    buffer_load_dwordx4 v241, s[8:11], s7 offen offset:1024 nt lds
    s_waitcnt vmcnt(5)
    buffer_load_dwordx4 v242, s[8:11], s7 offen offset:2048 nt lds
    s_waitcnt vmcnt(5)
    buffer_load_dwordx4 v243, s[8:11], s7 offen offset:3072 nt lds
    s_add_u32 m0, s46, 0
    s_add_u32 s7, s44, 0
    s_waitcnt vmcnt(5)
    buffer_load_dwordx4 v244, s[12:15], s7 offen nt lds
    s_waitcnt vmcnt(5)
    buffer_load_dwordx4 v245, s[12:15], s7 offen offset:1024 nt lds
    s_waitcnt vmcnt(5)
    buffer_load_dwordx4 v244, s[12:15], s7 offen offset:2048 nt lds
    s_waitcnt vmcnt(5)
    buffer_load_dwordx4 v245, s[12:15], s7 offen offset:3072 nt lds
    s_add_u32 m0, s46, 4096
    s_add_u32 s7, s44, 4096
    s_waitcnt vmcnt(5)
    buffer_load_dwordx4 v244, s[12:15], s7 offen nt lds
    s_waitcnt vmcnt(5)
    buffer_load_dwordx4 v245, s[12:15], s7 offen offset:1024 nt lds
    s_add_u32 s45, s45, 16384
    s_cmp_eq_u32 s45, 49152
    s_cselect_b32 s45, 0, s45
    s_add_u32 s43, s43, 16384
    s_add_u32 s46, s46, 16384
    s_cmp_eq_u32 s46, 98304
    s_cselect_b32 s46, 49152, s46
    s_add_u32 s44, s44, 16384
    v_mov_b32 v249, 163824
    ds_read_b32 v250, v249
    s_and_b32 s4, s2, 7
    s_lshl_b32 s67, s4, 13
    s_add_u32 s67, s67, 58720256
    s_waitcnt lgkmcnt(0)
    v_readfirstlane_b32 s62, v250
    s_lshr_b32 s5, s2, 3
    s_mul_i32 s64, s5, 52
    s_lshr_b32 s64, s64, 8
    s_mul_i32 s6, s64, 5
    s_sub_u32 s65, s5, s6
    s_and_b32 s7, s2, 3
    s_mul_i32 s6, s36, 72
    s_mul_i32 s60, s64, 12
    s_add_u32 s6, s6, s60
    s_add_u32 s6, s6, 3
    s_lshl_b32 s6, s6, 2
    s_add_u32 s6, s6, s7
    s_lshl_b32 s60, s6, 15
    s_mul_i32 s61, s7, 1310720
    s_lshl_b32 s6, s65, 8
    s_add_u32 s61, s61, s6
    s_mul_i32 s6, s36, 30
    s_add_u32 s6, s6, s5
    s_lshl_b32 s72, s6, 18
    s_add_u32 s72, s72, 33558528
    s_lshl_b32 s6, s6, 2
    s_add_u32 s6, s6, 1
    s_lshl_b32 s69, s6, 9
    s_add_u32 s69, s69, 58785792
    s_mul_i32 s73, s64, 192
    s_add_u32 s73, s73, 48
    s_cmp_lt_u32 s5, 30
    s_cselect_b32 s68, 1, 0
    v_bfe_u32 v128, v247, 2, 2
    v_lshrrev_b32 v130, 4, v247
    v_lshl_add_u32 v131, v130, 2, v128
    v_lshlrev_b32 v131, 8, v131
    v_and_b32 v130, 1, v130
    v_lshlrev_b32 v130, 1, v130
    v_lshl_add_u32 v130, v128, 2, v130
    v_bfe_u32 v132, v247, 1, 1
    v_xor_b32 v130, v130, v132
    v_lshl_add_u32 v131, v130, 4, v131
    v_and_b32 v129, 1, v247
    v_lshl_add_u32 v131, v129, 3, v131
    v_xor_b32 v232, 0, v131
    v_xor_b32 v233, 32, v131
    v_xor_b32 v234, 64, v131
    v_xor_b32 v235, 96, v131
    v_xor_b32 v236, 128, v131
    v_xor_b32 v237, 160, v131
    v_xor_b32 v238, 192, v131
    v_xor_b32 v239, 224, v131
    v_lshrrev_b32 v128, 4, v247
    v_and_b32 v129, 15, v247
    v_lshlrev_b32 v130, 2, v128
    v_xor_b32 v130, v130, v129
    v_lshlrev_b32 v130, 4, v130
    v_mul_u32_u24 v128, 1280, v128
    v_add_u32 v251, v128, v130
    v_xor_b32 v130, 32, v130
    v_add_u32 v252, v128, v130
    s_waitcnt vmcnt(11)
    s_barrier
    s_add_u32 m0, s45, 8192
    s_add_u32 s7, s43, 8192
    s_waitcnt vmcnt(5)
    buffer_load_dwordx4 v243, s[8:11], s7 offen offset:3072 nt lds
    s_add_u32 m0, s45, 12288
    s_add_u32 s7, s43, 12288
    s_waitcnt vmcnt(5)
    buffer_load_dwordx4 v240, s[8:11], s7 offen nt lds
    s_waitcnt vmcnt(5)
    buffer_load_dwordx4 v241, s[8:11], s7 offen offset:1024 nt lds
    s_waitcnt vmcnt(5)
    buffer_load_dwordx4 v242, s[8:11], s7 offen offset:2048 nt lds
    s_waitcnt vmcnt(5)
    buffer_load_dwordx4 v243, s[8:11], s7 offen offset:3072 nt lds
    s_add_u32 m0, s46, 0
    s_add_u32 s7, s44, 0
    s_waitcnt vmcnt(5)
    buffer_load_dwordx4 v244, s[12:15], s7 offen nt lds
    s_waitcnt vmcnt(5)
    buffer_load_dwordx4 v245, s[12:15], s7 offen offset:1024 nt lds
    s_waitcnt vmcnt(5)
    buffer_load_dwordx4 v244, s[12:15], s7 offen offset:2048 nt lds
    s_waitcnt vmcnt(5)
    buffer_load_dwordx4 v245, s[12:15], s7 offen offset:3072 nt lds
    s_add_u32 m0, s46, 4096
    s_add_u32 s7, s44, 4096
    s_waitcnt vmcnt(5)
    buffer_load_dwordx4 v244, s[12:15], s7 offen nt lds
    s_waitcnt vmcnt(5)
    buffer_load_dwordx4 v245, s[12:15], s7 offen offset:1024 nt lds
    s_add_u32 s45, s45, 16384
    s_cmp_eq_u32 s45, 49152
    s_cselect_b32 s45, 0, s45
    s_add_u32 s43, s43, 16384
    s_add_u32 s46, s46, 16384
    s_cmp_eq_u32 s46, 98304
    s_cselect_b32 s46, 49152, s46
    s_add_u32 s44, s44, 16384
    v_mov_b32 v0, 0
    v_mov_b32 v1, 0
    v_mov_b32 v2, 0
    v_mov_b32 v3, 0
    v_mov_b32 v4, 0
    v_mov_b32 v5, 0
    v_mov_b32 v6, 0
    v_mov_b32 v7, 0
    v_mov_b32 v8, 0
    v_mov_b32 v9, 0
    v_mov_b32 v10, 0
    v_mov_b32 v11, 0
    v_mov_b32 v12, 0
    v_mov_b32 v13, 0
    v_mov_b32 v14, 0
    v_mov_b32 v15, 0
    v_mov_b32 v16, 0
    v_mov_b32 v17, 0
    v_mov_b32 v18, 0
    v_mov_b32 v19, 0
    v_mov_b32 v20, 0
    v_mov_b32 v21, 0
    v_mov_b32 v22, 0
    v_mov_b32 v23, 0
    v_mov_b32 v24, 0
    v_mov_b32 v25, 0
    v_mov_b32 v26, 0
    v_mov_b32 v27, 0
    v_mov_b32 v28, 0
    v_mov_b32 v29, 0
    v_mov_b32 v30, 0
    v_mov_b32 v31, 0
    v_mov_b32 v32, 0
    v_mov_b32 v33, 0
    v_mov_b32 v34, 0
    v_mov_b32 v35, 0
    v_mov_b32 v36, 0
    v_mov_b32 v37, 0
    v_mov_b32 v38, 0
    v_mov_b32 v39, 0
    v_mov_b32 v40, 0
    v_mov_b32 v41, 0
    v_mov_b32 v42, 0
    v_mov_b32 v43, 0
    v_mov_b32 v44, 0
    v_mov_b32 v45, 0
    v_mov_b32 v46, 0
    v_mov_b32 v47, 0
    v_mov_b32 v48, 0
    v_mov_b32 v49, 0
    v_mov_b32 v50, 0
    v_mov_b32 v51, 0
    v_mov_b32 v52, 0
    v_mov_b32 v53, 0
    v_mov_b32 v54, 0
    v_mov_b32 v55, 0
    v_mov_b32 v56, 0
    v_mov_b32 v57, 0
    v_mov_b32 v58, 0
    v_mov_b32 v59, 0
    v_mov_b32 v60, 0
    v_mov_b32 v61, 0
    v_mov_b32 v62, 0
    v_mov_b32 v63, 0
    v_mov_b32 v64, 0
    v_mov_b32 v65, 0
    v_mov_b32 v66, 0
    v_mov_b32 v67, 0
    v_mov_b32 v68, 0
    v_mov_b32 v69, 0
    v_mov_b32 v70, 0
    v_mov_b32 v71, 0
    v_mov_b32 v72, 0
    v_mov_b32 v73, 0
    v_mov_b32 v74, 0
    v_mov_b32 v75, 0
    v_mov_b32 v76, 0
    v_mov_b32 v77, 0
    v_mov_b32 v78, 0
    v_mov_b32 v79, 0
    v_mov_b32 v80, 0
    v_mov_b32 v81, 0
    v_mov_b32 v82, 0
    v_mov_b32 v83, 0
    v_mov_b32 v84, 0
    v_mov_b32 v85, 0
    v_mov_b32 v86, 0
    v_mov_b32 v87, 0
    v_mov_b32 v88, 0
    v_mov_b32 v89, 0
    v_mov_b32 v90, 0
    v_mov_b32 v91, 0
    v_mov_b32 v92, 0
    v_mov_b32 v93, 0
    v_mov_b32 v94, 0
    v_mov_b32 v95, 0
    v_mov_b32 v128, 0
    s_and_b32 s6, s2, 3
    s_mul_i32 s6, s6, 81920
    s_add_u32 s6, s6, s72
    buffer_load_dword v129, v128, s[24:27], s6 offen
    s_waitcnt vmcnt(12)
    s_mul_i32 s66, s64, 3
    s_mul_i32 s6, s65, 2
    s_add_u32 s66, s66, s6
    s_mov_b32 s42, 3
L_kva_h1:
    s_barrier
    s_add_u32 m0, s45, 8192
    s_add_u32 s7, s43, 8192
    s_waitcnt vmcnt(5)
    buffer_load_dwordx4 v243, s[8:11], s7 offen offset:3072 nt lds
    s_add_u32 m0, s45, 12288
    s_add_u32 s7, s43, 12288
    s_waitcnt vmcnt(5)
    buffer_load_dwordx4 v240, s[8:11], s7 offen nt lds
    s_waitcnt vmcnt(5)
    buffer_load_dwordx4 v241, s[8:11], s7 offen offset:1024 nt lds
    s_waitcnt vmcnt(5)
    buffer_load_dwordx4 v242, s[8:11], s7 offen offset:2048 nt lds
    s_waitcnt vmcnt(5)
    buffer_load_dwordx4 v243, s[8:11], s7 offen offset:3072 nt lds
    s_add_u32 m0, s46, 0
    s_add_u32 s7, s44, 0
    s_waitcnt vmcnt(5)
    buffer_load_dwordx4 v244, s[12:15], s7 offen nt lds
    s_waitcnt vmcnt(5)
    buffer_load_dwordx4 v245, s[12:15], s7 offen offset:1024 nt lds
    s_waitcnt vmcnt(5)
    buffer_load_dwordx4 v244, s[12:15], s7 offen offset:2048 nt lds
    s_waitcnt vmcnt(5)
    buffer_load_dwordx4 v245, s[12:15], s7 offen offset:3072 nt lds
    s_add_u32 m0, s46, 4096
    s_add_u32 s7, s44, 4096
    s_waitcnt vmcnt(5)
    buffer_load_dwordx4 v244, s[12:15], s7 offen nt lds
    s_waitcnt vmcnt(5)
    buffer_load_dwordx4 v245, s[12:15], s7 offen offset:1024 nt lds
    s_add_u32 s45, s45, 16384
    s_cmp_eq_u32 s45, 49152
    s_cselect_b32 s45, 0, s45
    s_add_u32 s43, s43, 16384
    s_add_u32 s46, s46, 16384
    s_cmp_eq_u32 s46, 98304
    s_cselect_b32 s46, 49152, s46
    s_add_u32 s44, s44, 16384
    s_add_u32 s42, s42, 1
    s_cmp_le_u32 s42, 18
    s_waitcnt vmcnt(11)
    s_cbranch_scc1 L_kva_h1
    s_mov_b32 s42, 19
L_kvb_h1:
    s_barrier
    s_add_u32 m0, s45, 8192
    s_add_u32 s7, s43, 8192
    s_waitcnt vmcnt(5)
    buffer_load_dwordx4 v243, s[8:11], s7 offen offset:3072 nt lds
    s_add_u32 m0, s45, 12288
    s_add_u32 s7, s43, 12288
    s_waitcnt vmcnt(5)
    buffer_load_dwordx4 v240, s[8:11], s7 offen nt lds
    s_waitcnt vmcnt(5)
    buffer_load_dwordx4 v241, s[8:11], s7 offen offset:1024 nt lds
    s_waitcnt vmcnt(5)
    buffer_load_dwordx4 v242, s[8:11], s7 offen offset:2048 nt lds
    s_waitcnt vmcnt(5)
    buffer_load_dwordx4 v243, s[8:11], s7 offen offset:3072 nt lds
    s_add_u32 m0, s46, 0
    s_add_u32 s7, s44, 0
    s_waitcnt vmcnt(5)
    buffer_load_dwordx4 v244, s[12:15], s7 offen nt lds
    s_waitcnt vmcnt(5)
    buffer_load_dwordx4 v245, s[12:15], s7 offen offset:1024 nt lds
    s_waitcnt vmcnt(5)
    buffer_load_dwordx4 v244, s[12:15], s7 offen offset:2048 nt lds
    s_waitcnt vmcnt(5)
    buffer_load_dwordx4 v245, s[12:15], s7 offen offset:3072 nt lds
    s_add_u32 m0, s46, 4096
    s_add_u32 s7, s44, 4096
    s_waitcnt vmcnt(5)
    buffer_load_dwordx4 v244, s[12:15], s7 offen nt lds
    s_waitcnt vmcnt(5)
    buffer_load_dwordx4 v245, s[12:15], s7 offen offset:1024 nt lds
    s_add_u32 s45, s45, 16384
    s_cmp_eq_u32 s45, 49152
    s_cselect_b32 s45, 0, s45
    s_add_u32 s43, s43, 16384
    s_add_u32 s46, s46, 16384
    s_cmp_eq_u32 s46, 98304
    s_cselect_b32 s46, 49152, s46
    s_add_u32 s44, s44, 16384
    s_add_u32 s42, s42, 1
    s_cmp_le_u32 s42, 28
    s_waitcnt vmcnt(11)
    s_cbranch_scc1 L_kvb_h1
    s_barrier
    s_add_u32 m0, s46, 0
    s_add_u32 s7, s44, 0
    buffer_load_dwordx4 v244, s[12:15], s7 offen nt lds
    buffer_load_dwordx4 v245, s[12:15], s7 offen offset:1024 nt lds
    buffer_load_dwordx4 v244, s[12:15], s7 offen offset:2048 nt lds
    buffer_load_dwordx4 v245, s[12:15], s7 offen offset:3072 nt lds
    s_add_u32 m0, s46, 4096
    s_add_u32 s7, s44, 4096
    buffer_load_dwordx4 v244, s[12:15], s7 offen nt lds
    buffer_load_dwordx4 v245, s[12:15], s7 offen offset:1024 nt lds
    s_cmp_eq_u32 s68, 0
    s_cbranch_scc1 L_notile_h1
    s_mov_b32 s63, 0
    s_mov_b32 s52, 98304
    s_add_u32 s51, s63, s66
    s_bfe_u32 s49, s51, 0x20002
    s_lshl_b32 s49, s49, 3
    s_and_b32 s51, s51, 3
    s_add_u32 s49, s49, s51
    s_lshr_b32 s51, s63, 4
    s_lshl2_add_u32 s49, s51, s49
    s_add_u32 s63, s63, 1
    s_mul_i32 s48, s49, 40960
    s_add_u32 s48, s48, s61
    s_add_u32 m0, s52, 2048
    s_add_u32 s6, s48, 10240
    buffer_load_dwordx4 v251, s[28:31], s6 offen lds
    s_add_u32 m0, s52, 3072
    s_add_u32 s6, s48, 15360
    buffer_load_dwordx4 v252, s[28:31], s6 offen lds
    s_add_u32 m0, s52, 4096
    s_add_u32 s6, s48, 20480
    buffer_load_dwordx4 v251, s[28:31], s6 offen lds
    s_mov_b32 s63, 1
    s_mov_b32 s52, 106496
    s_add_u32 s51, s63, s66
    s_bfe_u32 s49, s51, 0x20002
    s_lshl_b32 s49, s49, 3
    s_and_b32 s51, s51, 3
    s_add_u32 s49, s49, s51
    s_lshr_b32 s51, s63, 4
    s_lshl2_add_u32 s49, s51, s49
    s_add_u32 s63, s63, 1
    s_mul_i32 s48, s49, 40960
    s_add_u32 s48, s48, s61
    s_add_u32 m0, s52, 2048
    s_add_u32 s6, s48, 10240
    buffer_load_dwordx4 v251, s[28:31], s6 offen lds
    s_add_u32 m0, s52, 3072
    s_add_u32 s6, s48, 15360
    buffer_load_dwordx4 v252, s[28:31], s6 offen lds
    s_add_u32 m0, s52, 4096
    s_add_u32 s6, s48, 20480
    buffer_load_dwordx4 v251, s[28:31], s6 offen lds
    s_mov_b32 s63, 2
    s_mov_b32 s52, 114688
    s_add_u32 s51, s63, s66
    s_bfe_u32 s49, s51, 0x20002
    s_lshl_b32 s49, s49, 3
    s_and_b32 s51, s51, 3
    s_add_u32 s49, s49, s51
    s_lshr_b32 s51, s63, 4
    s_lshl2_add_u32 s49, s51, s49
    s_add_u32 s63, s63, 1
    s_mul_i32 s48, s49, 40960
    s_add_u32 s48, s48, s61
    s_add_u32 m0, s52, 2048
    s_add_u32 s6, s48, 10240
    buffer_load_dwordx4 v251, s[28:31], s6 offen lds
    s_add_u32 m0, s52, 3072
    s_add_u32 s6, s48, 15360
    buffer_load_dwordx4 v252, s[28:31], s6 offen lds
    s_add_u32 m0, s52, 4096
    s_add_u32 s6, s48, 20480
    buffer_load_dwordx4 v251, s[28:31], s6 offen lds
    s_mov_b32 s63, 3
    s_mov_b32 s52, 122880
    s_add_u32 s51, s63, s66
    s_bfe_u32 s49, s51, 0x20002
    s_lshl_b32 s49, s49, 3
    s_and_b32 s51, s51, 3
    s_add_u32 s49, s49, s51
    s_lshr_b32 s51, s63, 4
    s_lshl2_add_u32 s49, s51, s49
    s_add_u32 s63, s63, 1
    s_mul_i32 s48, s49, 40960
    s_add_u32 s48, s48, s61
    s_add_u32 m0, s52, 2048
    s_add_u32 s6, s48, 10240
    buffer_load_dwordx4 v251, s[28:31], s6 offen lds
    s_add_u32 m0, s52, 3072
    s_add_u32 s6, s48, 15360
    buffer_load_dwordx4 v252, s[28:31], s6 offen lds
    s_add_u32 m0, s52, 4096
    s_add_u32 s6, s48, 20480
    buffer_load_dwordx4 v251, s[28:31], s6 offen lds
    s_mov_b32 s63, 4
    s_mov_b32 s52, 131072
    s_add_u32 s51, s63, s66
    s_bfe_u32 s49, s51, 0x20002
    s_lshl_b32 s49, s49, 3
    s_and_b32 s51, s51, 3
    s_add_u32 s49, s49, s51
    s_lshr_b32 s51, s63, 4
    s_lshl2_add_u32 s49, s51, s49
    s_add_u32 s63, s63, 1
    s_mul_i32 s48, s49, 40960
    s_add_u32 s48, s48, s61
    s_add_u32 m0, s52, 2048
    s_add_u32 s6, s48, 10240
    buffer_load_dwordx4 v251, s[28:31], s6 offen lds
    s_add_u32 m0, s52, 3072
    s_add_u32 s6, s48, 15360
    buffer_load_dwordx4 v252, s[28:31], s6 offen lds
    s_add_u32 m0, s52, 4096
    s_add_u32 s6, s48, 20480
    buffer_load_dwordx4 v251, s[28:31], s6 offen lds
    s_mov_b32 s63, 5
    s_mov_b32 s52, 139264
    s_add_u32 s51, s63, s66
    s_bfe_u32 s49, s51, 0x20002
    s_lshl_b32 s49, s49, 3
    s_and_b32 s51, s51, 3
    s_add_u32 s49, s49, s51
    s_lshr_b32 s51, s63, 4
    s_lshl2_add_u32 s49, s51, s49
    s_add_u32 s63, s63, 1
    s_mul_i32 s48, s49, 40960
    s_add_u32 s48, s48, s61
    s_add_u32 m0, s52, 2048
    s_add_u32 s6, s48, 10240
    buffer_load_dwordx4 v251, s[28:31], s6 offen lds
    s_add_u32 m0, s52, 3072
    s_add_u32 s6, s48, 15360
    buffer_load_dwordx4 v252, s[28:31], s6 offen lds
    s_add_u32 m0, s52, 4096
    s_add_u32 s6, s48, 20480
    buffer_load_dwordx4 v251, s[28:31], s6 offen lds
    s_mov_b32 s63, 6
    s_mov_b32 s52, 32768
    s_add_u32 s51, s63, s66
    s_bfe_u32 s49, s51, 0x20002
    s_lshl_b32 s49, s49, 3
    s_and_b32 s51, s51, 3
    s_add_u32 s49, s49, s51
    s_lshr_b32 s51, s63, 4
    s_lshl2_add_u32 s49, s51, s49
    s_add_u32 s63, s63, 1
    s_mul_i32 s48, s49, 40960
    s_add_u32 s48, s48, s61
    s_add_u32 m0, s52, 2048
    s_add_u32 s6, s48, 10240
    buffer_load_dwordx4 v251, s[28:31], s6 offen lds
    s_add_u32 m0, s52, 3072
    s_add_u32 s6, s48, 15360
    buffer_load_dwordx4 v252, s[28:31], s6 offen lds
    s_add_u32 m0, s52, 4096
    s_add_u32 s6, s48, 20480
    buffer_load_dwordx4 v251, s[28:31], s6 offen lds
    s_mov_b32 s63, 7
    s_mov_b32 s52, 40960
    s_add_u32 s51, s63, s66
    s_bfe_u32 s49, s51, 0x20002
    s_lshl_b32 s49, s49, 3
    s_and_b32 s51, s51, 3
    s_add_u32 s49, s49, s51
    s_lshr_b32 s51, s63, 4
    s_lshl2_add_u32 s49, s51, s49
    s_add_u32 s63, s63, 1
    s_mul_i32 s48, s49, 40960
    s_add_u32 s48, s48, s61
    s_add_u32 m0, s52, 2048
    s_add_u32 s6, s48, 10240
    buffer_load_dwordx4 v251, s[28:31], s6 offen lds
    s_add_u32 m0, s52, 3072
    s_add_u32 s6, s48, 15360
    buffer_load_dwordx4 v252, s[28:31], s6 offen lds
    s_add_u32 m0, s52, 4096
    s_add_u32 s6, s48, 20480
    buffer_load_dwordx4 v251, s[28:31], s6 offen lds
    s_mul_i32 s6, s73, 7282
    s_lshr_b32 s6, s6, 20
    s_and_b32 s6, s6, 7
    s_lshl_b32 s6, s6, 7
    v_lshlrev_b32 v249, 3, v246
    v_and_b32 v249, 3072, v249
    v_add_u32 v249, s6, v249
    buffer_load_dword v250, v249, s[24:27], s67 offen sc1
    s_waitcnt vmcnt(31)
    s_barrier
    s_mov_b32 s63, 8
    s_mov_b32 s52, 0
    s_add_u32 s51, s63, s66
    s_bfe_u32 s49, s51, 0x20002
    s_lshl_b32 s49, s49, 3
    s_and_b32 s51, s51, 3
    s_add_u32 s49, s49, s51
    s_lshr_b32 s51, s63, 4
    s_lshl2_add_u32 s49, s51, s49
    s_add_u32 s63, s63, 1
    s_mul_i32 s48, s49, 40960
    s_add_u32 s48, s48, s61
    s_add_u32 m0, s52, 2048
    s_add_u32 s6, s48, 10240
    buffer_load_dwordx4 v251, s[28:31], s6 offen lds
    s_add_u32 m0, s52, 3072
    s_add_u32 s6, s48, 15360
    buffer_load_dwordx4 v252, s[28:31], s6 offen lds
    s_add_u32 m0, s52, 4096
    s_add_u32 s6, s48, 20480
    buffer_load_dwordx4 v251, s[28:31], s6 offen lds
    s_mov_b32 s63, 9
    s_mov_b32 s52, 8192
    s_add_u32 s51, s63, s66
    s_bfe_u32 s49, s51, 0x20002
    s_lshl_b32 s49, s49, 3
    s_and_b32 s51, s51, 3
    s_add_u32 s49, s49, s51
    s_lshr_b32 s51, s63, 4
    s_lshl2_add_u32 s49, s51, s49
    s_add_u32 s63, s63, 1
    s_mul_i32 s48, s49, 40960
    s_add_u32 s48, s48, s61
    s_add_u32 m0, s52, 2048
    s_add_u32 s6, s48, 10240
    buffer_load_dwordx4 v251, s[28:31], s6 offen lds
    s_add_u32 m0, s52, 3072
    s_add_u32 s6, s48, 15360
    buffer_load_dwordx4 v252, s[28:31], s6 offen lds
    s_add_u32 m0, s52, 4096
    s_add_u32 s6, s48, 20480
    buffer_load_dwordx4 v251, s[28:31], s6 offen lds
    s_mov_b32 s63, 10
    s_mov_b32 s52, 81920
    s_add_u32 s51, s63, s66
    s_bfe_u32 s49, s51, 0x20002
    s_lshl_b32 s49, s49, 3
    s_and_b32 s51, s51, 3
    s_add_u32 s49, s49, s51
    s_lshr_b32 s51, s63, 4
    s_lshl2_add_u32 s49, s51, s49
    s_add_u32 s63, s63, 1
    s_mul_i32 s48, s49, 40960
    s_add_u32 s48, s48, s61
    s_add_u32 m0, s52, 2048
    s_add_u32 s6, s48, 10240
    buffer_load_dwordx4 v251, s[28:31], s6 offen lds
    s_add_u32 m0, s52, 3072
    s_add_u32 s6, s48, 15360
    buffer_load_dwordx4 v252, s[28:31], s6 offen lds
    s_add_u32 m0, s52, 4096
    s_add_u32 s6, s48, 20480
    buffer_load_dwordx4 v251, s[28:31], s6 offen lds
    s_mov_b32 s63, 11
    s_mov_b32 s52, 90112
    s_add_u32 s51, s63, s66
    s_bfe_u32 s49, s51, 0x20002
    s_lshl_b32 s49, s49, 3
    s_and_b32 s51, s51, 3
    s_add_u32 s49, s49, s51
    s_lshr_b32 s51, s63, 4
    s_lshl2_add_u32 s49, s51, s49
    s_add_u32 s63, s63, 1
    s_mul_i32 s48, s49, 40960
    s_add_u32 s48, s48, s61
    s_add_u32 m0, s52, 2048
    s_add_u32 s6, s48, 10240
    buffer_load_dwordx4 v251, s[28:31], s6 offen lds
    s_add_u32 m0, s52, 3072
    s_add_u32 s6, s48, 15360
    buffer_load_dwordx4 v252, s[28:31], s6 offen lds
    s_add_u32 m0, s52, 4096
    s_add_u32 s6, s48, 20480
    buffer_load_dwordx4 v251, s[28:31], s6 offen lds
    s_waitcnt vmcnt(12)
    v_cmp_ne_u32 vcc, s62, v250
    s_nop 0
    s_cmp_eq_u64 vcc, 0
    s_cbranch_scc1 L_spx_o1h1
    s_mov_b32 s53, 0
L_sp_o1h1:
    s_add_u32 s53, s53, 1
    s_cmp_gt_u32 s53, 400000
    s_cbranch_scc1 L_spx_o1h1
    buffer_load_dword v250, v249, s[24:27], s67 offen sc1
    s_waitcnt vmcnt(0)
    v_cmp_ne_u32 vcc, s62, v250
    s_nop 0
    s_cmp_eq_u64 vcc, 0
    s_cbranch_scc0 L_sp_o1h1
L_spx_o1h1:
    s_mov_b32 s63, 0
    s_add_u32 s51, s63, s66
    s_bfe_u32 s49, s51, 0x20002
    s_lshl_b32 s49, s49, 3
    s_and_b32 s51, s51, 3
    s_add_u32 s49, s49, s51
    s_lshr_b32 s51, s63, 4
    s_lshl2_add_u32 s49, s51, s49
    s_add_u32 s63, s63, 1
    s_lshl_b32 s49, s49, 10
    s_add_u32 s49, s49, s60
    s_add_u32 s6, s49, 0
    buffer_load_dwordx4 v[128:131], v246, s[24:27], s6 offen sc1
    s_add_u32 s6, s49, 131072
    buffer_load_dwordx4 v[132:135], v246, s[24:27], s6 offen sc1
    s_add_u32 s6, s49, 262144
    buffer_load_dwordx4 v[136:139], v246, s[24:27], s6 offen sc1
    s_add_u32 s51, s63, s66
    s_bfe_u32 s49, s51, 0x20002
    s_lshl_b32 s49, s49, 3
    s_and_b32 s51, s51, 3
    s_add_u32 s49, s49, s51
    s_lshr_b32 s51, s63, 4
    s_lshl2_add_u32 s49, s51, s49
    s_add_u32 s63, s63, 1
    s_lshl_b32 s49, s49, 10
    s_add_u32 s49, s49, s60
    s_add_u32 s6, s49, 0
    buffer_load_dwordx4 v[144:147], v246, s[24:27], s6 offen sc1
    s_add_u32 s6, s49, 131072
    buffer_load_dwordx4 v[148:151], v246, s[24:27], s6 offen sc1
    s_add_u32 s6, s49, 262144
    buffer_load_dwordx4 v[152:155], v246, s[24:27], s6 offen sc1
    s_add_u32 s51, s63, s66
    s_bfe_u32 s49, s51, 0x20002
    s_lshl_b32 s49, s49, 3
    s_and_b32 s51, s51, 3
    s_add_u32 s49, s49, s51
    s_lshr_b32 s51, s63, 4
    s_lshl2_add_u32 s49, s51, s49
    s_add_u32 s63, s63, 1
    s_lshl_b32 s49, s49, 10
    s_add_u32 s49, s49, s60
    s_add_u32 s6, s49, 0
    buffer_load_dwordx4 v[160:163], v246, s[24:27], s6 offen sc1
    s_add_u32 s6, s49, 131072
    buffer_load_dwordx4 v[164:167], v246, s[24:27], s6 offen sc1
    s_add_u32 s6, s49, 262144
    buffer_load_dwordx4 v[168:171], v246, s[24:27], s6 offen sc1
    s_barrier
    s_mov_b32 s63, 12
    s_mov_b32 s52, 16384
    s_add_u32 s51, s63, s66
    s_bfe_u32 s49, s51, 0x20002
    s_lshl_b32 s49, s49, 3
    s_and_b32 s51, s51, 3
    s_add_u32 s49, s49, s51
    s_lshr_b32 s51, s63, 4
    s_lshl2_add_u32 s49, s51, s49
    s_add_u32 s63, s63, 1
    s_mul_i32 s48, s49, 40960
    s_add_u32 s48, s48, s61
    s_add_u32 m0, s52, 2048
    s_add_u32 s6, s48, 10240
    buffer_load_dwordx4 v251, s[28:31], s6 offen lds
    s_add_u32 m0, s52, 3072
    s_add_u32 s6, s48, 15360
    buffer_load_dwordx4 v252, s[28:31], s6 offen lds
    s_add_u32 m0, s52, 4096
    s_add_u32 s6, s48, 20480
    buffer_load_dwordx4 v251, s[28:31], s6 offen lds
    s_mov_b32 s63, 13
    s_mov_b32 s52, 24576
    s_add_u32 s51, s63, s66
    s_bfe_u32 s49, s51, 0x20002
    s_lshl_b32 s49, s49, 3
    s_and_b32 s51, s51, 3
    s_add_u32 s49, s49, s51
    s_lshr_b32 s51, s63, 4
    s_lshl2_add_u32 s49, s51, s49
    s_add_u32 s63, s63, 1
    s_mul_i32 s48, s49, 40960
    s_add_u32 s48, s48, s61
    s_add_u32 m0, s52, 2048
    s_add_u32 s6, s48, 10240
    buffer_load_dwordx4 v251, s[28:31], s6 offen lds
    s_add_u32 m0, s52, 3072
    s_add_u32 s6, s48, 15360
    buffer_load_dwordx4 v252, s[28:31], s6 offen lds
    s_add_u32 m0, s52, 4096
    s_add_u32 s6, s48, 20480
    buffer_load_dwordx4 v251, s[28:31], s6 offen lds
    s_mov_b32 s63, 14
    s_mov_b32 s52, 49152
    s_add_u32 s51, s63, s66
    s_bfe_u32 s49, s51, 0x20002
    s_lshl_b32 s49, s49, 3
    s_and_b32 s51, s51, 3
    s_add_u32 s49, s49, s51
    s_lshr_b32 s51, s63, 4
    s_lshl2_add_u32 s49, s51, s49
    s_add_u32 s63, s63, 1
    s_mul_i32 s48, s49, 40960
    s_add_u32 s48, s48, s61
    s_add_u32 m0, s52, 2048
    s_add_u32 s6, s48, 10240
    buffer_load_dwordx4 v251, s[28:31], s6 offen lds
    s_add_u32 m0, s52, 3072
    s_add_u32 s6, s48, 15360
    buffer_load_dwordx4 v252, s[28:31], s6 offen lds
    s_add_u32 m0, s52, 4096
    s_add_u32 s6, s48, 20480
    buffer_load_dwordx4 v251, s[28:31], s6 offen lds
    s_mov_b32 s63, 15
    s_mov_b32 s52, 57344
    s_add_u32 s51, s63, s66
    s_bfe_u32 s49, s51, 0x20002
    s_lshl_b32 s49, s49, 3
    s_and_b32 s51, s51, 3
    s_add_u32 s49, s49, s51
    s_lshr_b32 s51, s63, 4
    s_lshl2_add_u32 s49, s51, s49
    s_add_u32 s63, s63, 1
    s_mul_i32 s48, s49, 40960
    s_add_u32 s48, s48, s61
    s_add_u32 m0, s52, 2048
    s_add_u32 s6, s48, 10240
    buffer_load_dwordx4 v251, s[28:31], s6 offen lds
    s_add_u32 m0, s52, 3072
    s_add_u32 s6, s48, 15360
    buffer_load_dwordx4 v252, s[28:31], s6 offen lds
    s_add_u32 m0, s52, 4096
    s_add_u32 s6, s48, 20480
    buffer_load_dwordx4 v251, s[28:31], s6 offen lds
    s_mov_b32 s63, 3
    s_mov_b32 s50, 0
    s_mov_b32 s58, 0x43150287
    s_mov_b32 s59, 0x31502876
    s_add_u32 s54, s67, 4096
    v_add_u32 v224, 98304, v232
    v_add_u32 v225, 98304, v233
    v_add_u32 v226, 98304, v234
    v_add_u32 v227, 98304, v235
    v_add_u32 v228, 98304, v236
    v_add_u32 v229, 98304, v237
    v_add_u32 v230, 98304, v238
    v_add_u32 v231, 98304, v239
    ds_read_b64_tr_b16 v[192:193], v224
    ds_read_b64_tr_b16 v[194:195], v224 offset:4096
    ds_read_b64_tr_b16 v[196:197], v225
    ds_read_b64_tr_b16 v[198:199], v225 offset:4096
    ds_read_b64_tr_b16 v[200:201], v226
    ds_read_b64_tr_b16 v[202:203], v226 offset:4096
    ds_read_b64_tr_b16 v[204:205], v227
    ds_read_b64_tr_b16 v[206:207], v227 offset:4096
    ds_read_b64_tr_b16 v[208:209], v228
    ds_read_b64_tr_b16 v[210:211], v228 offset:4096
    ds_read_b64_tr_b16 v[212:213], v229
    ds_read_b64_tr_b16 v[214:215], v229 offset:4096
    ds_read_b64_tr_b16 v[216:217], v230
    ds_read_b64_tr_b16 v[218:219], v230 offset:4096
    ds_read_b64_tr_b16 v[220:221], v231
    ds_read_b64_tr_b16 v[222:223], v231 offset:4096
    s_waitcnt vmcnt(9)
    s_barrier
    s_branch L_t
L_notile_h1:
    s_waitcnt vmcnt(6)
    s_barrier
    s_waitcnt vmcnt(0)
    s_barrier
    s_branch L_end
L_h2:
    v_lshrrev_b32 v1, 4, v247
    v_and_b32 v2, 15, v247
    v_lshlrev_b32 v3, 2, v1
    v_xor_b32 v3, v3, v2
    v_lshlrev_b32 v3, 4, v3
    v_lshl_add_u32 v232, v1, 13, v3
    v_xor_b32 v233, 32, v232
    v_lshrrev_b32 v5, 3, v247
    v_mul_u32_u24 v5, 1280, v5
    v_and_b32 v6, 7, v247
    v_xor_b32 v4, 0, v1
    v_xor_b32 v4, v4, v6
    v_lshl_add_u32 v234, v4, 4, v5
    v_xor_b32 v4, 4, v1
    v_xor_b32 v4, v4, v6
    v_lshl_add_u32 v235, v4, 4, v5
    s_lshl_b32 s48, s38, 8
    s_mul_i32 s49, s37, 184320
    s_mov_b32 s52, 49152
    s_mov_b32 s53, 32768
    s_mov_b32 s54, 65536
    s_mov_b32 s55, 81920
    s_mov_b32 s56, 98304
    s_mov_b32 s60, s101
    s_mov_b32 s101, 0
    s_mov_b32 s57, s101
    s_mov_b32 s50, s48
    s_add_u32 s101, s60, 1
    s_add_u32 s57, s60, 1
    s_mov_b32 s52, 32768
    s_mov_b32 s53, 65536
    s_mov_b32 s54, 81920
    s_mov_b32 s55, 49152
    s_mov_b32 s56, 116736
    s_add_u32 m0, s52, 11264
    s_add_u32 s6, s50, 360704
    buffer_load_dwordx4 v233, s[20:23], s6 offen lds
    s_add_u32 m0, s52, 12288
    s_add_u32 s6, s50, 393472
    buffer_load_dwordx4 v232, s[20:23], s6 offen lds
    s_add_u32 m0, s52, 13312
    s_add_u32 s6, s50, 426240
    buffer_load_dwordx4 v232, s[20:23], s6 offen lds
    s_add_u32 m0, s52, 14336
    s_add_u32 s6, s50, 459008
    buffer_load_dwordx4 v233, s[20:23], s6 offen lds
    s_add_u32 m0, s52, 15360
    s_add_u32 s6, s50, 491776
    buffer_load_dwordx4 v233, s[20:23], s6 offen lds
    s_mov_b32 s4, s52
    s_mov_b32 s52, s53
    s_mov_b32 s53, s54
    s_mov_b32 s54, s55
    s_mov_b32 s55, s4
    s_lshl_b32 s50, s101, 19
    s_add_u32 s50, s50, s48
    s_add_u32 s101, s101, 1
    s_cmp_eq_u32 s101, 10
    s_cselect_b32 s101, 1, s101
    s_add_u32 m0, s52, 11264
    s_add_u32 s6, s50, 98560
    buffer_load_dwordx4 v233, s[20:23], s6 offen lds
    s_add_u32 m0, s52, 12288
    s_add_u32 s6, s50, 131328
    buffer_load_dwordx4 v232, s[20:23], s6 offen lds
    s_add_u32 m0, s52, 13312
    s_add_u32 s6, s50, 164096
    buffer_load_dwordx4 v232, s[20:23], s6 offen lds
    s_add_u32 m0, s52, 14336
    s_add_u32 s6, s50, 196864
    buffer_load_dwordx4 v233, s[20:23], s6 offen lds
    s_add_u32 m0, s52, 15360
    s_add_u32 s6, s50, 229632
    buffer_load_dwordx4 v233, s[20:23], s6 offen lds
    s_mov_b32 s4, s52
    s_mov_b32 s52, s53
    s_mov_b32 s53, s54
    s_mov_b32 s54, s55
    s_mov_b32 s55, s4
    s_lshl_b32 s51, s57, 7
    s_add_u32 s51, s51, s49
    s_add_u32 s57, s57, 1
    s_cmp_eq_u32 s57, 10
    s_cselect_b32 s57, 1, s57
    s_add_u32 m0, s56, 12288
    s_add_u32 s6, s51, 122880
    buffer_load_dwordx4 v234, s[16:19], s6 offen lds
    s_add_u32 m0, s56, 13312
    s_add_u32 s6, s51, 133120
    buffer_load_dwordx4 v235, s[16:19], s6 offen lds
    s_add_u32 m0, s56, 14336
    s_add_u32 s6, s51, 143360
    buffer_load_dwordx4 v234, s[16:19], s6 offen lds
    s_add_u32 m0, s56, 15360
    s_add_u32 s6, s51, 153600
    buffer_load_dwordx4 v235, s[16:19], s6 offen lds
    s_add_u32 m0, s56, 16384
    s_add_u32 s6, s51, 163840
    buffer_load_dwordx4 v234, s[16:19], s6 offen lds
    s_add_u32 m0, s56, 17408
    s_add_u32 s6, s51, 174080
    buffer_load_dwordx4 v235, s[16:19], s6 offen lds
    s_add_u32 s56, s56, 18432
    s_cmp_eq_u32 s56, 153600
    s_cselect_b32 s56, 98304, s56
    v_add_u32 v4, 0, v1
    v_xor_b32 v4, v4, v2
    v_lshlrev_b32 v4, 4, v4
    v_lshl_add_u32 v240, v1, 8, v4
    v_add_u32 v4, 4, v1
    v_xor_b32 v4, v4, v2
    v_lshlrev_b32 v4, 4, v4
    v_lshl_add_u32 v241, v1, 8, v4
    v_add_u32 v4, 8, v1
    v_xor_b32 v4, v4, v2
    v_lshlrev_b32 v4, 4, v4
    v_lshl_add_u32 v242, v1, 8, v4
    v_add_u32 v4, 12, v1
    v_xor_b32 v4, v4, v2
    v_lshlrev_b32 v4, 4, v4
    v_lshl_add_u32 v243, v1, 8, v4
    v_lshl_add_u32 v244, v1, 8, v3
    v_xor_b32 v245, 32, v244
    s_waitcnt vmcnt(16)
    s_barrier
    s_add_u32 m0, s52, 11264
    s_add_u32 s6, s50, 360704
    buffer_load_dwordx4 v233, s[20:23], s6 offen lds
    s_add_u32 m0, s52, 12288
    s_add_u32 s6, s50, 393472
    buffer_load_dwordx4 v232, s[20:23], s6 offen lds
    s_add_u32 m0, s52, 13312
    s_add_u32 s6, s50, 426240
    buffer_load_dwordx4 v232, s[20:23], s6 offen lds
    s_add_u32 m0, s52, 14336
    s_add_u32 s6, s50, 459008
    buffer_load_dwordx4 v233, s[20:23], s6 offen lds
    s_add_u32 m0, s52, 15360
    s_add_u32 s6, s50, 491776
    buffer_load_dwordx4 v233, s[20:23], s6 offen lds
    s_mov_b32 s4, s52
    s_mov_b32 s52, s53
    s_mov_b32 s53, s54
    s_mov_b32 s54, s55
    s_mov_b32 s55, s4
    s_waitcnt vmcnt(16)
    s_barrier
    s_lshl_b32 s50, s101, 19
    s_add_u32 s50, s50, s48
    s_add_u32 s101, s101, 1
    s_cmp_eq_u32 s101, 10
    s_cselect_b32 s101, 1, s101
    s_add_u32 m0, s52, 11264
    s_add_u32 s6, s50, 98560
    buffer_load_dwordx4 v233, s[20:23], s6 offen lds
    s_add_u32 m0, s52, 12288
    s_add_u32 s6, s50, 131328
    buffer_load_dwordx4 v232, s[20:23], s6 offen lds
    s_add_u32 m0, s52, 13312
    s_add_u32 s6, s50, 164096
    buffer_load_dwordx4 v232, s[20:23], s6 offen lds
    s_add_u32 m0, s52, 14336
    s_add_u32 s6, s50, 196864
    buffer_load_dwordx4 v233, s[20:23], s6 offen lds
    s_add_u32 m0, s52, 15360
    s_add_u32 s6, s50, 229632
    buffer_load_dwordx4 v233, s[20:23], s6 offen lds
    s_mov_b32 s4, s52
    s_mov_b32 s52, s53
    s_mov_b32 s53, s54
    s_mov_b32 s54, s55
    s_mov_b32 s55, s4
    s_lshl_b32 s51, s57, 7
    s_add_u32 s51, s51, s49
    s_add_u32 s57, s57, 1
    s_cmp_eq_u32 s57, 10
    s_cselect_b32 s57, 1, s57
    s_add_u32 m0, s56, 12288
    s_add_u32 s6, s51, 122880
    buffer_load_dwordx4 v234, s[16:19], s6 offen lds
    s_add_u32 m0, s56, 13312
    s_add_u32 s6, s51, 133120
    buffer_load_dwordx4 v235, s[16:19], s6 offen lds
    s_add_u32 m0, s56, 14336
    s_add_u32 s6, s51, 143360
    buffer_load_dwordx4 v234, s[16:19], s6 offen lds
    s_add_u32 m0, s56, 15360
    s_add_u32 s6, s51, 153600
    buffer_load_dwordx4 v235, s[16:19], s6 offen lds
    s_add_u32 m0, s56, 16384
    s_add_u32 s6, s51, 163840
    buffer_load_dwordx4 v234, s[16:19], s6 offen lds
    s_add_u32 m0, s56, 17408
    s_add_u32 s6, s51, 174080
    buffer_load_dwordx4 v235, s[16:19], s6 offen lds
    s_add_u32 s56, s56, 18432
    s_cmp_eq_u32 s56, 153600
    s_cselect_b32 s56, 98304, s56
    s_waitcnt vmcnt(16)
    s_barrier
    s_add_u32 m0, s52, 11264
    s_add_u32 s6, s50, 360704
    buffer_load_dwordx4 v233, s[20:23], s6 offen lds
    s_add_u32 m0, s52, 12288
    s_add_u32 s6, s50, 393472
    buffer_load_dwordx4 v232, s[20:23], s6 offen lds
    s_add_u32 m0, s52, 13312
    s_add_u32 s6, s50, 426240
    buffer_load_dwordx4 v232, s[20:23], s6 offen lds
    s_add_u32 m0, s52, 14336
    s_add_u32 s6, s50, 459008
    buffer_load_dwordx4 v233, s[20:23], s6 offen lds
    s_add_u32 m0, s52, 15360
    s_add_u32 s6, s50, 491776
    buffer_load_dwordx4 v233, s[20:23], s6 offen lds
    s_mov_b32 s4, s52
    s_mov_b32 s52, s53
    s_mov_b32 s53, s54
    s_mov_b32 s54, s55
    s_mov_b32 s55, s4
    s_mov_b32 m0, 8192
    s_add_u32 s6, s39, 8192
    buffer_load_dwordx4 v240, s[8:11], s6 offen nt lds
    buffer_load_dwordx4 v241, s[8:11], s6 offen offset:1024 nt lds
    buffer_load_dwordx4 v242, s[8:11], s6 offen offset:2048 nt lds
    buffer_load_dwordx4 v243, s[8:11], s6 offen offset:3072 nt lds
    s_waitcnt vmcnt(20)
    s_barrier
    s_lshl_b32 s50, s101, 19
    s_add_u32 s50, s50, s48
    s_add_u32 s101, s101, 1
    s_cmp_eq_u32 s101, 10
    s_cselect_b32 s101, 1, s101
    s_add_u32 m0, s52, 11264
    s_add_u32 s6, s50, 98560
    buffer_load_dwordx4 v233, s[20:23], s6 offen lds
    s_add_u32 m0, s52, 12288
    s_add_u32 s6, s50, 131328
    buffer_load_dwordx4 v232, s[20:23], s6 offen lds
    s_add_u32 m0, s52, 13312
    s_add_u32 s6, s50, 164096
    buffer_load_dwordx4 v232, s[20:23], s6 offen lds
    s_add_u32 m0, s52, 14336
    s_add_u32 s6, s50, 196864
    buffer_load_dwordx4 v233, s[20:23], s6 offen lds
    s_add_u32 m0, s52, 15360
    s_add_u32 s6, s50, 229632
    buffer_load_dwordx4 v233, s[20:23], s6 offen lds
    s_mov_b32 s4, s52
    s_mov_b32 s52, s53
    s_mov_b32 s53, s54
    s_mov_b32 s54, s55
    s_mov_b32 s55, s4
    s_lshl_b32 s51, s57, 7
    s_add_u32 s51, s51, s49
    s_add_u32 s57, s57, 1
    s_cmp_eq_u32 s57, 10
    s_cselect_b32 s57, 1, s57
    s_add_u32 m0, s56, 12288
    s_add_u32 s6, s51, 122880
    buffer_load_dwordx4 v234, s[16:19], s6 offen lds
    s_add_u32 m0, s56, 13312
    s_add_u32 s6, s51, 133120
    buffer_load_dwordx4 v235, s[16:19], s6 offen lds
    s_add_u32 m0, s56, 14336
    s_add_u32 s6, s51, 143360
    buffer_load_dwordx4 v234, s[16:19], s6 offen lds
    s_add_u32 m0, s56, 15360
    s_add_u32 s6, s51, 153600
    buffer_load_dwordx4 v235, s[16:19], s6 offen lds
    s_add_u32 m0, s56, 16384
    s_add_u32 s6, s51, 163840
    buffer_load_dwordx4 v234, s[16:19], s6 offen lds
    s_add_u32 m0, s56, 17408
    s_add_u32 s6, s51, 174080
    buffer_load_dwordx4 v235, s[16:19], s6 offen lds
    s_add_u32 s56, s56, 18432
    s_cmp_eq_u32 s56, 153600
    s_cselect_b32 s56, 98304, s56
    s_waitcnt vmcnt(20)
    s_barrier
    s_add_u32 m0, s52, 11264
    s_add_u32 s6, s50, 360704
    buffer_load_dwordx4 v233, s[20:23], s6 offen lds
    s_add_u32 m0, s52, 12288
    s_add_u32 s6, s50, 393472
    buffer_load_dwordx4 v232, s[20:23], s6 offen lds
    s_add_u32 m0, s52, 13312
    s_add_u32 s6, s50, 426240
    buffer_load_dwordx4 v232, s[20:23], s6 offen lds
    s_add_u32 m0, s52, 14336
    s_add_u32 s6, s50, 459008
    buffer_load_dwordx4 v233, s[20:23], s6 offen lds
    s_add_u32 m0, s52, 15360
    s_add_u32 s6, s50, 491776
    buffer_load_dwordx4 v233, s[20:23], s6 offen lds
    s_mov_b32 s4, s52
    s_mov_b32 s52, s53
    s_mov_b32 s53, s54
    s_mov_b32 s54, s55
    s_mov_b32 s55, s4
    s_mov_b32 m0, 24576
    s_add_u32 s6, s39, 24576
    buffer_load_dwordx4 v240, s[8:11], s6 offen nt lds
    buffer_load_dwordx4 v241, s[8:11], s6 offen offset:1024 nt lds
    buffer_load_dwordx4 v242, s[8:11], s6 offen offset:2048 nt lds
    buffer_load_dwordx4 v243, s[8:11], s6 offen offset:3072 nt lds
    s_mov_b32 s42, 2
L_p_h2:
    s_waitcnt vmcnt(16)
    s_barrier
    s_lshl_b32 s50, s101, 19
    s_add_u32 s50, s50, s48
    s_add_u32 s101, s101, 1
    s_cmp_eq_u32 s101, 10
    s_cselect_b32 s101, 1, s101
    s_add_u32 m0, s52, 11264
    s_add_u32 s6, s50, 98560
    buffer_load_dwordx4 v233, s[20:23], s6 offen lds
    s_add_u32 m0, s52, 12288
    s_add_u32 s6, s50, 131328
    buffer_load_dwordx4 v232, s[20:23], s6 offen lds
    s_add_u32 m0, s52, 13312
    s_add_u32 s6, s50, 164096
    buffer_load_dwordx4 v232, s[20:23], s6 offen lds
    s_add_u32 m0, s52, 14336
    s_add_u32 s6, s50, 196864
    buffer_load_dwordx4 v233, s[20:23], s6 offen lds
    s_add_u32 m0, s52, 15360
    s_add_u32 s6, s50, 229632
    buffer_load_dwordx4 v233, s[20:23], s6 offen lds
    s_mov_b32 s4, s52
    s_mov_b32 s52, s53
    s_mov_b32 s53, s54
    s_mov_b32 s54, s55
    s_mov_b32 s55, s4
    s_lshl_b32 s51, s57, 7
    s_add_u32 s51, s51, s49
    s_add_u32 s57, s57, 1
    s_cmp_eq_u32 s57, 10
    s_cselect_b32 s57, 1, s57
    s_add_u32 m0, s56, 12288
    s_add_u32 s6, s51, 122880
    buffer_load_dwordx4 v234, s[16:19], s6 offen lds
    s_add_u32 m0, s56, 13312
    s_add_u32 s6, s51, 133120
    buffer_load_dwordx4 v235, s[16:19], s6 offen lds
    s_add_u32 m0, s56, 14336
    s_add_u32 s6, s51, 143360
    buffer_load_dwordx4 v234, s[16:19], s6 offen lds
    s_add_u32 m0, s56, 15360
    s_add_u32 s6, s51, 153600
    buffer_load_dwordx4 v235, s[16:19], s6 offen lds
    s_add_u32 m0, s56, 16384
    s_add_u32 s6, s51, 163840
    buffer_load_dwordx4 v234, s[16:19], s6 offen lds
    s_add_u32 m0, s56, 17408
    s_add_u32 s6, s51, 174080
    buffer_load_dwordx4 v235, s[16:19], s6 offen lds
    s_add_u32 s56, s56, 18432
    s_cmp_eq_u32 s56, 153600
    s_cselect_b32 s56, 98304, s56
    s_waitcnt vmcnt(16)
    s_barrier
    s_add_u32 m0, s52, 11264
    s_add_u32 s6, s50, 360704
    buffer_load_dwordx4 v233, s[20:23], s6 offen lds
    s_add_u32 m0, s52, 12288
    s_add_u32 s6, s50, 393472
    buffer_load_dwordx4 v232, s[20:23], s6 offen lds
    s_add_u32 m0, s52, 13312
    s_add_u32 s6, s50, 426240
    buffer_load_dwordx4 v232, s[20:23], s6 offen lds
    s_add_u32 m0, s52, 14336
    s_add_u32 s6, s50, 459008
    buffer_load_dwordx4 v233, s[20:23], s6 offen lds
    s_add_u32 m0, s52, 15360
    s_add_u32 s6, s50, 491776
    buffer_load_dwordx4 v233, s[20:23], s6 offen lds
    s_mov_b32 s4, s52
    s_mov_b32 s52, s53
    s_mov_b32 s53, s54
    s_mov_b32 s54, s55
    s_mov_b32 s55, s4
    s_add_u32 s42, s42, 1
    s_cmp_lt_u32 s42, 8
    s_cbranch_scc1 L_p_h2
    s_waitcnt vmcnt(16)
    s_barrier
    s_mov_b32 m0, 57344
    s_add_u32 s6, s39, 8192
    buffer_load_dwordx4 v244, s[12:15], s6 offen nt lds
    buffer_load_dwordx4 v245, s[12:15], s6 offen offset:1024 nt lds
    buffer_load_dwordx4 v244, s[12:15], s6 offen offset:2048 nt lds
    buffer_load_dwordx4 v245, s[12:15], s6 offen offset:3072 nt lds
    s_mov_b32 m0, 61440
    s_add_u32 s6, s39, 12288
    buffer_load_dwordx4 v244, s[12:15], s6 offen nt lds
    buffer_load_dwordx4 v245, s[12:15], s6 offen offset:1024 nt lds
    buffer_load_dwordx4 v244, s[12:15], s6 offen offset:2048 nt lds
    buffer_load_dwordx4 v245, s[12:15], s6 offen offset:3072 nt lds
    s_waitcnt vmcnt(13)
    s_barrier
    s_mov_b32 m0, 40960
    s_add_u32 s6, s39, 40960
    buffer_load_dwordx4 v240, s[8:11], s6 offen nt lds
    buffer_load_dwordx4 v241, s[8:11], s6 offen offset:1024 nt lds
    buffer_load_dwordx4 v242, s[8:11], s6 offen offset:2048 nt lds
    buffer_load_dwordx4 v243, s[8:11], s6 offen offset:3072 nt lds
    s_waitcnt vmcnt(12)
    s_barrier
    s_mov_b32 m0, 73728
    s_add_u32 s6, s39, 24576
    buffer_load_dwordx4 v244, s[12:15], s6 offen nt lds
    buffer_load_dwordx4 v245, s[12:15], s6 offen offset:1024 nt lds
    buffer_load_dwordx4 v244, s[12:15], s6 offen offset:2048 nt lds
    buffer_load_dwordx4 v245, s[12:15], s6 offen offset:3072 nt lds
    s_barrier
    s_barrier
    s_waitcnt vmcnt(8) lgkmcnt(0)
    s_barrier
    s_mov_b32 m0, 90112
    s_add_u32 s6, s39, 40960
    buffer_load_dwordx4 v244, s[12:15], s6 offen nt lds
    buffer_load_dwordx4 v245, s[12:15], s6 offen offset:1024 nt lds
    buffer_load_dwordx4 v244, s[12:15], s6 offen offset:2048 nt lds
    buffer_load_dwordx4 v245, s[12:15], s6 offen offset:3072 nt lds
    s_mov_b32 m0, 94208
    s_add_u32 s6, s39, 45056
    buffer_load_dwordx4 v244, s[12:15], s6 offen nt lds
    buffer_load_dwordx4 v245, s[12:15], s6 offen offset:1024 nt lds
    buffer_load_dwordx4 v244, s[12:15], s6 offen offset:2048 nt lds
    buffer_load_dwordx4 v245, s[12:15], s6 offen offset:3072 nt lds
    s_mov_b32 m0, 8192
    s_add_u32 s6, s39, 57344
    buffer_load_dwordx4 v240, s[8:11], s6 offen nt lds
    buffer_load_dwordx4 v241, s[8:11], s6 offen offset:1024 nt lds
    buffer_load_dwordx4 v242, s[8:11], s6 offen offset:2048 nt lds
    buffer_load_dwordx4 v243, s[8:11], s6 offen offset:3072 nt lds
    s_mov_b32 s45, 16384
    s_mov_b32 s46, 49152
    s_add_u32 s43, s39, 65536
    s_add_u32 s44, s39, 49152
    s_waitcnt vmcnt(12)
    s_barrier
    s_add_u32 m0, s46, 4096
    s_add_u32 s7, s44, 4096
    s_waitcnt vmcnt(5)
    buffer_load_dwordx4 v244, s[12:15], s7 offen offset:2048 nt lds
    s_waitcnt vmcnt(5)
    buffer_load_dwordx4 v245, s[12:15], s7 offen offset:3072 nt lds
    s_add_u32 m0, s46, 8192
    s_add_u32 s7, s44, 8192
    s_waitcnt vmcnt(5)
    buffer_load_dwordx4 v244, s[12:15], s7 offen nt lds
    s_waitcnt vmcnt(5)
    buffer_load_dwordx4 v245, s[12:15], s7 offen offset:1024 nt lds
    s_waitcnt vmcnt(5)
    buffer_load_dwordx4 v244, s[12:15], s7 offen offset:2048 nt lds
    s_waitcnt vmcnt(5)
    buffer_load_dwordx4 v245, s[12:15], s7 offen offset:3072 nt lds
    s_add_u32 m0, s46, 12288
    s_add_u32 s7, s44, 12288
    s_waitcnt vmcnt(5)
    buffer_load_dwordx4 v244, s[12:15], s7 offen nt lds
    s_waitcnt vmcnt(5)
    buffer_load_dwordx4 v245, s[12:15], s7 offen offset:1024 nt lds
    s_waitcnt vmcnt(5)
    buffer_load_dwordx4 v244, s[12:15], s7 offen offset:2048 nt lds
    s_waitcnt vmcnt(5)
    buffer_load_dwordx4 v245, s[12:15], s7 offen offset:3072 nt lds
    s_add_u32 s45, s45, 16384
    s_cmp_eq_u32 s45, 49152
    s_cselect_b32 s45, 0, s45
    s_add_u32 s43, s43, 16384
    s_add_u32 s46, s46, 16384
    s_cmp_eq_u32 s46, 98304
    s_cselect_b32 s46, 49152, s46
    s_add_u32 s44, s44, 16384
    v_mov_b32 v249, 163824
    ds_read_b32 v250, v249
    s_and_b32 s4, s2, 7
    s_lshl_b32 s67, s4, 13
    s_add_u32 s67, s67, 58720256
    s_waitcnt lgkmcnt(0)
    v_readfirstlane_b32 s62, v250
    s_lshr_b32 s5, s2, 3
    s_mul_i32 s64, s5, 52
    s_lshr_b32 s64, s64, 8
    s_mul_i32 s6, s64, 5
    s_sub_u32 s65, s5, s6
    s_and_b32 s7, s2, 3
    s_mul_i32 s6, s36, 72
    s_mul_i32 s60, s64, 12
    s_add_u32 s6, s6, s60
    s_add_u32 s6, s6, 6
    s_lshl_b32 s6, s6, 2
    s_add_u32 s6, s6, s7
    s_lshl_b32 s60, s6, 15
    s_mul_i32 s61, s7, 1310720
    s_lshl_b32 s6, s65, 8
    s_add_u32 s61, s61, s6
    s_mul_i32 s6, s36, 30
    s_add_u32 s6, s6, s5
    s_lshl_b32 s72, s6, 18
    s_add_u32 s72, s72, 33562624
    s_lshl_b32 s6, s6, 2
    s_add_u32 s6, s6, 2
    s_lshl_b32 s69, s6, 9
    s_add_u32 s69, s69, 58785792
    s_mul_i32 s73, s64, 192
    s_add_u32 s73, s73, 96
    s_cmp_lt_u32 s5, 30
    s_cselect_b32 s68, 1, 0
    v_bfe_u32 v128, v247, 2, 2
    v_lshrrev_b32 v130, 4, v247
    v_lshl_add_u32 v131, v130, 2, v128
    v_lshlrev_b32 v131, 8, v131
    v_and_b32 v130, 1, v130
    v_lshlrev_b32 v130, 1, v130
    v_lshl_add_u32 v130, v128, 2, v130
    v_bfe_u32 v132, v247, 1, 1
    v_xor_b32 v130, v130, v132
    v_lshl_add_u32 v131, v130, 4, v131
    v_and_b32 v129, 1, v247
    v_lshl_add_u32 v131, v129, 3, v131
    v_xor_b32 v232, 0, v131
    v_xor_b32 v233, 32, v131
    v_xor_b32 v234, 64, v131
    v_xor_b32 v235, 96, v131
    v_xor_b32 v236, 128, v131
    v_xor_b32 v237, 160, v131
    v_xor_b32 v238, 192, v131
    v_xor_b32 v239, 224, v131
    v_lshrrev_b32 v128, 4, v247
    v_and_b32 v129, 15, v247
    v_lshlrev_b32 v130, 2, v128
    v_xor_b32 v130, v130, v129
    v_lshlrev_b32 v130, 4, v130
    v_mul_u32_u24 v128, 1280, v128
    v_add_u32 v251, v128, v130
    v_xor_b32 v130, 32, v130
    v_add_u32 v252, v128, v130
    s_waitcnt vmcnt(10)
    s_barrier
    s_add_u32 m0, s46, 4096
    s_add_u32 s7, s44, 4096
    s_waitcnt vmcnt(5)
    buffer_load_dwordx4 v244, s[12:15], s7 offen offset:2048 nt lds
    s_waitcnt vmcnt(5)
    buffer_load_dwordx4 v245, s[12:15], s7 offen offset:3072 nt lds
    s_add_u32 m0, s46, 8192
    s_add_u32 s7, s44, 8192
    s_waitcnt vmcnt(5)
    buffer_load_dwordx4 v244, s[12:15], s7 offen nt lds
    s_waitcnt vmcnt(5)
    buffer_load_dwordx4 v245, s[12:15], s7 offen offset:1024 nt lds
    s_waitcnt vmcnt(5)
    buffer_load_dwordx4 v244, s[12:15], s7 offen offset:2048 nt lds
    s_waitcnt vmcnt(5)
    buffer_load_dwordx4 v245, s[12:15], s7 offen offset:3072 nt lds
    s_add_u32 m0, s46, 12288
    s_add_u32 s7, s44, 12288
    s_waitcnt vmcnt(5)
    buffer_load_dwordx4 v244, s[12:15], s7 offen nt lds
    s_waitcnt vmcnt(5)
    buffer_load_dwordx4 v245, s[12:15], s7 offen offset:1024 nt lds
    s_waitcnt vmcnt(5)
    buffer_load_dwordx4 v244, s[12:15], s7 offen offset:2048 nt lds
    s_waitcnt vmcnt(5)
    buffer_load_dwordx4 v245, s[12:15], s7 offen offset:3072 nt lds
    s_add_u32 s45, s45, 16384
    s_cmp_eq_u32 s45, 49152
    s_cselect_b32 s45, 0, s45
    s_add_u32 s43, s43, 16384
    s_add_u32 s46, s46, 16384
    s_cmp_eq_u32 s46, 98304
    s_cselect_b32 s46, 49152, s46
    s_add_u32 s44, s44, 16384
    v_mov_b32 v0, 0
    v_mov_b32 v1, 0
    v_mov_b32 v2, 0
    v_mov_b32 v3, 0
    v_mov_b32 v4, 0
    v_mov_b32 v5, 0
    v_mov_b32 v6, 0
    v_mov_b32 v7, 0
    v_mov_b32 v8, 0
    v_mov_b32 v9, 0
    v_mov_b32 v10, 0
    v_mov_b32 v11, 0
    v_mov_b32 v12, 0
    v_mov_b32 v13, 0
    v_mov_b32 v14, 0
    v_mov_b32 v15, 0
    v_mov_b32 v16, 0
    v_mov_b32 v17, 0
    v_mov_b32 v18, 0
    v_mov_b32 v19, 0
    v_mov_b32 v20, 0
    v_mov_b32 v21, 0
    v_mov_b32 v22, 0
    v_mov_b32 v23, 0
    v_mov_b32 v24, 0
    v_mov_b32 v25, 0
    v_mov_b32 v26, 0
    v_mov_b32 v27, 0
    v_mov_b32 v28, 0
    v_mov_b32 v29, 0
    v_mov_b32 v30, 0
    v_mov_b32 v31, 0
    v_mov_b32 v32, 0
    v_mov_b32 v33, 0
    v_mov_b32 v34, 0
    v_mov_b32 v35, 0
    v_mov_b32 v36, 0
    v_mov_b32 v37, 0
    v_mov_b32 v38, 0
    v_mov_b32 v39, 0
    v_mov_b32 v40, 0
    v_mov_b32 v41, 0
    v_mov_b32 v42, 0
    v_mov_b32 v43, 0
    v_mov_b32 v44, 0
    v_mov_b32 v45, 0
    v_mov_b32 v46, 0
    v_mov_b32 v47, 0
    v_mov_b32 v48, 0
    v_mov_b32 v49, 0
    v_mov_b32 v50, 0
    v_mov_b32 v51, 0
    v_mov_b32 v52, 0
    v_mov_b32 v53, 0
    v_mov_b32 v54, 0
    v_mov_b32 v55, 0
    v_mov_b32 v56, 0
    v_mov_b32 v57, 0
    v_mov_b32 v58, 0
    v_mov_b32 v59, 0
    v_mov_b32 v60, 0
    v_mov_b32 v61, 0
    v_mov_b32 v62, 0
    v_mov_b32 v63, 0
    v_mov_b32 v64, 0
    v_mov_b32 v65, 0
    v_mov_b32 v66, 0
    v_mov_b32 v67, 0
    v_mov_b32 v68, 0
    v_mov_b32 v69, 0
    v_mov_b32 v70, 0
    v_mov_b32 v71, 0
    v_mov_b32 v72, 0
    v_mov_b32 v73, 0
    v_mov_b32 v74, 0
    v_mov_b32 v75, 0
    v_mov_b32 v76, 0
    v_mov_b32 v77, 0
    v_mov_b32 v78, 0
    v_mov_b32 v79, 0
    v_mov_b32 v80, 0
    v_mov_b32 v81, 0
    v_mov_b32 v82, 0
    v_mov_b32 v83, 0
    v_mov_b32 v84, 0
    v_mov_b32 v85, 0
    v_mov_b32 v86, 0
    v_mov_b32 v87, 0
    v_mov_b32 v88, 0
    v_mov_b32 v89, 0
    v_mov_b32 v90, 0
    v_mov_b32 v91, 0
    v_mov_b32 v92, 0
    v_mov_b32 v93, 0
    v_mov_b32 v94, 0
    v_mov_b32 v95, 0
    v_mov_b32 v128, 0
    s_and_b32 s6, s2, 3
    s_mul_i32 s6, s6, 81920
    s_add_u32 s6, s6, s72
    buffer_load_dword v129, v128, s[24:27], s6 offen
    s_waitcnt vmcnt(11)
    s_mul_i32 s66, s64, 3
    s_mul_i32 s6, s65, 2
    s_add_u32 s66, s66, s6
    s_mov_b32 s42, 3
L_kva_h2:
    s_barrier
    s_add_u32 m0, s46, 4096
    s_add_u32 s7, s44, 4096
    s_waitcnt vmcnt(5)
    buffer_load_dwordx4 v244, s[12:15], s7 offen offset:2048 nt lds
    s_waitcnt vmcnt(5)
    buffer_load_dwordx4 v245, s[12:15], s7 offen offset:3072 nt lds
    s_add_u32 m0, s46, 8192
    s_add_u32 s7, s44, 8192
    s_waitcnt vmcnt(5)
    buffer_load_dwordx4 v244, s[12:15], s7 offen nt lds
    s_waitcnt vmcnt(5)
    buffer_load_dwordx4 v245, s[12:15], s7 offen offset:1024 nt lds
    s_waitcnt vmcnt(5)
    buffer_load_dwordx4 v244, s[12:15], s7 offen offset:2048 nt lds
    s_waitcnt vmcnt(5)
    buffer_load_dwordx4 v245, s[12:15], s7 offen offset:3072 nt lds
    s_add_u32 m0, s46, 12288
    s_add_u32 s7, s44, 12288
    s_waitcnt vmcnt(5)
    buffer_load_dwordx4 v244, s[12:15], s7 offen nt lds
    s_waitcnt vmcnt(5)
    buffer_load_dwordx4 v245, s[12:15], s7 offen offset:1024 nt lds
    s_waitcnt vmcnt(5)
    buffer_load_dwordx4 v244, s[12:15], s7 offen offset:2048 nt lds
    s_waitcnt vmcnt(5)
    buffer_load_dwordx4 v245, s[12:15], s7 offen offset:3072 nt lds
    s_add_u32 s45, s45, 16384
    s_cmp_eq_u32 s45, 49152
    s_cselect_b32 s45, 0, s45
    s_add_u32 s43, s43, 16384
    s_add_u32 s46, s46, 16384
    s_cmp_eq_u32 s46, 98304
    s_cselect_b32 s46, 49152, s46
    s_add_u32 s44, s44, 16384
    s_add_u32 s42, s42, 1
    s_cmp_le_u32 s42, 18
    s_waitcnt vmcnt(10)
    s_cbranch_scc1 L_kva_h2
    s_mov_b32 s42, 19
L_kvb_h2:
    s_barrier
    s_add_u32 m0, s46, 4096
    s_add_u32 s7, s44, 4096
    s_waitcnt vmcnt(5)
    buffer_load_dwordx4 v244, s[12:15], s7 offen offset:2048 nt lds
    s_waitcnt vmcnt(5)
    buffer_load_dwordx4 v245, s[12:15], s7 offen offset:3072 nt lds
    s_add_u32 m0, s46, 8192
    s_add_u32 s7, s44, 8192
    s_waitcnt vmcnt(5)
    buffer_load_dwordx4 v244, s[12:15], s7 offen nt lds
    s_waitcnt vmcnt(5)
    buffer_load_dwordx4 v245, s[12:15], s7 offen offset:1024 nt lds
    s_waitcnt vmcnt(5)
    buffer_load_dwordx4 v244, s[12:15], s7 offen offset:2048 nt lds
    s_waitcnt vmcnt(5)
    buffer_load_dwordx4 v245, s[12:15], s7 offen offset:3072 nt lds
    s_add_u32 m0, s46, 12288
    s_add_u32 s7, s44, 12288
    s_waitcnt vmcnt(5)
    buffer_load_dwordx4 v244, s[12:15], s7 offen nt lds
    s_waitcnt vmcnt(5)
    buffer_load_dwordx4 v245, s[12:15], s7 offen offset:1024 nt lds
    s_waitcnt vmcnt(5)
    buffer_load_dwordx4 v244, s[12:15], s7 offen offset:2048 nt lds
    s_waitcnt vmcnt(5)
    buffer_load_dwordx4 v245, s[12:15], s7 offen offset:3072 nt lds
    s_add_u32 s45, s45, 16384
    s_cmp_eq_u32 s45, 49152
    s_cselect_b32 s45, 0, s45
    s_add_u32 s43, s43, 16384
    s_add_u32 s46, s46, 16384
    s_cmp_eq_u32 s46, 98304
    s_cselect_b32 s46, 49152, s46
    s_add_u32 s44, s44, 16384
    s_add_u32 s42, s42, 1
    s_cmp_le_u32 s42, 28
    s_waitcnt vmcnt(10)
    s_cbranch_scc1 L_kvb_h2
    s_barrier
    s_add_u32 m0, s46, 4096
    s_add_u32 s7, s44, 4096
    buffer_load_dwordx4 v244, s[12:15], s7 offen offset:2048 nt lds
    buffer_load_dwordx4 v245, s[12:15], s7 offen offset:3072 nt lds
    s_add_u32 m0, s46, 8192
    s_add_u32 s7, s44, 8192
    buffer_load_dwordx4 v244, s[12:15], s7 offen nt lds
    buffer_load_dwordx4 v245, s[12:15], s7 offen offset:1024 nt lds
    buffer_load_dwordx4 v244, s[12:15], s7 offen offset:2048 nt lds
    buffer_load_dwordx4 v245, s[12:15], s7 offen offset:3072 nt lds
    s_add_u32 m0, s46, 12288
    s_add_u32 s7, s44, 12288
    buffer_load_dwordx4 v244, s[12:15], s7 offen nt lds
    buffer_load_dwordx4 v245, s[12:15], s7 offen offset:1024 nt lds
    buffer_load_dwordx4 v244, s[12:15], s7 offen offset:2048 nt lds
    buffer_load_dwordx4 v245, s[12:15], s7 offen offset:3072 nt lds
    s_cmp_eq_u32 s68, 0
    s_cbranch_scc1 L_notile_h2
    s_mov_b32 s63, 0
    s_mov_b32 s52, 98304
    s_add_u32 s51, s63, s66
    s_bfe_u32 s49, s51, 0x20002
    s_lshl_b32 s49, s49, 3
    s_and_b32 s51, s51, 3
    s_add_u32 s49, s49, s51
    s_lshr_b32 s51, s63, 4
    s_lshl2_add_u32 s49, s51, s49
    s_add_u32 s63, s63, 1
    s_mul_i32 s48, s49, 40960
    s_add_u32 s48, s48, s61
    s_add_u32 m0, s52, 5120
    s_add_u32 s6, s48, 25600
    buffer_load_dwordx4 v252, s[28:31], s6 offen lds
    s_add_u32 m0, s52, 6144
    s_add_u32 s6, s48, 30720
    buffer_load_dwordx4 v251, s[28:31], s6 offen lds
    s_add_u32 m0, s52, 7168
    s_add_u32 s6, s48, 35840
    buffer_load_dwordx4 v252, s[28:31], s6 offen lds
    s_mov_b32 s63, 1
    s_mov_b32 s52, 106496
    s_add_u32 s51, s63, s66
    s_bfe_u32 s49, s51, 0x20002
    s_lshl_b32 s49, s49, 3
    s_and_b32 s51, s51, 3
    s_add_u32 s49, s49, s51
    s_lshr_b32 s51, s63, 4
    s_lshl2_add_u32 s49, s51, s49
    s_add_u32 s63, s63, 1
    s_mul_i32 s48, s49, 40960
    s_add_u32 s48, s48, s61
    s_add_u32 m0, s52, 5120
    s_add_u32 s6, s48, 25600
    buffer_load_dwordx4 v252, s[28:31], s6 offen lds
    s_add_u32 m0, s52, 6144
    s_add_u32 s6, s48, 30720
    buffer_load_dwordx4 v251, s[28:31], s6 offen lds
    s_add_u32 m0, s52, 7168
    s_add_u32 s6, s48, 35840
    buffer_load_dwordx4 v252, s[28:31], s6 offen lds
    s_mov_b32 s63, 2
    s_mov_b32 s52, 114688
    s_add_u32 s51, s63, s66
    s_bfe_u32 s49, s51, 0x20002
    s_lshl_b32 s49, s49, 3
    s_and_b32 s51, s51, 3
    s_add_u32 s49, s49, s51
    s_lshr_b32 s51, s63, 4
    s_lshl2_add_u32 s49, s51, s49
    s_add_u32 s63, s63, 1
    s_mul_i32 s48, s49, 40960
    s_add_u32 s48, s48, s61
    s_add_u32 m0, s52, 5120
    s_add_u32 s6, s48, 25600
    buffer_load_dwordx4 v252, s[28:31], s6 offen lds
    s_add_u32 m0, s52, 6144
    s_add_u32 s6, s48, 30720
    buffer_load_dwordx4 v251, s[28:31], s6 offen lds
    s_add_u32 m0, s52, 7168
    s_add_u32 s6, s48, 35840
    buffer_load_dwordx4 v252, s[28:31], s6 offen lds
    s_mov_b32 s63, 3
    s_mov_b32 s52, 122880
    s_add_u32 s51, s63, s66
    s_bfe_u32 s49, s51, 0x20002
    s_lshl_b32 s49, s49, 3
    s_and_b32 s51, s51, 3
    s_add_u32 s49, s49, s51
    s_lshr_b32 s51, s63, 4
    s_lshl2_add_u32 s49, s51, s49
    s_add_u32 s63, s63, 1
    s_mul_i32 s48, s49, 40960
    s_add_u32 s48, s48, s61
    s_add_u32 m0, s52, 5120
    s_add_u32 s6, s48, 25600
    buffer_load_dwordx4 v252, s[28:31], s6 offen lds
    s_add_u32 m0, s52, 6144
    s_add_u32 s6, s48, 30720
    buffer_load_dwordx4 v251, s[28:31], s6 offen lds
    s_add_u32 m0, s52, 7168
    s_add_u32 s6, s48, 35840
    buffer_load_dwordx4 v252, s[28:31], s6 offen lds
    s_mov_b32 s63, 4
    s_mov_b32 s52, 131072
    s_add_u32 s51, s63, s66
    s_bfe_u32 s49, s51, 0x20002
    s_lshl_b32 s49, s49, 3
    s_and_b32 s51, s51, 3
    s_add_u32 s49, s49, s51
    s_lshr_b32 s51, s63, 4
    s_lshl2_add_u32 s49, s51, s49
    s_add_u32 s63, s63, 1
    s_mul_i32 s48, s49, 40960
    s_add_u32 s48, s48, s61
    s_add_u32 m0, s52, 5120
    s_add_u32 s6, s48, 25600
    buffer_load_dwordx4 v252, s[28:31], s6 offen lds
    s_add_u32 m0, s52, 6144
    s_add_u32 s6, s48, 30720
    buffer_load_dwordx4 v251, s[28:31], s6 offen lds
    s_add_u32 m0, s52, 7168
    s_add_u32 s6, s48, 35840
    buffer_load_dwordx4 v252, s[28:31], s6 offen lds
    s_mov_b32 s63, 5
    s_mov_b32 s52, 139264
    s_add_u32 s51, s63, s66
    s_bfe_u32 s49, s51, 0x20002
    s_lshl_b32 s49, s49, 3
    s_and_b32 s51, s51, 3
    s_add_u32 s49, s49, s51
    s_lshr_b32 s51, s63, 4
    s_lshl2_add_u32 s49, s51, s49
    s_add_u32 s63, s63, 1
    s_mul_i32 s48, s49, 40960
    s_add_u32 s48, s48, s61
    s_add_u32 m0, s52, 5120
    s_add_u32 s6, s48, 25600
    buffer_load_dwordx4 v252, s[28:31], s6 offen lds
    s_add_u32 m0, s52, 6144
    s_add_u32 s6, s48, 30720
    buffer_load_dwordx4 v251, s[28:31], s6 offen lds
    s_add_u32 m0, s52, 7168
    s_add_u32 s6, s48, 35840
    buffer_load_dwordx4 v252, s[28:31], s6 offen lds
    s_mov_b32 s63, 6
    s_mov_b32 s52, 32768
    s_add_u32 s51, s63, s66
    s_bfe_u32 s49, s51, 0x20002
    s_lshl_b32 s49, s49, 3
    s_and_b32 s51, s51, 3
    s_add_u32 s49, s49, s51
    s_lshr_b32 s51, s63, 4
    s_lshl2_add_u32 s49, s51, s49
    s_add_u32 s63, s63, 1
    s_mul_i32 s48, s49, 40960
    s_add_u32 s48, s48, s61
    s_add_u32 m0, s52, 5120
    s_add_u32 s6, s48, 25600
    buffer_load_dwordx4 v252, s[28:31], s6 offen lds
    s_add_u32 m0, s52, 6144
    s_add_u32 s6, s48, 30720
    buffer_load_dwordx4 v251, s[28:31], s6 offen lds
    s_add_u32 m0, s52, 7168
    s_add_u32 s6, s48, 35840
    buffer_load_dwordx4 v252, s[28:31], s6 offen lds
    s_mov_b32 s63, 7
    s_mov_b32 s52, 40960
    s_add_u32 s51, s63, s66
    s_bfe_u32 s49, s51, 0x20002
    s_lshl_b32 s49, s49, 3
    s_and_b32 s51, s51, 3
    s_add_u32 s49, s49, s51
    s_lshr_b32 s51, s63, 4
    s_lshl2_add_u32 s49, s51, s49
    s_add_u32 s63, s63, 1
    s_mul_i32 s48, s49, 40960
    s_add_u32 s48, s48, s61
    s_add_u32 m0, s52, 5120
    s_add_u32 s6, s48, 25600
    buffer_load_dwordx4 v252, s[28:31], s6 offen lds
    s_add_u32 m0, s52, 6144
    s_add_u32 s6, s48, 30720
    buffer_load_dwordx4 v251, s[28:31], s6 offen lds
    s_add_u32 m0, s52, 7168
    s_add_u32 s6, s48, 35840
    buffer_load_dwordx4 v252, s[28:31], s6 offen lds
    s_mul_i32 s6, s73, 7282
    s_lshr_b32 s6, s6, 20
    s_and_b32 s6, s6, 7
    s_lshl_b32 s6, s6, 7
    v_lshlrev_b32 v249, 3, v246
    v_and_b32 v249, 3072, v249
    v_add_u32 v249, s6, v249
    buffer_load_dword v250, v249, s[24:27], s67 offen sc1
    s_waitcnt vmcnt(35)
    s_barrier
    s_mov_b32 s63, 8
    s_mov_b32 s52, 0
    s_add_u32 s51, s63, s66
    s_bfe_u32 s49, s51, 0x20002
    s_lshl_b32 s49, s49, 3
    s_and_b32 s51, s51, 3
    s_add_u32 s49, s49, s51
    s_lshr_b32 s51, s63, 4
    s_lshl2_add_u32 s49, s51, s49
    s_add_u32 s63, s63, 1
    s_mul_i32 s48, s49, 40960
    s_add_u32 s48, s48, s61
    s_add_u32 m0, s52, 5120
    s_add_u32 s6, s48, 25600
    buffer_load_dwordx4 v252, s[28:31], s6 offen lds
    s_add_u32 m0, s52, 6144
    s_add_u32 s6, s48, 30720
    buffer_load_dwordx4 v251, s[28:31], s6 offen lds
    s_add_u32 m0, s52, 7168
    s_add_u32 s6, s48, 35840
    buffer_load_dwordx4 v252, s[28:31], s6 offen lds
    s_mov_b32 s63, 9
    s_mov_b32 s52, 8192
    s_add_u32 s51, s63, s66
    s_bfe_u32 s49, s51, 0x20002
    s_lshl_b32 s49, s49, 3
    s_and_b32 s51, s51, 3
    s_add_u32 s49, s49, s51
    s_lshr_b32 s51, s63, 4
    s_lshl2_add_u32 s49, s51, s49
    s_add_u32 s63, s63, 1
    s_mul_i32 s48, s49, 40960
    s_add_u32 s48, s48, s61
    s_add_u32 m0, s52, 5120
    s_add_u32 s6, s48, 25600
    buffer_load_dwordx4 v252, s[28:31], s6 offen lds
    s_add_u32 m0, s52, 6144
    s_add_u32 s6, s48, 30720
    buffer_load_dwordx4 v251, s[28:31], s6 offen lds
    s_add_u32 m0, s52, 7168
    s_add_u32 s6, s48, 35840
    buffer_load_dwordx4 v252, s[28:31], s6 offen lds
    s_mov_b32 s63, 10
    s_mov_b32 s52, 81920
    s_add_u32 s51, s63, s66
    s_bfe_u32 s49, s51, 0x20002
    s_lshl_b32 s49, s49, 3
    s_and_b32 s51, s51, 3
    s_add_u32 s49, s49, s51
    s_lshr_b32 s51, s63, 4
    s_lshl2_add_u32 s49, s51, s49
    s_add_u32 s63, s63, 1
    s_mul_i32 s48, s49, 40960
    s_add_u32 s48, s48, s61
    s_add_u32 m0, s52, 5120
    s_add_u32 s6, s48, 25600
    buffer_load_dwordx4 v252, s[28:31], s6 offen lds
    s_add_u32 m0, s52, 6144
    s_add_u32 s6, s48, 30720
    buffer_load_dwordx4 v251, s[28:31], s6 offen lds
    s_add_u32 m0, s52, 7168
    s_add_u32 s6, s48, 35840
    buffer_load_dwordx4 v252, s[28:31], s6 offen lds
    s_mov_b32 s63, 11
    s_mov_b32 s52, 90112
    s_add_u32 s51, s63, s66
    s_bfe_u32 s49, s51, 0x20002
    s_lshl_b32 s49, s49, 3
    s_and_b32 s51, s51, 3
    s_add_u32 s49, s49, s51
    s_lshr_b32 s51, s63, 4
    s_lshl2_add_u32 s49, s51, s49
    s_add_u32 s63, s63, 1
    s_mul_i32 s48, s49, 40960
    s_add_u32 s48, s48, s61
    s_add_u32 m0, s52, 5120
    s_add_u32 s6, s48, 25600
    buffer_load_dwordx4 v252, s[28:31], s6 offen lds
    s_add_u32 m0, s52, 6144
    s_add_u32 s6, s48, 30720
    buffer_load_dwordx4 v251, s[28:31], s6 offen lds
    s_add_u32 m0, s52, 7168
    s_add_u32 s6, s48, 35840
    buffer_load_dwordx4 v252, s[28:31], s6 offen lds
    s_waitcnt vmcnt(12)
    v_cmp_ne_u32 vcc, s62, v250
    s_nop 0
    s_cmp_eq_u64 vcc, 0
    s_cbranch_scc1 L_spx_o1h2
    s_mov_b32 s53, 0
L_sp_o1h2:
    s_add_u32 s53, s53, 1
    s_cmp_gt_u32 s53, 400000
    s_cbranch_scc1 L_spx_o1h2
    buffer_load_dword v250, v249, s[24:27], s67 offen sc1
    s_waitcnt vmcnt(0)
    v_cmp_ne_u32 vcc, s62, v250
    s_nop 0
    s_cmp_eq_u64 vcc, 0
    s_cbranch_scc0 L_sp_o1h2
L_spx_o1h2:
    s_mov_b32 s63, 0
    s_add_u32 s51, s63, s66
    s_bfe_u32 s49, s51, 0x20002
    s_lshl_b32 s49, s49, 3
    s_and_b32 s51, s51, 3
    s_add_u32 s49, s49, s51
    s_lshr_b32 s51, s63, 4
    s_lshl2_add_u32 s49, s51, s49
    s_add_u32 s63, s63, 1
    s_lshl_b32 s49, s49, 10
    s_add_u32 s49, s49, s60
    s_add_u32 s6, s49, 0
    buffer_load_dwordx4 v[128:131], v246, s[24:27], s6 offen sc1
    s_add_u32 s6, s49, 131072
    buffer_load_dwordx4 v[132:135], v246, s[24:27], s6 offen sc1
    s_add_u32 s6, s49, 262144
    buffer_load_dwordx4 v[136:139], v246, s[24:27], s6 offen sc1
    s_add_u32 s51, s63, s66
    s_bfe_u32 s49, s51, 0x20002
    s_lshl_b32 s49, s49, 3
    s_and_b32 s51, s51, 3
    s_add_u32 s49, s49, s51
    s_lshr_b32 s51, s63, 4
    s_lshl2_add_u32 s49, s51, s49
    s_add_u32 s63, s63, 1
    s_lshl_b32 s49, s49, 10
    s_add_u32 s49, s49, s60
    s_add_u32 s6, s49, 0
    buffer_load_dwordx4 v[144:147], v246, s[24:27], s6 offen sc1
    s_add_u32 s6, s49, 131072
    buffer_load_dwordx4 v[148:151], v246, s[24:27], s6 offen sc1
    s_add_u32 s6, s49, 262144
    buffer_load_dwordx4 v[152:155], v246, s[24:27], s6 offen sc1
    s_add_u32 s51, s63, s66
    s_bfe_u32 s49, s51, 0x20002
    s_lshl_b32 s49, s49, 3
    s_and_b32 s51, s51, 3
    s_add_u32 s49, s49, s51
    s_lshr_b32 s51, s63, 4
    s_lshl2_add_u32 s49, s51, s49
    s_add_u32 s63, s63, 1
    s_lshl_b32 s49, s49, 10
    s_add_u32 s49, s49, s60
    s_add_u32 s6, s49, 0
    buffer_load_dwordx4 v[160:163], v246, s[24:27], s6 offen sc1
    s_add_u32 s6, s49, 131072
    buffer_load_dwordx4 v[164:167], v246, s[24:27], s6 offen sc1
    s_add_u32 s6, s49, 262144
    buffer_load_dwordx4 v[168:171], v246, s[24:27], s6 offen sc1
    s_barrier
    s_mov_b32 s63, 12
    s_mov_b32 s52, 16384
    s_add_u32 s51, s63, s66
    s_bfe_u32 s49, s51, 0x20002
    s_lshl_b32 s49, s49, 3
    s_and_b32 s51, s51, 3
    s_add_u32 s49, s49, s51
    s_lshr_b32 s51, s63, 4
    s_lshl2_add_u32 s49, s51, s49
    s_add_u32 s63, s63, 1
    s_mul_i32 s48, s49, 40960
    s_add_u32 s48, s48, s61
    s_add_u32 m0, s52, 5120
    s_add_u32 s6, s48, 25600
    buffer_load_dwordx4 v252, s[28:31], s6 offen lds
    s_add_u32 m0, s52, 6144
    s_add_u32 s6, s48, 30720
    buffer_load_dwordx4 v251, s[28:31], s6 offen lds
    s_add_u32 m0, s52, 7168
    s_add_u32 s6, s48, 35840
    buffer_load_dwordx4 v252, s[28:31], s6 offen lds
    s_mov_b32 s63, 13
    s_mov_b32 s52, 24576
    s_add_u32 s51, s63, s66
    s_bfe_u32 s49, s51, 0x20002
    s_lshl_b32 s49, s49, 3
    s_and_b32 s51, s51, 3
    s_add_u32 s49, s49, s51
    s_lshr_b32 s51, s63, 4
    s_lshl2_add_u32 s49, s51, s49
    s_add_u32 s63, s63, 1
    s_mul_i32 s48, s49, 40960
    s_add_u32 s48, s48, s61
    s_add_u32 m0, s52, 5120
    s_add_u32 s6, s48, 25600
    buffer_load_dwordx4 v252, s[28:31], s6 offen lds
    s_add_u32 m0, s52, 6144
    s_add_u32 s6, s48, 30720
    buffer_load_dwordx4 v251, s[28:31], s6 offen lds
    s_add_u32 m0, s52, 7168
    s_add_u32 s6, s48, 35840
    buffer_load_dwordx4 v252, s[28:31], s6 offen lds
    s_mov_b32 s63, 14
    s_mov_b32 s52, 49152
    s_add_u32 s51, s63, s66
    s_bfe_u32 s49, s51, 0x20002
    s_lshl_b32 s49, s49, 3
    s_and_b32 s51, s51, 3
    s_add_u32 s49, s49, s51
    s_lshr_b32 s51, s63, 4
    s_lshl2_add_u32 s49, s51, s49
    s_add_u32 s63, s63, 1
    s_mul_i32 s48, s49, 40960
    s_add_u32 s48, s48, s61
    s_add_u32 m0, s52, 5120
    s_add_u32 s6, s48, 25600
    buffer_load_dwordx4 v252, s[28:31], s6 offen lds
    s_add_u32 m0, s52, 6144
    s_add_u32 s6, s48, 30720
    buffer_load_dwordx4 v251, s[28:31], s6 offen lds
    s_add_u32 m0, s52, 7168
    s_add_u32 s6, s48, 35840
    buffer_load_dwordx4 v252, s[28:31], s6 offen lds
    s_mov_b32 s63, 15
    s_mov_b32 s52, 57344
    s_add_u32 s51, s63, s66
    s_bfe_u32 s49, s51, 0x20002
    s_lshl_b32 s49, s49, 3
    s_and_b32 s51, s51, 3
    s_add_u32 s49, s49, s51
    s_lshr_b32 s51, s63, 4
    s_lshl2_add_u32 s49, s51, s49
    s_add_u32 s63, s63, 1
    s_mul_i32 s48, s49, 40960
    s_add_u32 s48, s48, s61
    s_add_u32 m0, s52, 5120
    s_add_u32 s6, s48, 25600
    buffer_load_dwordx4 v252, s[28:31], s6 offen lds
    s_add_u32 m0, s52, 6144
    s_add_u32 s6, s48, 30720
    buffer_load_dwordx4 v251, s[28:31], s6 offen lds
    s_add_u32 m0, s52, 7168
    s_add_u32 s6, s48, 35840
    buffer_load_dwordx4 v252, s[28:31], s6 offen lds
    s_mov_b32 s63, 3
    s_mov_b32 s50, 0
    s_mov_b32 s58, 0x43150287
    s_mov_b32 s59, 0x31502876
    s_add_u32 s54, s67, 4096
    v_add_u32 v224, 98304, v232
    v_add_u32 v225, 98304, v233
    v_add_u32 v226, 98304, v234
    v_add_u32 v227, 98304, v235
    v_add_u32 v228, 98304, v236
    v_add_u32 v229, 98304, v237
    v_add_u32 v230, 98304, v238
    v_add_u32 v231, 98304, v239
    ds_read_b64_tr_b16 v[192:193], v224
    ds_read_b64_tr_b16 v[194:195], v224 offset:4096
    ds_read_b64_tr_b16 v[196:197], v225
    ds_read_b64_tr_b16 v[198:199], v225 offset:4096
    ds_read_b64_tr_b16 v[200:201], v226
    ds_read_b64_tr_b16 v[202:203], v226 offset:4096
    ds_read_b64_tr_b16 v[204:205], v227
    ds_read_b64_tr_b16 v[206:207], v227 offset:4096
    ds_read_b64_tr_b16 v[208:209], v228
    ds_read_b64_tr_b16 v[210:211], v228 offset:4096
    ds_read_b64_tr_b16 v[212:213], v229
    ds_read_b64_tr_b16 v[214:215], v229 offset:4096
    ds_read_b64_tr_b16 v[216:217], v230
    ds_read_b64_tr_b16 v[218:219], v230 offset:4096
    ds_read_b64_tr_b16 v[220:221], v231
    ds_read_b64_tr_b16 v[222:223], v231 offset:4096
    s_waitcnt vmcnt(9)
    s_barrier
    s_branch L_t
L_notile_h2:
    s_waitcnt vmcnt(10)
    s_barrier
    s_waitcnt vmcnt(0)
    s_barrier
    s_branch L_end
.p2align 3
L_t:
    s_waitcnt vmcnt(8) lgkmcnt(14)
    v_mfma_f32_16x16x32_bf16 v[0:3], v[192:195], v[128:131], v[0:3]
    s_add_u32 s51, s63, s66
    s_bfe_u32 s49, s51, 0x20002
    s_waitcnt vmcnt(7)
    v_mfma_f32_16x16x32_bf16 v[32:35], v[192:195], v[132:135], v[32:35]
    s_lshl_b32 s49, s49, 3
    s_and_b32 s51, s51, 3
    s_waitcnt vmcnt(6)
    v_mfma_f32_16x16x32_bf16 v[64:67], v[192:195], v[136:139], v[64:67]
    s_add_u32 s49, s49, s51
    s_lshr_b32 s51, s63, 4
    s_waitcnt lgkmcnt(12)
    v_mfma_f32_16x16x32_bf16 v[4:7], v[196:199], v[128:131], v[4:7]
    ds_read_b64_tr_b16 v[192:193], v224 offset:8192
    v_mfma_f32_16x16x32_bf16 v[36:39], v[196:199], v[132:135], v[36:39]
    ds_read_b64_tr_b16 v[194:195], v224 offset:12288
    v_mfma_f32_16x16x32_bf16 v[68:71], v[196:199], v[136:139], v[68:71]
    s_lshl2_add_u32 s49, s51, s49
    s_add_u32 s63, s63, 1
    s_waitcnt lgkmcnt(12)
    v_mfma_f32_16x16x32_bf16 v[8:11], v[200:203], v[128:131], v[8:11]
    ds_read_b64_tr_b16 v[196:197], v225 offset:8192
    v_mfma_f32_16x16x32_bf16 v[40:43], v[200:203], v[132:135], v[40:43]
    ds_read_b64_tr_b16 v[198:199], v225 offset:12288
    v_mfma_f32_16x16x32_bf16 v[72:75], v[200:203], v[136:139], v[72:75]
    s_lshl_b32 s49, s49, 10
    s_add_u32 s49, s49, s60
    s_waitcnt lgkmcnt(12)
    v_mfma_f32_16x16x32_bf16 v[12:15], v[204:207], v[128:131], v[12:15]
    ds_read_b64_tr_b16 v[200:201], v226 offset:8192
    v_mfma_f32_16x16x32_bf16 v[44:47], v[204:207], v[132:135], v[44:47]
    ds_read_b64_tr_b16 v[202:203], v226 offset:12288
    v_mfma_f32_16x16x32_bf16 v[76:79], v[204:207], v[136:139], v[76:79]
    s_add_u32 s6, s49, 0
    buffer_load_dwordx4 v[176:179], v246, s[24:27], s6 offen sc1
    s_waitcnt lgkmcnt(12)
    v_mfma_f32_16x16x32_bf16 v[16:19], v[208:211], v[128:131], v[16:19]
    ds_read_b64_tr_b16 v[204:205], v227 offset:8192
    v_mfma_f32_16x16x32_bf16 v[48:51], v[208:211], v[132:135], v[48:51]
    ds_read_b64_tr_b16 v[206:207], v227 offset:12288
    v_mfma_f32_16x16x32_bf16 v[80:83], v[208:211], v[136:139], v[80:83]
    s_add_u32 s6, s49, 131072
    buffer_load_dwordx4 v[180:183], v246, s[24:27], s6 offen sc1
    s_waitcnt lgkmcnt(12)
    v_mfma_f32_16x16x32_bf16 v[20:23], v[212:215], v[128:131], v[20:23]
    ds_read_b64_tr_b16 v[208:209], v228 offset:8192
    v_mfma_f32_16x16x32_bf16 v[52:55], v[212:215], v[132:135], v[52:55]
    ds_read_b64_tr_b16 v[210:211], v228 offset:12288
    v_mfma_f32_16x16x32_bf16 v[84:87], v[212:215], v[136:139], v[84:87]
    s_add_u32 s6, s49, 262144
    buffer_load_dwordx4 v[184:187], v246, s[24:27], s6 offen sc1
    s_waitcnt lgkmcnt(12)
    v_mfma_f32_16x16x32_bf16 v[24:27], v[216:219], v[128:131], v[24:27]
    ds_read_b64_tr_b16 v[212:213], v229 offset:8192
    v_mfma_f32_16x16x32_bf16 v[56:59], v[216:219], v[132:135], v[56:59]
    ds_read_b64_tr_b16 v[214:215], v229 offset:12288
    v_mfma_f32_16x16x32_bf16 v[88:91], v[216:219], v[136:139], v[88:91]
    s_waitcnt lgkmcnt(12)
    v_mfma_f32_16x16x32_bf16 v[28:31], v[220:223], v[128:131], v[28:31]
    ds_read_b64_tr_b16 v[216:217], v230 offset:8192
    v_mfma_f32_16x16x32_bf16 v[60:63], v[220:223], v[132:135], v[60:63]
    ds_read_b64_tr_b16 v[218:219], v230 offset:12288
    v_mfma_f32_16x16x32_bf16 v[92:95], v[220:223], v[136:139], v[92:95]
    s_and_b32 s55, s58, 15
    s_lshl_b32 s55, s55, 14
    s_lshr_b64 s[58:59], s[58:59], 4
    s_waitcnt vmcnt(8) lgkmcnt(12)
    v_mfma_f32_16x16x32_bf16 v[0:3], v[192:195], v[144:147], v[0:3]
    ds_read_b64_tr_b16 v[220:221], v231 offset:8192
    s_waitcnt vmcnt(7)
    v_mfma_f32_16x16x32_bf16 v[32:35], v[192:195], v[148:151], v[32:35]
    ds_read_b64_tr_b16 v[222:223], v231 offset:12288
    s_waitcnt vmcnt(6)
    v_mfma_f32_16x16x32_bf16 v[64:67], v[192:195], v[152:155], v[64:67]
    s_add_u32 s51, s63, s66
    s_bfe_u32 s49, s51, 0x20002
    v_add_u32 v224, s55, v232
    s_waitcnt lgkmcnt(12)
    v_mfma_f32_16x16x32_bf16 v[4:7], v[196:199], v[144:147], v[4:7]
    ds_read_b64_tr_b16 v[192:193], v224
    v_mfma_f32_16x16x32_bf16 v[36:39], v[196:199], v[148:151], v[36:39]
    ds_read_b64_tr_b16 v[194:195], v224 offset:4096
    v_mfma_f32_16x16x32_bf16 v[68:71], v[196:199], v[152:155], v[68:71]
    s_lshl_b32 s49, s49, 3
    s_and_b32 s51, s51, 3
    v_add_u32 v225, s55, v233
    s_waitcnt lgkmcnt(12)
    v_mfma_f32_16x16x32_bf16 v[8:11], v[200:203], v[144:147], v[8:11]
    ds_read_b64_tr_b16 v[196:197], v225
    v_mfma_f32_16x16x32_bf16 v[40:43], v[200:203], v[148:151], v[40:43]
    ds_read_b64_tr_b16 v[198:199], v225 offset:4096
    v_mfma_f32_16x16x32_bf16 v[72:75], v[200:203], v[152:155], v[72:75]
    s_add_u32 s49, s49, s51
    s_lshr_b32 s51, s63, 4
    v_add_u32 v226, s55, v234
    s_waitcnt lgkmcnt(12)
    v_mfma_f32_16x16x32_bf16 v[12:15], v[204:207], v[144:147], v[12:15]
    ds_read_b64_tr_b16 v[200:201], v226
    v_mfma_f32_16x16x32_bf16 v[44:47], v[204:207], v[148:151], v[44:47]
    ds_read_b64_tr_b16 v[202:203], v226 offset:4096
    v_mfma_f32_16x16x32_bf16 v[76:79], v[204:207], v[152:155], v[76:79]
    s_lshl2_add_u32 s49, s51, s49
    s_add_u32 s63, s63, 1
    v_add_u32 v227, s55, v235
    s_waitcnt lgkmcnt(12)
    v_mfma_f32_16x16x32_bf16 v[16:19], v[208:211], v[144:147], v[16:19]
    ds_read_b64_tr_b16 v[204:205], v227
    v_mfma_f32_16x16x32_bf16 v[48:51], v[208:211], v[148:151], v[48:51]
    ds_read_b64_tr_b16 v[206:207], v227 offset:4096
    v_mfma_f32_16x16x32_bf16 v[80:83], v[208:211], v[152:155], v[80:83]
    s_lshl_b32 s49, s49, 10
    s_add_u32 s49, s49, s60
    v_add_u32 v228, s55, v236
    s_waitcnt lgkmcnt(12)
    v_mfma_f32_16x16x32_bf16 v[20:23], v[212:215], v[144:147], v[20:23]
    ds_read_b64_tr_b16 v[208:209], v228
    v_mfma_f32_16x16x32_bf16 v[52:55], v[212:215], v[148:151], v[52:55]
    ds_read_b64_tr_b16 v[210:211], v228 offset:4096
    v_mfma_f32_16x16x32_bf16 v[84:87], v[212:215], v[152:155], v[84:87]
    s_add_u32 s6, s49, 0
    buffer_load_dwordx4 v[128:131], v246, s[24:27], s6 offen sc1
    v_add_u32 v229, s55, v237
    s_waitcnt lgkmcnt(12)
    v_mfma_f32_16x16x32_bf16 v[24:27], v[216:219], v[144:147], v[24:27]
    ds_read_b64_tr_b16 v[212:213], v229
    v_mfma_f32_16x16x32_bf16 v[56:59], v[216:219], v[148:151], v[56:59]
    ds_read_b64_tr_b16 v[214:215], v229 offset:4096
    v_mfma_f32_16x16x32_bf16 v[88:91], v[216:219], v[152:155], v[88:91]
    s_add_u32 s6, s49, 131072
    buffer_load_dwordx4 v[132:135], v246, s[24:27], s6 offen sc1
    v_add_u32 v230, s55, v238
    s_waitcnt lgkmcnt(12)
    v_mfma_f32_16x16x32_bf16 v[28:31], v[220:223], v[144:147], v[28:31]
    ds_read_b64_tr_b16 v[216:217], v230
    v_mfma_f32_16x16x32_bf16 v[60:63], v[220:223], v[148:151], v[60:63]
    ds_read_b64_tr_b16 v[218:219], v230 offset:4096
    v_mfma_f32_16x16x32_bf16 v[92:95], v[220:223], v[152:155], v[92:95]
    s_add_u32 s6, s49, 262144
    buffer_load_dwordx4 v[136:139], v246, s[24:27], s6 offen sc1
    v_add_u32 v231, s55, v239
    s_waitcnt vmcnt(8) lgkmcnt(12)
    v_mfma_f32_16x16x32_bf16 v[0:3], v[192:195], v[160:163], v[0:3]
    ds_read_b64_tr_b16 v[220:221], v231
    s_waitcnt vmcnt(7)
    v_mfma_f32_16x16x32_bf16 v[32:35], v[192:195], v[164:167], v[32:35]
    ds_read_b64_tr_b16 v[222:223], v231 offset:4096
    s_waitcnt vmcnt(6)
    v_mfma_f32_16x16x32_bf16 v[64:67], v[192:195], v[168:171], v[64:67]
    s_add_u32 s51, s63, s66
    s_bfe_u32 s49, s51, 0x20002
    s_waitcnt lgkmcnt(12)
    v_mfma_f32_16x16x32_bf16 v[4:7], v[196:199], v[160:163], v[4:7]
    ds_read_b64_tr_b16 v[192:193], v224 offset:8192
    v_mfma_f32_16x16x32_bf16 v[36:39], v[196:199], v[164:167], v[36:39]
    ds_read_b64_tr_b16 v[194:195], v224 offset:12288
    v_mfma_f32_16x16x32_bf16 v[68:71], v[196:199], v[168:171], v[68:71]
    s_lshl_b32 s49, s49, 3
    s_and_b32 s51, s51, 3
    s_waitcnt lgkmcnt(12)
    v_mfma_f32_16x16x32_bf16 v[8:11], v[200:203], v[160:163], v[8:11]
    ds_read_b64_tr_b16 v[196:197], v225 offset:8192
    v_mfma_f32_16x16x32_bf16 v[40:43], v[200:203], v[164:167], v[40:43]
    ds_read_b64_tr_b16 v[198:199], v225 offset:12288
    v_mfma_f32_16x16x32_bf16 v[72:75], v[200:203], v[168:171], v[72:75]
    s_add_u32 s49, s49, s51
    s_lshr_b32 s51, s63, 4
    s_waitcnt lgkmcnt(12)
    v_mfma_f32_16x16x32_bf16 v[12:15], v[204:207], v[160:163], v[12:15]
    ds_read_b64_tr_b16 v[200:201], v226 offset:8192
    v_mfma_f32_16x16x32_bf16 v[44:47], v[204:207], v[164:167], v[44:47]
    ds_read_b64_tr_b16 v[202:203], v226 offset:12288
    v_mfma_f32_16x16x32_bf16 v[76:79], v[204:207], v[168:171], v[76:79]
    s_lshl2_add_u32 s49, s51, s49
    s_add_u32 s63, s63, 1
    s_waitcnt lgkmcnt(12)
    v_mfma_f32_16x16x32_bf16 v[16:19], v[208:211], v[160:163], v[16:19]
    ds_read_b64_tr_b16 v[204:205], v227 offset:8192
    v_mfma_f32_16x16x32_bf16 v[48:51], v[208:211], v[164:167], v[48:51]
    ds_read_b64_tr_b16 v[206:207], v227 offset:12288
    v_mfma_f32_16x16x32_bf16 v[80:83], v[208:211], v[168:171], v[80:83]
    s_lshl_b32 s49, s49, 10
    s_add_u32 s49, s49, s60
    s_waitcnt lgkmcnt(12)
    v_mfma_f32_16x16x32_bf16 v[20:23], v[212:215], v[160:163], v[20:23]
    ds_read_b64_tr_b16 v[208:209], v228 offset:8192
    v_mfma_f32_16x16x32_bf16 v[52:55], v[212:215], v[164:167], v[52:55]
    ds_read_b64_tr_b16 v[210:211], v228 offset:12288
    v_mfma_f32_16x16x32_bf16 v[84:87], v[212:215], v[168:171], v[84:87]
    s_add_u32 s6, s49, 0
    buffer_load_dwordx4 v[144:147], v246, s[24:27], s6 offen sc1
    s_waitcnt lgkmcnt(12)
    v_mfma_f32_16x16x32_bf16 v[24:27], v[216:219], v[160:163], v[24:27]
    ds_read_b64_tr_b16 v[212:213], v229 offset:8192
    v_mfma_f32_16x16x32_bf16 v[56:59], v[216:219], v[164:167], v[56:59]
    ds_read_b64_tr_b16 v[214:215], v229 offset:12288
    v_mfma_f32_16x16x32_bf16 v[88:91], v[216:219], v[168:171], v[88:91]
    s_add_u32 s6, s49, 131072
    buffer_load_dwordx4 v[148:151], v246, s[24:27], s6 offen sc1
    s_waitcnt lgkmcnt(12)
    v_mfma_f32_16x16x32_bf16 v[28:31], v[220:223], v[160:163], v[28:31]
    ds_read_b64_tr_b16 v[216:217], v230 offset:8192
    v_mfma_f32_16x16x32_bf16 v[60:63], v[220:223], v[164:167], v[60:63]
    ds_read_b64_tr_b16 v[218:219], v230 offset:12288
    v_mfma_f32_16x16x32_bf16 v[92:95], v[220:223], v[168:171], v[92:95]
    s_add_u32 s6, s49, 262144
    buffer_load_dwordx4 v[152:155], v246, s[24:27], s6 offen sc1
    s_and_b32 s55, s58, 15
    s_lshl_b32 s55, s55, 14
    s_lshr_b64 s[58:59], s[58:59], 4
    s_waitcnt vmcnt(8) lgkmcnt(12)
    v_mfma_f32_16x16x32_bf16 v[0:3], v[192:195], v[176:179], v[0:3]
    ds_read_b64_tr_b16 v[220:221], v231 offset:8192
    s_waitcnt vmcnt(7)
    v_mfma_f32_16x16x32_bf16 v[32:35], v[192:195], v[180:183], v[32:35]
    ds_read_b64_tr_b16 v[222:223], v231 offset:12288
    s_waitcnt vmcnt(6)
    v_mfma_f32_16x16x32_bf16 v[64:67], v[192:195], v[184:187], v[64:67]
    s_add_u32 s51, s63, s66
    s_bfe_u32 s49, s51, 0x20002
    v_add_u32 v224, s55, v232
    s_waitcnt lgkmcnt(12)
    v_mfma_f32_16x16x32_bf16 v[4:7], v[196:199], v[176:179], v[4:7]
    ds_read_b64_tr_b16 v[192:193], v224
    v_mfma_f32_16x16x32_bf16 v[36:39], v[196:199], v[180:183], v[36:39]
    ds_read_b64_tr_b16 v[194:195], v224 offset:4096
    v_mfma_f32_16x16x32_bf16 v[68:71], v[196:199], v[184:187], v[68:71]
    s_lshl_b32 s49, s49, 3
    s_and_b32 s51, s51, 3
    v_add_u32 v225, s55, v233
    s_waitcnt lgkmcnt(12)
    v_mfma_f32_16x16x32_bf16 v[8:11], v[200:203], v[176:179], v[8:11]
    ds_read_b64_tr_b16 v[196:197], v225
    v_mfma_f32_16x16x32_bf16 v[40:43], v[200:203], v[180:183], v[40:43]
    ds_read_b64_tr_b16 v[198:199], v225 offset:4096
    v_mfma_f32_16x16x32_bf16 v[72:75], v[200:203], v[184:187], v[72:75]
    s_add_u32 s49, s49, s51
    s_lshr_b32 s51, s63, 4
    v_add_u32 v226, s55, v234
    s_waitcnt lgkmcnt(12)
    v_mfma_f32_16x16x32_bf16 v[12:15], v[204:207], v[176:179], v[12:15]
    ds_read_b64_tr_b16 v[200:201], v226
    v_mfma_f32_16x16x32_bf16 v[44:47], v[204:207], v[180:183], v[44:47]
    ds_read_b64_tr_b16 v[202:203], v226 offset:4096
    v_mfma_f32_16x16x32_bf16 v[76:79], v[204:207], v[184:187], v[76:79]
    s_lshl2_add_u32 s49, s51, s49
    s_add_u32 s63, s63, 1
    v_add_u32 v227, s55, v235
    s_waitcnt lgkmcnt(12)
    v_mfma_f32_16x16x32_bf16 v[16:19], v[208:211], v[176:179], v[16:19]
    ds_read_b64_tr_b16 v[204:205], v227
    v_mfma_f32_16x16x32_bf16 v[48:51], v[208:211], v[180:183], v[48:51]
    ds_read_b64_tr_b16 v[206:207], v227 offset:4096
    v_mfma_f32_16x16x32_bf16 v[80:83], v[208:211], v[184:187], v[80:83]
    s_lshl_b32 s49, s49, 10
    s_add_u32 s49, s49, s60
    v_add_u32 v228, s55, v236
    s_waitcnt lgkmcnt(12)
    v_mfma_f32_16x16x32_bf16 v[20:23], v[212:215], v[176:179], v[20:23]
    ds_read_b64_tr_b16 v[208:209], v228
    v_mfma_f32_16x16x32_bf16 v[52:55], v[212:215], v[180:183], v[52:55]
    ds_read_b64_tr_b16 v[210:211], v228 offset:4096
    v_mfma_f32_16x16x32_bf16 v[84:87], v[212:215], v[184:187], v[84:87]
    s_add_u32 s6, s49, 0
    buffer_load_dwordx4 v[160:163], v246, s[24:27], s6 offen sc1
    v_add_u32 v229, s55, v237
    s_waitcnt lgkmcnt(12)
    v_mfma_f32_16x16x32_bf16 v[24:27], v[216:219], v[176:179], v[24:27]
    ds_read_b64_tr_b16 v[212:213], v229
    v_mfma_f32_16x16x32_bf16 v[56:59], v[216:219], v[180:183], v[56:59]
    ds_read_b64_tr_b16 v[214:215], v229 offset:4096
    v_mfma_f32_16x16x32_bf16 v[88:91], v[216:219], v[184:187], v[88:91]
    s_add_u32 s6, s49, 131072
    buffer_load_dwordx4 v[164:167], v246, s[24:27], s6 offen sc1
    v_add_u32 v230, s55, v238
    s_waitcnt lgkmcnt(12)
    v_mfma_f32_16x16x32_bf16 v[28:31], v[220:223], v[176:179], v[28:31]
    ds_read_b64_tr_b16 v[216:217], v230
    v_mfma_f32_16x16x32_bf16 v[60:63], v[220:223], v[180:183], v[60:63]
    ds_read_b64_tr_b16 v[218:219], v230 offset:4096
    v_mfma_f32_16x16x32_bf16 v[92:95], v[220:223], v[184:187], v[92:95]
    s_add_u32 s6, s49, 262144
    buffer_load_dwordx4 v[168:171], v246, s[24:27], s6 offen sc1
    v_add_u32 v231, s55, v239
    ds_read_b64_tr_b16 v[220:221], v231
    ds_read_b64_tr_b16 v[222:223], v231 offset:4096
    s_add_u32 s50, s50, 1
    s_cmp_lt_u32 s50, 4
    s_cbranch_scc1 L_tx
L_ty:
    s_barrier
    s_cmp_lg_u32 s50, 7
    s_cbranch_scc1 L_t
L_tn:
    s_waitcnt vmcnt(8) lgkmcnt(14)
    v_mfma_f32_16x16x32_bf16 v[0:3], v[192:195], v[128:131], v[0:3]
    s_add_u32 s51, s63, s66
    s_bfe_u32 s49, s51, 0x20002
    s_waitcnt vmcnt(7)
    v_mfma_f32_16x16x32_bf16 v[32:35], v[192:195], v[132:135], v[32:35]
    s_lshl_b32 s49, s49, 3
    s_and_b32 s51, s51, 3
    s_waitcnt vmcnt(6)
    v_mfma_f32_16x16x32_bf16 v[64:67], v[192:195], v[136:139], v[64:67]
    s_add_u32 s49, s49, s51
    s_lshr_b32 s51, s63, 4
    s_waitcnt lgkmcnt(12)
    v_mfma_f32_16x16x32_bf16 v[4:7], v[196:199], v[128:131], v[4:7]
    ds_read_b64_tr_b16 v[192:193], v224 offset:8192
    v_mfma_f32_16x16x32_bf16 v[36:39], v[196:199], v[132:135], v[36:39]
    ds_read_b64_tr_b16 v[194:195], v224 offset:12288
    v_mfma_f32_16x16x32_bf16 v[68:71], v[196:199], v[136:139], v[68:71]
    s_lshl2_add_u32 s49, s51, s49
    s_add_u32 s63, s63, 1
    s_waitcnt lgkmcnt(12)
    v_mfma_f32_16x16x32_bf16 v[8:11], v[200:203], v[128:131], v[8:11]
    ds_read_b64_tr_b16 v[196:197], v225 offset:8192
    v_mfma_f32_16x16x32_bf16 v[40:43], v[200:203], v[132:135], v[40:43]
    ds_read_b64_tr_b16 v[198:199], v225 offset:12288
    v_mfma_f32_16x16x32_bf16 v[72:75], v[200:203], v[136:139], v[72:75]
    s_lshl_b32 s49, s49, 10
    s_add_u32 s49, s49, s60
    s_waitcnt lgkmcnt(12)
    v_mfma_f32_16x16x32_bf16 v[12:15], v[204:207], v[128:131], v[12:15]
    ds_read_b64_tr_b16 v[200:201], v226 offset:8192
    v_mfma_f32_16x16x32_bf16 v[44:47], v[204:207], v[132:135], v[44:47]
    ds_read_b64_tr_b16 v[202:203], v226 offset:12288
    v_mfma_f32_16x16x32_bf16 v[76:79], v[204:207], v[136:139], v[76:79]
    s_add_u32 s6, s49, 0
    buffer_load_dwordx4 v[176:179], v246, s[24:27], s6 offen sc1
    s_waitcnt lgkmcnt(12)
    v_mfma_f32_16x16x32_bf16 v[16:19], v[208:211], v[128:131], v[16:19]
    ds_read_b64_tr_b16 v[204:205], v227 offset:8192
    v_mfma_f32_16x16x32_bf16 v[48:51], v[208:211], v[132:135], v[48:51]
    ds_read_b64_tr_b16 v[206:207], v227 offset:12288
    v_mfma_f32_16x16x32_bf16 v[80:83], v[208:211], v[136:139], v[80:83]
    s_add_u32 s6, s49, 131072
    buffer_load_dwordx4 v[180:183], v246, s[24:27], s6 offen sc1
    s_waitcnt lgkmcnt(12)
    v_mfma_f32_16x16x32_bf16 v[20:23], v[212:215], v[128:131], v[20:23]
    ds_read_b64_tr_b16 v[208:209], v228 offset:8192
    v_mfma_f32_16x16x32_bf16 v[52:55], v[212:215], v[132:135], v[52:55]
    ds_read_b64_tr_b16 v[210:211], v228 offset:12288
    v_mfma_f32_16x16x32_bf16 v[84:87], v[212:215], v[136:139], v[84:87]
    s_add_u32 s6, s49, 262144
    buffer_load_dwordx4 v[184:187], v246, s[24:27], s6 offen sc1
    s_waitcnt lgkmcnt(12)
    v_mfma_f32_16x16x32_bf16 v[24:27], v[216:219], v[128:131], v[24:27]
    ds_read_b64_tr_b16 v[212:213], v229 offset:8192
    v_mfma_f32_16x16x32_bf16 v[56:59], v[216:219], v[132:135], v[56:59]
    ds_read_b64_tr_b16 v[214:215], v229 offset:12288
    v_mfma_f32_16x16x32_bf16 v[88:91], v[216:219], v[136:139], v[88:91]
    s_waitcnt lgkmcnt(12)
    v_mfma_f32_16x16x32_bf16 v[28:31], v[220:223], v[128:131], v[28:31]
    ds_read_b64_tr_b16 v[216:217], v230 offset:8192
    v_mfma_f32_16x16x32_bf16 v[60:63], v[220:223], v[132:135], v[60:63]
    ds_read_b64_tr_b16 v[218:219], v230 offset:12288
    v_mfma_f32_16x16x32_bf16 v[92:95], v[220:223], v[136:139], v[92:95]
    s_and_b32 s55, s58, 15
    s_lshl_b32 s55, s55, 14
    s_lshr_b64 s[58:59], s[58:59], 4
    s_waitcnt vmcnt(8) lgkmcnt(12)
    v_mfma_f32_16x16x32_bf16 v[0:3], v[192:195], v[144:147], v[0:3]
    ds_read_b64_tr_b16 v[220:221], v231 offset:8192
    s_waitcnt vmcnt(7)
    v_mfma_f32_16x16x32_bf16 v[32:35], v[192:195], v[148:151], v[32:35]
    ds_read_b64_tr_b16 v[222:223], v231 offset:12288
    s_waitcnt vmcnt(6)
    v_mfma_f32_16x16x32_bf16 v[64:67], v[192:195], v[152:155], v[64:67]
    v_add_u32 v224, s55, v232
    s_waitcnt lgkmcnt(12)
    v_mfma_f32_16x16x32_bf16 v[4:7], v[196:199], v[144:147], v[4:7]
    ds_read_b64_tr_b16 v[192:193], v224
    v_mfma_f32_16x16x32_bf16 v[36:39], v[196:199], v[148:151], v[36:39]
    ds_read_b64_tr_b16 v[194:195], v224 offset:4096
    v_mfma_f32_16x16x32_bf16 v[68:71], v[196:199], v[152:155], v[68:71]
    v_add_u32 v225, s55, v233
    s_waitcnt lgkmcnt(12)
    v_mfma_f32_16x16x32_bf16 v[8:11], v[200:203], v[144:147], v[8:11]
    ds_read_b64_tr_b16 v[196:197], v225
    v_mfma_f32_16x16x32_bf16 v[40:43], v[200:203], v[148:151], v[40:43]
    ds_read_b64_tr_b16 v[198:199], v225 offset:4096
    v_mfma_f32_16x16x32_bf16 v[72:75], v[200:203], v[152:155], v[72:75]
    v_add_u32 v226, s55, v234
    s_waitcnt lgkmcnt(12)
    v_mfma_f32_16x16x32_bf16 v[12:15], v[204:207], v[144:147], v[12:15]
    ds_read_b64_tr_b16 v[200:201], v226
    v_mfma_f32_16x16x32_bf16 v[44:47], v[204:207], v[148:151], v[44:47]
    ds_read_b64_tr_b16 v[202:203], v226 offset:4096
    v_mfma_f32_16x16x32_bf16 v[76:79], v[204:207], v[152:155], v[76:79]
    v_add_u32 v227, s55, v235
    s_waitcnt lgkmcnt(12)
    v_mfma_f32_16x16x32_bf16 v[16:19], v[208:211], v[144:147], v[16:19]
    ds_read_b64_tr_b16 v[204:205], v227
    v_mfma_f32_16x16x32_bf16 v[48:51], v[208:211], v[148:151], v[48:51]
    ds_read_b64_tr_b16 v[206:207], v227 offset:4096
    v_mfma_f32_16x16x32_bf16 v[80:83], v[208:211], v[152:155], v[80:83]
    v_add_u32 v228, s55, v236
    s_waitcnt lgkmcnt(12)
    v_mfma_f32_16x16x32_bf16 v[20:23], v[212:215], v[144:147], v[20:23]
    ds_read_b64_tr_b16 v[208:209], v228
    v_mfma_f32_16x16x32_bf16 v[52:55], v[212:215], v[148:151], v[52:55]
    ds_read_b64_tr_b16 v[210:211], v228 offset:4096
    v_mfma_f32_16x16x32_bf16 v[84:87], v[212:215], v[152:155], v[84:87]
    v_add_u32 v229, s55, v237
    s_waitcnt lgkmcnt(12)
    v_mfma_f32_16x16x32_bf16 v[24:27], v[216:219], v[144:147], v[24:27]
    ds_read_b64_tr_b16 v[212:213], v229
    v_mfma_f32_16x16x32_bf16 v[56:59], v[216:219], v[148:151], v[56:59]
    ds_read_b64_tr_b16 v[214:215], v229 offset:4096
    v_mfma_f32_16x16x32_bf16 v[88:91], v[216:219], v[152:155], v[88:91]
    v_add_u32 v230, s55, v238
    s_waitcnt lgkmcnt(12)
    v_mfma_f32_16x16x32_bf16 v[28:31], v[220:223], v[144:147], v[28:31]
    ds_read_b64_tr_b16 v[216:217], v230
    v_mfma_f32_16x16x32_bf16 v[60:63], v[220:223], v[148:151], v[60:63]
    ds_read_b64_tr_b16 v[218:219], v230 offset:4096
    v_mfma_f32_16x16x32_bf16 v[92:95], v[220:223], v[152:155], v[92:95]
    v_add_u32 v231, s55, v239
    s_waitcnt vmcnt(5) lgkmcnt(12)
    v_mfma_f32_16x16x32_bf16 v[0:3], v[192:195], v[160:163], v[0:3]
    ds_read_b64_tr_b16 v[220:221], v231
    s_waitcnt vmcnt(4)
    v_mfma_f32_16x16x32_bf16 v[32:35], v[192:195], v[164:167], v[32:35]
    ds_read_b64_tr_b16 v[222:223], v231 offset:4096
    s_waitcnt vmcnt(3)
    v_mfma_f32_16x16x32_bf16 v[64:67], v[192:195], v[168:171], v[64:67]
    s_waitcnt lgkmcnt(12)
    v_mfma_f32_16x16x32_bf16 v[4:7], v[196:199], v[160:163], v[4:7]
    ds_read_b64_tr_b16 v[192:193], v224 offset:8192
    v_mfma_f32_16x16x32_bf16 v[36:39], v[196:199], v[164:167], v[36:39]
    ds_read_b64_tr_b16 v[194:195], v224 offset:12288
    v_mfma_f32_16x16x32_bf16 v[68:71], v[196:199], v[168:171], v[68:71]
    s_waitcnt lgkmcnt(12)
    v_mfma_f32_16x16x32_bf16 v[8:11], v[200:203], v[160:163], v[8:11]
    ds_read_b64_tr_b16 v[196:197], v225 offset:8192
    v_mfma_f32_16x16x32_bf16 v[40:43], v[200:203], v[164:167], v[40:43]
    ds_read_b64_tr_b16 v[198:199], v225 offset:12288
    v_mfma_f32_16x16x32_bf16 v[72:75], v[200:203], v[168:171], v[72:75]
    s_waitcnt lgkmcnt(12)
    v_mfma_f32_16x16x32_bf16 v[12:15], v[204:207], v[160:163], v[12:15]
    ds_read_b64_tr_b16 v[200:201], v226 offset:8192
    v_mfma_f32_16x16x32_bf16 v[44:47], v[204:207], v[164:167], v[44:47]
    ds_read_b64_tr_b16 v[202:203], v226 offset:12288
    v_mfma_f32_16x16x32_bf16 v[76:79], v[204:207], v[168:171], v[76:79]
    s_waitcnt lgkmcnt(12)
    v_mfma_f32_16x16x32_bf16 v[16:19], v[208:211], v[160:163], v[16:19]
    ds_read_b64_tr_b16 v[204:205], v227 offset:8192
    v_mfma_f32_16x16x32_bf16 v[48:51], v[208:211], v[164:167], v[48:51]
    ds_read_b64_tr_b16 v[206:207], v227 offset:12288
    v_mfma_f32_16x16x32_bf16 v[80:83], v[208:211], v[168:171], v[80:83]
    s_waitcnt lgkmcnt(12)
    v_mfma_f32_16x16x32_bf16 v[20:23], v[212:215], v[160:163], v[20:23]
    ds_read_b64_tr_b16 v[208:209], v228 offset:8192
    v_mfma_f32_16x16x32_bf16 v[52:55], v[212:215], v[164:167], v[52:55]
    ds_read_b64_tr_b16 v[210:211], v228 offset:12288
    v_mfma_f32_16x16x32_bf16 v[84:87], v[212:215], v[168:171], v[84:87]
    s_waitcnt lgkmcnt(12)
    v_mfma_f32_16x16x32_bf16 v[24:27], v[216:219], v[160:163], v[24:27]
    ds_read_b64_tr_b16 v[212:213], v229 offset:8192
    v_mfma_f32_16x16x32_bf16 v[56:59], v[216:219], v[164:167], v[56:59]
    ds_read_b64_tr_b16 v[214:215], v229 offset:12288
    v_mfma_f32_16x16x32_bf16 v[88:91], v[216:219], v[168:171], v[88:91]
    s_waitcnt lgkmcnt(12)
    v_mfma_f32_16x16x32_bf16 v[28:31], v[220:223], v[160:163], v[28:31]
    ds_read_b64_tr_b16 v[216:217], v230 offset:8192
    v_mfma_f32_16x16x32_bf16 v[60:63], v[220:223], v[164:167], v[60:63]
    ds_read_b64_tr_b16 v[218:219], v230 offset:12288
    v_mfma_f32_16x16x32_bf16 v[92:95], v[220:223], v[168:171], v[92:95]
    s_and_b32 s55, s58, 15
    s_lshl_b32 s55, s55, 14
    s_lshr_b64 s[58:59], s[58:59], 4
    s_waitcnt vmcnt(2) lgkmcnt(12)
    v_mfma_f32_16x16x32_bf16 v[0:3], v[192:195], v[176:179], v[0:3]
    ds_read_b64_tr_b16 v[220:221], v231 offset:8192
    s_waitcnt vmcnt(1)
    v_mfma_f32_16x16x32_bf16 v[32:35], v[192:195], v[180:183], v[32:35]
    ds_read_b64_tr_b16 v[222:223], v231 offset:12288
    s_waitcnt vmcnt(0)
    v_mfma_f32_16x16x32_bf16 v[64:67], v[192:195], v[184:187], v[64:67]
    v_add_u32 v224, s55, v232
    s_waitcnt lgkmcnt(12)
    v_mfma_f32_16x16x32_bf16 v[4:7], v[196:199], v[176:179], v[4:7]
    ds_read_b64_tr_b16 v[192:193], v224
    v_mfma_f32_16x16x32_bf16 v[36:39], v[196:199], v[180:183], v[36:39]
    ds_read_b64_tr_b16 v[194:195], v224 offset:4096
    v_mfma_f32_16x16x32_bf16 v[68:71], v[196:199], v[184:187], v[68:71]
    v_add_u32 v225, s55, v233
    s_waitcnt lgkmcnt(12)
    v_mfma_f32_16x16x32_bf16 v[8:11], v[200:203], v[176:179], v[8:11]
    ds_read_b64_tr_b16 v[196:197], v225
    v_mfma_f32_16x16x32_bf16 v[40:43], v[200:203], v[180:183], v[40:43]
    ds_read_b64_tr_b16 v[198:199], v225 offset:4096
    v_mfma_f32_16x16x32_bf16 v[72:75], v[200:203], v[184:187], v[72:75]
    v_add_u32 v226, s55, v234
    s_waitcnt lgkmcnt(12)
    v_mfma_f32_16x16x32_bf16 v[12:15], v[204:207], v[176:179], v[12:15]
    ds_read_b64_tr_b16 v[200:201], v226
    v_mfma_f32_16x16x32_bf16 v[44:47], v[204:207], v[180:183], v[44:47]
    ds_read_b64_tr_b16 v[202:203], v226 offset:4096
    v_mfma_f32_16x16x32_bf16 v[76:79], v[204:207], v[184:187], v[76:79]
    v_add_u32 v227, s55, v235
    s_waitcnt lgkmcnt(12)
    v_mfma_f32_16x16x32_bf16 v[16:19], v[208:211], v[176:179], v[16:19]
    ds_read_b64_tr_b16 v[204:205], v227
    v_mfma_f32_16x16x32_bf16 v[48:51], v[208:211], v[180:183], v[48:51]
    ds_read_b64_tr_b16 v[206:207], v227 offset:4096
    v_mfma_f32_16x16x32_bf16 v[80:83], v[208:211], v[184:187], v[80:83]
    v_add_u32 v228, s55, v236
    s_waitcnt lgkmcnt(12)
    v_mfma_f32_16x16x32_bf16 v[20:23], v[212:215], v[176:179], v[20:23]
    ds_read_b64_tr_b16 v[208:209], v228
    v_mfma_f32_16x16x32_bf16 v[52:55], v[212:215], v[180:183], v[52:55]
    ds_read_b64_tr_b16 v[210:211], v228 offset:4096
    v_mfma_f32_16x16x32_bf16 v[84:87], v[212:215], v[184:187], v[84:87]
    v_add_u32 v229, s55, v237
    s_waitcnt lgkmcnt(12)
    v_mfma_f32_16x16x32_bf16 v[24:27], v[216:219], v[176:179], v[24:27]
    ds_read_b64_tr_b16 v[212:213], v229
    v_mfma_f32_16x16x32_bf16 v[56:59], v[216:219], v[180:183], v[56:59]
    ds_read_b64_tr_b16 v[214:215], v229 offset:4096
    v_mfma_f32_16x16x32_bf16 v[88:91], v[216:219], v[184:187], v[88:91]
    v_add_u32 v230, s55, v238
    s_waitcnt lgkmcnt(12)
    v_mfma_f32_16x16x32_bf16 v[28:31], v[220:223], v[176:179], v[28:31]
    ds_read_b64_tr_b16 v[216:217], v230
    v_mfma_f32_16x16x32_bf16 v[60:63], v[220:223], v[180:183], v[60:63]
    ds_read_b64_tr_b16 v[218:219], v230 offset:4096
    v_mfma_f32_16x16x32_bf16 v[92:95], v[220:223], v[184:187], v[92:95]
    v_add_u32 v231, s55, v239
    ds_read_b64_tr_b16 v[220:221], v231
    ds_read_b64_tr_b16 v[222:223], v231 offset:4096
    s_add_u32 s50, s50, 1
    s_cmp_eq_u32 s50, 8
    s_cbranch_scc1 L_xch
    s_mov_b32 s53, 0
L_sp_o2:
    s_add_u32 s53, s53, 1
    s_cmp_gt_u32 s53, 400000
    s_cbranch_scc1 L_spx_o2
    buffer_load_dword v250, v249, s[24:27], s54 offen sc1
    s_waitcnt vmcnt(0)
    v_cmp_ne_u32 vcc, s62, v250
    s_nop 0
    s_cmp_eq_u64 vcc, 0
    s_cbranch_scc0 L_sp_o2
L_spx_o2:
    s_add_u32 s51, s63, s66
    s_bfe_u32 s49, s51, 0x20002
    s_lshl_b32 s49, s49, 3
    s_and_b32 s51, s51, 3
    s_add_u32 s49, s49, s51
    s_lshr_b32 s51, s63, 4
    s_lshl2_add_u32 s49, s51, s49
    s_add_u32 s63, s63, 1
    s_lshl_b32 s49, s49, 10
    s_add_u32 s49, s49, s60
    s_add_u32 s6, s49, 0
    buffer_load_dwordx4 v[128:131], v246, s[24:27], s6 offen sc1
    s_add_u32 s6, s49, 131072
    buffer_load_dwordx4 v[132:135], v246, s[24:27], s6 offen sc1
    s_add_u32 s6, s49, 262144
    buffer_load_dwordx4 v[136:139], v246, s[24:27], s6 offen sc1
    s_add_u32 s51, s63, s66
    s_bfe_u32 s49, s51, 0x20002
    s_lshl_b32 s49, s49, 3
    s_and_b32 s51, s51, 3
    s_add_u32 s49, s49, s51
    s_lshr_b32 s51, s63, 4
    s_lshl2_add_u32 s49, s51, s49
    s_add_u32 s63, s63, 1
    s_lshl_b32 s49, s49, 10
    s_add_u32 s49, s49, s60
    s_add_u32 s6, s49, 0
    buffer_load_dwordx4 v[144:147], v246, s[24:27], s6 offen sc1
    s_add_u32 s6, s49, 131072
    buffer_load_dwordx4 v[148:151], v246, s[24:27], s6 offen sc1
    s_add_u32 s6, s49, 262144
    buffer_load_dwordx4 v[152:155], v246, s[24:27], s6 offen sc1
    s_add_u32 s51, s63, s66
    s_bfe_u32 s49, s51, 0x20002
    s_lshl_b32 s49, s49, 3
    s_and_b32 s51, s51, 3
    s_add_u32 s49, s49, s51
    s_lshr_b32 s51, s63, 4
    s_lshl2_add_u32 s49, s51, s49
    s_add_u32 s63, s63, 1
    s_lshl_b32 s49, s49, 10
    s_add_u32 s49, s49, s60
    s_add_u32 s6, s49, 0
    buffer_load_dwordx4 v[160:163], v246, s[24:27], s6 offen sc1
    s_add_u32 s6, s49, 131072
    buffer_load_dwordx4 v[164:167], v246, s[24:27], s6 offen sc1
    s_add_u32 s6, s49, 262144
    buffer_load_dwordx4 v[168:171], v246, s[24:27], s6 offen sc1
    s_branch L_ty
L_tx:
    s_cmp_eq_u32 s50, 3
    s_cbranch_scc1 L_tz
    buffer_load_dword v250, v249, s[24:27], s54 offen sc1
    s_cmp_eq_u32 s50, 2
    s_cbranch_scc1 L_ty
    s_branch L_t
L_tz:
    v_cmp_ne_u32 vcc, s62, v250
    s_nop 0
    s_cmp_eq_u64 vcc, 0
    s_cbranch_scc1 L_ty
    s_barrier
    s_branch L_tn
L_xch:
    s_nop 7
    s_and_b32 s4, s2, 3
    s_lshl_b32 s6, s4, 14
    s_add_u32 s48, s72, s6
    s_waitcnt lgkmcnt(0)
    s_cmp_eq_u32 s4, 0
    s_cbranch_scc1 L_xs0
    s_add_u32 s6, s48, 0
    v_cvt_pk_bf16_f32 v128, v0, v1
    v_cvt_pk_bf16_f32 v129, v2, v3
    v_cvt_pk_bf16_f32 v130, v4, v5
    v_cvt_pk_bf16_f32 v131, v6, v7
    buffer_store_dwordx4 v[128:131], v246, s[24:27], s6 offen sc0 sc1
    v_cvt_pk_bf16_f32 v132, v32, v33
    v_cvt_pk_bf16_f32 v133, v34, v35
    v_cvt_pk_bf16_f32 v134, v36, v37
    v_cvt_pk_bf16_f32 v135, v38, v39
    buffer_store_dwordx4 v[132:135], v246, s[24:27], s6 offen offset:1024 sc0 sc1
    v_cvt_pk_bf16_f32 v136, v64, v65
    v_cvt_pk_bf16_f32 v137, v66, v67
    v_cvt_pk_bf16_f32 v138, v68, v69
    v_cvt_pk_bf16_f32 v139, v70, v71
    buffer_store_dwordx4 v[136:139], v246, s[24:27], s6 offen offset:2048 sc0 sc1
L_xe0:
    s_cmp_eq_u32 s4, 1
    s_cbranch_scc1 L_xs1
    s_add_u32 s6, s48, 65536
    v_cvt_pk_bf16_f32 v144, v8, v9
    v_cvt_pk_bf16_f32 v145, v10, v11
    v_cvt_pk_bf16_f32 v146, v12, v13
    v_cvt_pk_bf16_f32 v147, v14, v15
    buffer_store_dwordx4 v[144:147], v246, s[24:27], s6 offen sc0 sc1
    v_cvt_pk_bf16_f32 v148, v40, v41
    v_cvt_pk_bf16_f32 v149, v42, v43
    v_cvt_pk_bf16_f32 v150, v44, v45
    v_cvt_pk_bf16_f32 v151, v46, v47
    buffer_store_dwordx4 v[148:151], v246, s[24:27], s6 offen offset:1024 sc0 sc1
    v_cvt_pk_bf16_f32 v152, v72, v73
    v_cvt_pk_bf16_f32 v153, v74, v75
    v_cvt_pk_bf16_f32 v154, v76, v77
    v_cvt_pk_bf16_f32 v155, v78, v79
    buffer_store_dwordx4 v[152:155], v246, s[24:27], s6 offen offset:2048 sc0 sc1
L_xe1:
    s_cmp_eq_u32 s4, 2
    s_cbranch_scc1 L_xs2
    s_add_u32 s6, s48, 131072
    v_cvt_pk_bf16_f32 v160, v16, v17
    v_cvt_pk_bf16_f32 v161, v18, v19
    v_cvt_pk_bf16_f32 v162, v20, v21
    v_cvt_pk_bf16_f32 v163, v22, v23
    buffer_store_dwordx4 v[160:163], v246, s[24:27], s6 offen sc0 sc1
    v_cvt_pk_bf16_f32 v164, v48, v49
    v_cvt_pk_bf16_f32 v165, v50, v51
    v_cvt_pk_bf16_f32 v166, v52, v53
    v_cvt_pk_bf16_f32 v167, v54, v55
    buffer_store_dwordx4 v[164:167], v246, s[24:27], s6 offen offset:1024 sc0 sc1
    v_cvt_pk_bf16_f32 v168, v80, v81
    v_cvt_pk_bf16_f32 v169, v82, v83
    v_cvt_pk_bf16_f32 v170, v84, v85
    v_cvt_pk_bf16_f32 v171, v86, v87
    buffer_store_dwordx4 v[168:171], v246, s[24:27], s6 offen offset:2048 sc0 sc1
L_xe2:
    s_cmp_eq_u32 s4, 3
    s_cbranch_scc1 L_xs3
    s_add_u32 s6, s48, 196608
    v_cvt_pk_bf16_f32 v176, v24, v25
    v_cvt_pk_bf16_f32 v177, v26, v27
    v_cvt_pk_bf16_f32 v178, v28, v29
    v_cvt_pk_bf16_f32 v179, v30, v31
    buffer_store_dwordx4 v[176:179], v246, s[24:27], s6 offen sc0 sc1
    v_cvt_pk_bf16_f32 v180, v56, v57
    v_cvt_pk_bf16_f32 v181, v58, v59
    v_cvt_pk_bf16_f32 v182, v60, v61
    v_cvt_pk_bf16_f32 v183, v62, v63
    buffer_store_dwordx4 v[180:183], v246, s[24:27], s6 offen offset:1024 sc0 sc1
    v_cvt_pk_bf16_f32 v184, v88, v89
    v_cvt_pk_bf16_f32 v185, v90, v91
    v_cvt_pk_bf16_f32 v186, v92, v93
    v_cvt_pk_bf16_f32 v187, v94, v95
    buffer_store_dwordx4 v[184:187], v246, s[24:27], s6 offen offset:2048 sc0 sc1
L_xe3:
    v_lshrrev_b32 v234, 4, v246
    v_and_b32 v232, 15, v234
    v_add_u32 v232, s73, v232
    v_mul_u32_u24 v232, 2560, v232
    v_lshrrev_b32 v233, 4, v234
    v_lshl_add_u32 v232, v233, 3, v232
    s_mul_i32 s49, s36, 1280
    s_lshl_b32 s7, s65, 8
    s_add_u32 s49, s49, s7
    s_lshl_b32 s7, s4, 6
    s_add_u32 s49, s49, s7
    s_lshl_b32 s6, s4, 16
    s_add_u32 s48, s72, s6
    s_waitcnt vmcnt(0)
    s_lshl_b32 s6, s4, 7
    v_mov_b32 v249, s6
    v_mov_b32 v250, s62
    s_mov_b64 exec, 1
    buffer_store_dword v250, v249, s[24:27], s69 offen sc0 sc1
    s_mov_b64 exec, -1
    v_lshlrev_b32 v249, 3, v246
    v_and_b32 v249, 384, v249
    s_mov_b32 s53, 0
L_sp_x:
    s_add_u32 s53, s53, 1
    s_cmp_gt_u32 s53, 400000
    s_cbranch_scc1 L_spx_x
    buffer_load_dword v250, v249, s[24:27], s69 offen sc1
    s_waitcnt vmcnt(0)
    v_cmp_ne_u32 vcc, s62, v250
    s_nop 0
    s_cmp_eq_u64 vcc, 0
    s_cbranch_scc0 L_sp_x
L_spx_x:
    s_add_u32 s56, s4, 1
    s_and_b32 s56, s56, 3
    s_lshl_b32 s56, s56, 14
    s_add_u32 s56, s56, s48
    s_add_u32 s57, s4, 2
    s_and_b32 s57, s57, 3
    s_lshl_b32 s57, s57, 14
    s_add_u32 s57, s57, s48
    s_add_u32 s58, s4, 3
    s_and_b32 s58, s58, 3
    s_lshl_b32 s58, s58, 14
    s_add_u32 s58, s58, s48
    buffer_load_dwordx4 v[0:3], v246, s[24:27], s56 offen sc1
    buffer_load_dwordx4 v[4:7], v246, s[24:27], s56 offen offset:1024 sc1
    buffer_load_dwordx4 v[8:11], v246, s[24:27], s56 offen offset:2048 sc1
    buffer_load_dwordx4 v[32:35], v246, s[24:27], s57 offen sc1
    buffer_load_dwordx4 v[36:39], v246, s[24:27], s57 offen offset:1024 sc1
    buffer_load_dwordx4 v[40:43], v246, s[24:27], s57 offen offset:2048 sc1
    buffer_load_dwordx4 v[64:67], v246, s[24:27], s58 offen sc1
    buffer_load_dwordx4 v[68:71], v246, s[24:27], s58 offen offset:1024 sc1
    buffer_load_dwordx4 v[72:75], v246, s[24:27], s58 offen offset:2048 sc1
    s_waitcnt vmcnt(8)
    v_lshlrev_b32 v16, 16, v0
    v_and_b32 v17, 0xffff0000, v0
    v_add_f32 v192, v192, v16
    v_add_f32 v193, v193, v17
    v_lshlrev_b32 v18, 16, v1
    v_and_b32 v19, 0xffff0000, v1
    v_add_f32 v194, v194, v18
    v_add_f32 v195, v195, v19
    v_lshlrev_b32 v20, 16, v2
    v_and_b32 v21, 0xffff0000, v2
    v_add_f32 v196, v196, v20
    v_add_f32 v197, v197, v21
    v_lshlrev_b32 v22, 16, v3
    v_and_b32 v23, 0xffff0000, v3
    v_add_f32 v198, v198, v22
    v_add_f32 v199, v199, v23
    s_waitcnt vmcnt(7)
    v_lshlrev_b32 v24, 16, v4
    v_and_b32 v25, 0xffff0000, v4
    v_add_f32 v200, v200, v24
    v_add_f32 v201, v201, v25
    v_lshlrev_b32 v26, 16, v5
    v_and_b32 v27, 0xffff0000, v5
    v_add_f32 v202, v202, v26
    v_add_f32 v203, v203, v27
    v_lshlrev_b32 v28, 16, v6
    v_and_b32 v29, 0xffff0000, v6
    v_add_f32 v204, v204, v28
    v_add_f32 v205, v205, v29
    v_lshlrev_b32 v30, 16, v7
    v_and_b32 v31, 0xffff0000, v7
    v_add_f32 v206, v206, v30
    v_add_f32 v207, v207, v31
    s_waitcnt vmcnt(6)
    v_lshlrev_b32 v16, 16, v8
    v_and_b32 v17, 0xffff0000, v8
    v_add_f32 v208, v208, v16
    v_add_f32 v209, v209, v17
    v_lshlrev_b32 v18, 16, v9
    v_and_b32 v19, 0xffff0000, v9
    v_add_f32 v210, v210, v18
    v_add_f32 v211, v211, v19
    v_lshlrev_b32 v20, 16, v10
    v_and_b32 v21, 0xffff0000, v10
    v_add_f32 v212, v212, v20
    v_add_f32 v213, v213, v21
    v_lshlrev_b32 v22, 16, v11
    v_and_b32 v23, 0xffff0000, v11
    v_add_f32 v214, v214, v22
    v_add_f32 v215, v215, v23
    s_waitcnt vmcnt(5)
    v_lshlrev_b32 v48, 16, v32
    v_and_b32 v49, 0xffff0000, v32
    v_add_f32 v192, v192, v48
    v_add_f32 v193, v193, v49
    v_lshlrev_b32 v50, 16, v33
    v_and_b32 v51, 0xffff0000, v33
    v_add_f32 v194, v194, v50
    v_add_f32 v195, v195, v51
    v_lshlrev_b32 v52, 16, v34
    v_and_b32 v53, 0xffff0000, v34
    v_add_f32 v196, v196, v52
    v_add_f32 v197, v197, v53
    v_lshlrev_b32 v54, 16, v35
    v_and_b32 v55, 0xffff0000, v35
    v_add_f32 v198, v198, v54
    v_add_f32 v199, v199, v55
    s_waitcnt vmcnt(4)
    v_lshlrev_b32 v56, 16, v36
    v_and_b32 v57, 0xffff0000, v36
    v_add_f32 v200, v200, v56
    v_add_f32 v201, v201, v57
    v_lshlrev_b32 v58, 16, v37
    v_and_b32 v59, 0xffff0000, v37
    v_add_f32 v202, v202, v58
    v_add_f32 v203, v203, v59
    v_lshlrev_b32 v60, 16, v38
    v_and_b32 v61, 0xffff0000, v38
    v_add_f32 v204, v204, v60
    v_add_f32 v205, v205, v61
    v_lshlrev_b32 v62, 16, v39
    v_and_b32 v63, 0xffff0000, v39
    v_add_f32 v206, v206, v62
    v_add_f32 v207, v207, v63
    s_waitcnt vmcnt(3)
    v_lshlrev_b32 v48, 16, v40
    v_and_b32 v49, 0xffff0000, v40
    v_add_f32 v208, v208, v48
    v_add_f32 v209, v209, v49
    v_lshlrev_b32 v50, 16, v41
    v_and_b32 v51, 0xffff0000, v41
    v_add_f32 v210, v210, v50
    v_add_f32 v211, v211, v51
    v_lshlrev_b32 v52, 16, v42
    v_and_b32 v53, 0xffff0000, v42
    v_add_f32 v212, v212, v52
    v_add_f32 v213, v213, v53
    v_lshlrev_b32 v54, 16, v43
    v_and_b32 v55, 0xffff0000, v43
    v_add_f32 v214, v214, v54
    v_add_f32 v215, v215, v55
    s_waitcnt vmcnt(2)
    v_lshlrev_b32 v80, 16, v64
    v_and_b32 v81, 0xffff0000, v64
    v_add_f32 v192, v192, v80
    v_add_f32 v193, v193, v81
    v_lshlrev_b32 v82, 16, v65
    v_and_b32 v83, 0xffff0000, v65
    v_add_f32 v194, v194, v82
    v_add_f32 v195, v195, v83
    v_lshlrev_b32 v84, 16, v66
    v_and_b32 v85, 0xffff0000, v66
    v_add_f32 v196, v196, v84
    v_add_f32 v197, v197, v85
    v_lshlrev_b32 v86, 16, v67
    v_and_b32 v87, 0xffff0000, v67
    v_add_f32 v198, v198, v86
    v_add_f32 v199, v199, v87
    s_waitcnt vmcnt(1)
    v_lshlrev_b32 v88, 16, v68
    v_and_b32 v89, 0xffff0000, v68
    v_add_f32 v200, v200, v88
    v_add_f32 v201, v201, v89
    v_lshlrev_b32 v90, 16, v69
    v_and_b32 v91, 0xffff0000, v69
    v_add_f32 v202, v202, v90
    v_add_f32 v203, v203, v91
    v_lshlrev_b32 v92, 16, v70
    v_and_b32 v93, 0xffff0000, v70
    v_add_f32 v204, v204, v92
    v_add_f32 v205, v205, v93
    v_lshlrev_b32 v94, 16, v71
    v_and_b32 v95, 0xffff0000, v71
    v_add_f32 v206, v206, v94
    v_add_f32 v207, v207, v95
    s_waitcnt vmcnt(0)
    v_lshlrev_b32 v80, 16, v72
    v_and_b32 v81, 0xffff0000, v72
    v_add_f32 v208, v208, v80
    v_add_f32 v209, v209, v81
    v_lshlrev_b32 v82, 16, v73
    v_and_b32 v83, 0xffff0000, v73
    v_add_f32 v210, v210, v82
    v_add_f32 v211, v211, v83
    v_lshlrev_b32 v84, 16, v74
    v_and_b32 v85, 0xffff0000, v74
    v_add_f32 v212, v212, v84
    v_add_f32 v213, v213, v85
    v_lshlrev_b32 v86, 16, v75
    v_and_b32 v87, 0xffff0000, v75
    v_add_f32 v214, v214, v86
    v_add_f32 v215, v215, v87
    v_cvt_pk_bf16_f32 v128, v192, v193
    v_cvt_pk_bf16_f32 v129, v194, v195
    v_cvt_pk_bf16_f32 v130, v196, v197
    v_cvt_pk_bf16_f32 v131, v198, v199
    s_add_u32 s6, s49, 0
    buffer_store_dwordx2 v[128:129], v232, s[32:35], s6 offen nt
    buffer_store_dwordx2 v[130:131], v232, s[32:35], s6 offen offset:32 nt
    v_cvt_pk_bf16_f32 v132, v200, v201
    v_cvt_pk_bf16_f32 v133, v202, v203
    v_cvt_pk_bf16_f32 v134, v204, v205
    v_cvt_pk_bf16_f32 v135, v206, v207
    s_add_u32 s6, s49, 40960
    buffer_store_dwordx2 v[132:133], v232, s[32:35], s6 offen nt
    buffer_store_dwordx2 v[134:135], v232, s[32:35], s6 offen offset:32 nt
    v_cvt_pk_bf16_f32 v136, v208, v209
    v_cvt_pk_bf16_f32 v137, v210, v211
    v_cvt_pk_bf16_f32 v138, v212, v213
    v_cvt_pk_bf16_f32 v139, v214, v215
    s_add_u32 s6, s49, 81920
    buffer_store_dwordx2 v[136:137], v232, s[32:35], s6 offen nt
    buffer_store_dwordx2 v[138:139], v232, s[32:35], s6 offen offset:32 nt
    s_branch L_end
L_xs0:
    v_mov_b32 v192, v0
    v_mov_b32 v193, v1
    v_mov_b32 v194, v2
    v_mov_b32 v195, v3
    v_mov_b32 v196, v4
    v_mov_b32 v197, v5
    v_mov_b32 v198, v6
    v_mov_b32 v199, v7
    v_mov_b32 v200, v32
    v_mov_b32 v201, v33
    v_mov_b32 v202, v34
    v_mov_b32 v203, v35
    v_mov_b32 v204, v36
    v_mov_b32 v205, v37
    v_mov_b32 v206, v38
    v_mov_b32 v207, v39
    v_mov_b32 v208, v64
    v_mov_b32 v209, v65
    v_mov_b32 v210, v66
    v_mov_b32 v211, v67
    v_mov_b32 v212, v68
    v_mov_b32 v213, v69
    v_mov_b32 v214, v70
    v_mov_b32 v215, v71
    s_branch L_xe0
L_xs1:
    v_mov_b32 v192, v8
    v_mov_b32 v193, v9
    v_mov_b32 v194, v10
    v_mov_b32 v195, v11
    v_mov_b32 v196, v12
    v_mov_b32 v197, v13
    v_mov_b32 v198, v14
    v_mov_b32 v199, v15
    v_mov_b32 v200, v40
    v_mov_b32 v201, v41
    v_mov_b32 v202, v42
    v_mov_b32 v203, v43
    v_mov_b32 v204, v44
    v_mov_b32 v205, v45
    v_mov_b32 v206, v46
    v_mov_b32 v207, v47
    v_mov_b32 v208, v72
    v_mov_b32 v209, v73
    v_mov_b32 v210, v74
    v_mov_b32 v211, v75
    v_mov_b32 v212, v76
    v_mov_b32 v213, v77
    v_mov_b32 v214, v78
    v_mov_b32 v215, v79
    s_branch L_xe1
L_xs2:
    v_mov_b32 v192, v16
    v_mov_b32 v193, v17
    v_mov_b32 v194, v18
    v_mov_b32 v195, v19
    v_mov_b32 v196, v20
    v_mov_b32 v197, v21
    v_mov_b32 v198, v22
    v_mov_b32 v199, v23
    v_mov_b32 v200, v48
    v_mov_b32 v201, v49
    v_mov_b32 v202, v50
    v_mov_b32 v203, v51
    v_mov_b32 v204, v52
    v_mov_b32 v205, v53
    v_mov_b32 v206, v54
    v_mov_b32 v207, v55
    v_mov_b32 v208, v80
    v_mov_b32 v209, v81
    v_mov_b32 v210, v82
    v_mov_b32 v211, v83
    v_mov_b32 v212, v84
    v_mov_b32 v213, v85
    v_mov_b32 v214, v86
    v_mov_b32 v215, v87
    s_branch L_xe2
L_xs3:
    v_mov_b32 v192, v24
    v_mov_b32 v193, v25
    v_mov_b32 v194, v26
    v_mov_b32 v195, v27
    v_mov_b32 v196, v28
    v_mov_b32 v197, v29
    v_mov_b32 v198, v30
    v_mov_b32 v199, v31
    v_mov_b32 v200, v56
    v_mov_b32 v201, v57
    v_mov_b32 v202, v58
    v_mov_b32 v203, v59
    v_mov_b32 v204, v60
    v_mov_b32 v205, v61
    v_mov_b32 v206, v62
    v_mov_b32 v207, v63
    v_mov_b32 v208, v88
    v_mov_b32 v209, v89
    v_mov_b32 v210, v90
    v_mov_b32 v211, v91
    v_mov_b32 v212, v92
    v_mov_b32 v213, v93
    v_mov_b32 v214, v94
    v_mov_b32 v215, v95
    s_branch L_xe3
L_end:
    s_endpgm
.section .rodata,"a"
.p2align 6
.amdhsa_kernel concat_heads__gqa_block_cached__gqa_block_cached__near_ridge_kernel
  .amdhsa_next_free_vgpr 256
  .amdhsa_next_free_sgpr 102
  .amdhsa_accum_offset 256
  .amdhsa_group_segment_fixed_size 0
  .amdhsa_kernarg_size 104
  .amdhsa_user_sgpr_count 2
  .amdhsa_user_sgpr_kernarg_segment_ptr 1
  .amdhsa_system_sgpr_workgroup_id_x 1
.end_amdhsa_kernel
```
